```python
import torch

def _softmax(x, axis=-1):
    return torch.softmax(x, dim=axis)

def _gelu(x):
    return torch.nn.functional.gelu(x, approximate='tanh')

def _silu(x):
    return torch.nn.functional.silu(x)

def _sigmoid(x):
    return torch.sigmoid(x)

def _layernorm(x, axis=-1, eps=1e-05):
    m = x.mean(dim=axis, keepdim=True)
    v = x.var(dim=axis, keepdim=True, unbiased=False)
    return (x - m) / torch.sqrt(v + eps)

def _scatter_add(tgt, idx, src, axis=0):
    return tgt.clone().index_add_(axis, idx, src)

def _segment_sum(src, seg, n):
    out = torch.zeros((n,) + src.shape[1:], dtype=src.dtype)
    return out.index_add_(0, seg, src)

def _pad(x, pw):
    flat = tuple((v for pair in reversed(pw) for v in pair))
    return torch.nn.functional.pad(x, flat)
kernel_name = 'recurrent_scan__mha_block__mixer_gmlp__prompt'

def setup_inputs():

    _w = lambda a: (lambda t: t.to(torch.bfloat16) if t.is_floating_point() else t)(torch.as_tensor(a))

    def _A_setup():
        B, S, D, H = (1, 2048, 1024, 32)
        return {'x': _w((lambda *s: torch.randn(*s, dtype=torch.bfloat16) * 0.05)(B, S, D)), 'wqkv': _w((lambda *s: torch.randn(*s, dtype=torch.bfloat16) * 0.05)(D, 3 * D)), 'wo': _w((lambda *s: torch.randn(*s, dtype=torch.bfloat16) * 0.05)(D, D))}
    _A_in = _A_setup()

    def _B_setup():
        B, S, D, F = (1, 2048, 1024, 3584)
        Fh = F // 2
        return {'x': _w((lambda *s: torch.randn(*s, dtype=torch.bfloat16) * 0.05)(B, S, D)), 'w_in': _w((lambda *s: torch.randn(*s, dtype=torch.bfloat16) * 0.8)(D, 2 * Fh)), 'w_sp': _w(0.01 * (lambda *s: torch.randn(*s, dtype=torch.bfloat16) * 0.8)(S, S)), 'b_sp': _w(1.0 + 0.01 * (lambda *s: torch.randn(*s, dtype=torch.bfloat16) * 0.05)(S)), 'w_out': _w((lambda *s: torch.randn(*s, dtype=torch.bfloat16) * 0.05)(Fh, D))}
    _B_in = _B_setup()
    return {'A_x': _A_in['x'], 'A_wqkv': _A_in['wqkv'], 'A_wo': _A_in['wo'], 'B_x': _B_in['x'], 'B_w_in': _B_in['w_in'], 'B_w_sp': _B_in['w_sp'], 'B_b_sp': _B_in['b_sp'], 'B_w_out': _B_in['w_out']}

def reference(A_x, A_wqkv, A_wo, B_x, B_w_in, B_w_sp, B_b_sp, B_w_out):

    def _A_ref(x, wqkv, wo):
        B, S, D = x.shape
        H = 32
        Dh = D // H
        qkv = (lambda x, *d: x.permute(*d))((x @ wqkv).reshape(B, S, 3, H, Dh), 2, 0, 3, 1, 4)
        q, k, v = (qkv[0], qkv[1], qkv[2])
        scores = torch.einsum('bhqd,bhkd->bhqk', q, k) * Dh ** (-0.5)
        p = _softmax(scores, axis=-1)
        o = torch.einsum('bhqk,bhkd->bhqd', p, v)
        return (lambda x, *d: x.permute(*d))(o, 0, 2, 1, 3).reshape(B, S, D) @ wo

    def _B_ref(x, w_in, w_sp, b_sp, w_out):
        B, S, D = x.shape
        F = w_in.shape[-1]
        Fh = F // 2
        z = _gelu(torch.einsum('bsd,df->bsf', x, w_in))
        z1 = z[..., :Fh].clone()
        z2 = _layernorm(z[..., Fh:], axis=-1)
        g = torch.einsum('ts,bsf->btf', w_sp, z2) + b_sp[None, :, None]
        return torch.einsum('bsf,fd->bsd', z1 * g, w_out)
    x = A_x
    xn = _layernorm(x, axis=-1)
    s = _A_ref(xn, A_wqkv, A_wo)
    g = _silu(_B_ref(xn, B_w_in, B_w_sp, B_b_sp, B_w_out))
    return x + s * g
```

```asm
; @launch grid=(256,1,1) block=(512,1,1) lds=163840
.amdgcn_target "amdgcn-amd-amdhsa--gfx950"
.text
.globl recurrent_scan__mha_block__mixer_gmlp__prompt_kernel
.p2align 8
.type recurrent_scan__mha_block__mixer_gmlp__prompt_kernel,@function
recurrent_scan__mha_block__mixer_gmlp__prompt_kernel:
    s_cmp_ge_u32 s2, 256
    s_cbranch_scc1 m_done
    s_load_dwordx16 s[8:23], s[0:1], 0
    s_load_dwordx2 s[60:61], s[0:1], 64
    s_load_dwordx2 s[36:37], s[0:1], 80
    s_getpc_b64 s[34:35]
m_pc:
    v_subrev_u32 v11, 448, v0
    s_and_b32 s26, s2, 0xf8
    s_lshl_b32 s26, s26, 8
    v_cmp_gt_u32 vcc, 16, v11
    v_lshlrev_b32 v11, 7, v11
    v_add_u32 v11, s26, v11
    v_min_u32 v11, m_done - m_pc, v11
    s_and_saveexec_b64 s[28:29], vcc
    s_cbranch_execz m_nocw
    global_load_dword v253, v11, s[34:35]
m_nocw:
    s_mov_b64 exec, s[28:29]
    v_lshrrev_b32 v8, 6, v0
    v_and_b32 v9, 63, v0
    v_readfirstlane_b32 s3, v8
    s_lshr_b32 s24, s2, 5
    s_and_b32 s25, s2, 31
    s_and_b32 s7, s3, 3
    s_lshl_b32 s26, s24, 8
    s_lshr_b32 s27, s25, 2
    s_lshl_b32 s27, s27, 5
    s_add_u32 s26, s26, s27
    s_bfe_u32 s27, s25, 0x10001
    s_lshl_b32 s27, s27, 2
    s_add_u32 s26, s26, s27
    s_and_b32 s27, s25, 1
    s_lshl_b32 s27, s27, 4
    s_add_u32 s26, s26, s27
    v_bfe_u32 v10, v9, 2, 1
    v_lshlrev_b32 v10, 3, v10
    v_and_b32 v11, 3, v9
    v_add3_u32 v10, v10, v11, s26
    v_lshlrev_b32 v10, 11, v10
    v_lshrrev_b32 v11, 5, v9
    v_lshl_add_u32 v10, v11, 8, v10
    v_bfe_u32 v11, v9, 3, 2
    v_lshl_add_u32 v10, v11, 3, v10
    s_lshl_b32 s27, s3, 9
    s_waitcnt lgkmcnt(0)
    s_mov_b32 s56, s8
    s_mov_b32 s57, s9
    s_mov_b32 s58, 0x400000
    s_mov_b32 s59, 0x20000
    s_cmp_ge_u32 s3, 4
    s_cbranch_scc1 m_skipx
    buffer_load_dwordx2 v[16:17], v10, s[56:59], s27 offen offset:0
    buffer_load_dwordx2 v[18:19], v10, s[56:59], s27 offen offset:32
    buffer_load_dwordx2 v[20:21], v10, s[56:59], s27 offen offset:64
    buffer_load_dwordx2 v[22:23], v10, s[56:59], s27 offen offset:96
    buffer_load_dwordx2 v[24:25], v10, s[56:59], s27 offen offset:128
    buffer_load_dwordx2 v[26:27], v10, s[56:59], s27 offen offset:160
    buffer_load_dwordx2 v[28:29], v10, s[56:59], s27 offen offset:192
    buffer_load_dwordx2 v[30:31], v10, s[56:59], s27 offen offset:224
    v_and_b32 v10, 0xfffff800, v10
    buffer_load_ushort v87, v10, s[56:59], 0 offen
m_skipx:
    s_add_u32 s100, s36, 0x2f00000
    s_addc_u32 s101, s37, 0
    s_load_dword s4, s[100:101], 196608
    s_mov_b32 s38, 0x4000000
    s_mov_b32 s39, 0x20000
    s_mov_b32 s62, 0x400000
    s_mov_b32 s63, 0x20000
    s_mov_b32 s44, s18
    s_mov_b32 s45, s19
    s_mov_b32 s46, 0x800000
    s_mov_b32 s47, 0x20000
    s_mov_b32 s48, s12
    s_mov_b32 s49, s13
    s_mov_b32 s50, 0x200000
    s_mov_b32 s51, 0x20000
    s_mov_b32 s52, s22
    s_mov_b32 s53, s23
    s_mov_b32 s54, 0x380000
    s_mov_b32 s55, 0x20000
    s_mov_b32 s96, s20
    s_mov_b32 s97, s21
    s_mov_b32 s98, 0x1000
    s_mov_b32 s99, 0x20000
    v_lshlrev_b32 v11, 2, v9
    v_mov_b32 v12, 0
    ds_write_b32 v11, v12 offset:1024
    ds_write_b32 v11, v12 offset:1280
    ds_write_b32 v11, v12 offset:1536
    s_waitcnt lgkmcnt(0)
    s_barrier
    s_xor_b32 s30, s4, 0x9e3779b9
    s_mul_i32 s30, s30, 0x85ebca6b
    s_add_u32 s30, s30, 0x632be5ab
    s_add_u32 s31, s30, 1
    s_cmp_eq_u32 s30, s4
    s_cselect_b32 s4, s31, s30
    s_cmp_ge_u32 s3, 4
    s_cbranch_scc1 m_zwave
    s_mov_b32 s40, s10
    s_mov_b32 s41, s11
    s_mov_b32 s42, 0x600000
    s_mov_b32 s43, 0x20000
    v_and_b32 v10, 7, v9
    v_lshlrev_b32 v10, 4, v10
    s_lshl_b32 s16, s3, 2
    v_add_u32 v11, s16, v10
    v_lshrrev_b32 v12, 5, v9
    v_lshlrev_b32 v12, 16, v12
    v_bfe_u32 v13, v9, 3, 2
    v_lshl_add_u32 v12, v13, 8, v12
    v_add_u32 v12, v12, v10
    s_lshl_b32 s18, s24, 19
    s_lshl_b32 s19, s3, 17
    s_add_u32 s18, s18, s19
    s_lshl_b32 s19, s25, 9
    s_and_b32 s19, s19, 0xfffffc00
    s_add_u32 s18, s18, s19
    s_and_b32 s19, s25, 1
    s_lshl_b32 s19, s19, 7
    s_add_u32 s18, s18, s19
    v_lshlrev_b32 v14, 2, v9
    v_add_u32 v14, 1024, v14
    v_mov_b32 v15, 1
    s_mov_b32 s20, 0
    s_waitcnt vmcnt(0)
    v_lshlrev_b32 v32, 16, v16
    v_and_b32 v33, 0xffff0000, v16
    v_lshlrev_b32 v34, 16, v17
    v_and_b32 v35, 0xffff0000, v17
    v_lshlrev_b32 v36, 16, v18
    v_and_b32 v37, 0xffff0000, v18
    v_lshlrev_b32 v38, 16, v19
    v_and_b32 v39, 0xffff0000, v19
    v_lshlrev_b32 v40, 16, v20
    v_and_b32 v41, 0xffff0000, v20
    v_lshlrev_b32 v42, 16, v21
    v_and_b32 v43, 0xffff0000, v21
    v_lshlrev_b32 v44, 16, v22
    v_and_b32 v45, 0xffff0000, v22
    v_lshlrev_b32 v46, 16, v23
    v_and_b32 v47, 0xffff0000, v23
    v_lshlrev_b32 v48, 16, v24
    v_and_b32 v49, 0xffff0000, v24
    v_lshlrev_b32 v50, 16, v25
    v_and_b32 v51, 0xffff0000, v25
    v_lshlrev_b32 v52, 16, v26
    v_and_b32 v53, 0xffff0000, v26
    v_lshlrev_b32 v54, 16, v27
    v_and_b32 v55, 0xffff0000, v27
    v_lshlrev_b32 v56, 16, v28
    v_and_b32 v57, 0xffff0000, v28
    v_lshlrev_b32 v58, 16, v29
    v_and_b32 v59, 0xffff0000, v29
    v_lshlrev_b32 v60, 16, v30
    v_and_b32 v61, 0xffff0000, v30
    v_lshlrev_b32 v62, 16, v31
    v_and_b32 v63, 0xffff0000, v31
    v_lshlrev_b32 v76, 16, v87
    v_xor_b32 v76, 0x80000000, v76
    v_mov_b32 v77, v76
    v_pk_add_f32 v[80:81], v[32:33], v[76:77]
    v_pk_mul_f32 v[66:67], v[80:81], v[80:81]
    v_pk_add_f32 v[64:65], v[80:81], 0
    v_pk_add_f32 v[82:83], v[34:35], v[76:77]
    v_pk_fma_f32 v[66:67], v[82:83], v[82:83], v[66:67]
    v_pk_add_f32 v[64:65], v[64:65], v[82:83]
    v_pk_add_f32 v[80:81], v[36:37], v[76:77]
    v_pk_fma_f32 v[66:67], v[80:81], v[80:81], v[66:67]
    v_pk_add_f32 v[64:65], v[64:65], v[80:81]
    v_pk_add_f32 v[82:83], v[38:39], v[76:77]
    v_pk_fma_f32 v[66:67], v[82:83], v[82:83], v[66:67]
    v_pk_add_f32 v[64:65], v[64:65], v[82:83]
    v_pk_add_f32 v[80:81], v[40:41], v[76:77]
    v_pk_fma_f32 v[66:67], v[80:81], v[80:81], v[66:67]
    v_pk_add_f32 v[64:65], v[64:65], v[80:81]
    v_pk_add_f32 v[82:83], v[42:43], v[76:77]
    v_pk_fma_f32 v[66:67], v[82:83], v[82:83], v[66:67]
    v_pk_add_f32 v[64:65], v[64:65], v[82:83]
    v_pk_add_f32 v[80:81], v[44:45], v[76:77]
    v_pk_fma_f32 v[66:67], v[80:81], v[80:81], v[66:67]
    v_pk_add_f32 v[64:65], v[64:65], v[80:81]
    v_pk_add_f32 v[82:83], v[46:47], v[76:77]
    v_pk_fma_f32 v[66:67], v[82:83], v[82:83], v[66:67]
    v_pk_add_f32 v[64:65], v[64:65], v[82:83]
    v_pk_add_f32 v[80:81], v[48:49], v[76:77]
    v_pk_fma_f32 v[66:67], v[80:81], v[80:81], v[66:67]
    v_pk_add_f32 v[64:65], v[64:65], v[80:81]
    v_pk_add_f32 v[82:83], v[50:51], v[76:77]
    v_pk_fma_f32 v[66:67], v[82:83], v[82:83], v[66:67]
    v_pk_add_f32 v[64:65], v[64:65], v[82:83]
    v_pk_add_f32 v[80:81], v[52:53], v[76:77]
    v_pk_fma_f32 v[66:67], v[80:81], v[80:81], v[66:67]
    v_pk_add_f32 v[64:65], v[64:65], v[80:81]
    v_pk_add_f32 v[82:83], v[54:55], v[76:77]
    v_pk_fma_f32 v[66:67], v[82:83], v[82:83], v[66:67]
    v_pk_add_f32 v[64:65], v[64:65], v[82:83]
    v_pk_add_f32 v[80:81], v[56:57], v[76:77]
    v_pk_fma_f32 v[66:67], v[80:81], v[80:81], v[66:67]
    v_pk_add_f32 v[64:65], v[64:65], v[80:81]
    v_pk_add_f32 v[82:83], v[58:59], v[76:77]
    v_pk_fma_f32 v[66:67], v[82:83], v[82:83], v[66:67]
    v_pk_add_f32 v[64:65], v[64:65], v[82:83]
    v_pk_add_f32 v[80:81], v[60:61], v[76:77]
    v_pk_fma_f32 v[66:67], v[80:81], v[80:81], v[66:67]
    v_pk_add_f32 v[64:65], v[64:65], v[80:81]
    v_pk_add_f32 v[82:83], v[62:63], v[76:77]
    v_pk_fma_f32 v[66:67], v[82:83], v[82:83], v[66:67]
    v_pk_add_f32 v[64:65], v[64:65], v[82:83]
    v_add_f32 v64, v64, v65
    v_add_f32 v65, v66, v67
    s_nop 0
    v_add_f32_dpp v64, v64, v64 row_ror:8 row_mask:0xf bank_mask:0xf
    v_add_f32_dpp v65, v65, v65 row_ror:8 row_mask:0xf bank_mask:0xf
    v_mov_b32 v66, v64
    v_mov_b32 v67, v65
    s_nop 0
    v_permlane32_swap_b32 v64, v66
    v_permlane32_swap_b32 v65, v67
    s_nop 0
    v_add_f32 v64, v64, v66
    v_add_f32 v65, v65, v67
    v_mov_b32 v66, v64
    v_mov_b32 v67, v65
    s_nop 0
    v_permlane16_swap_b32 v64, v66
    v_permlane16_swap_b32 v65, v67
    s_nop 0
    v_add_f32 v64, v64, v66
    v_add_f32 v65, v65, v67
    ds_write_b32 v11, v64
    ds_write_b32 v11, v65 offset:256
    s_waitcnt lgkmcnt(0)
    s_add_u32 s20, s20, 4
    ds_add_u32 v14, v15
ln_s_s:
    ds_read_b32 v66, v14
    s_waitcnt lgkmcnt(0)
    v_readfirstlane_b32 s21, v66
    s_cmp_ge_u32 s21, s20
    s_cbranch_scc0 ln_s_s
    ds_read_b128 v[68:71], v10
    ds_read_b128 v[72:75], v10 offset:256
    s_waitcnt lgkmcnt(0)
    v_add_f32 v68, v68, v69
    v_add_f32 v70, v70, v71
    v_add_f32 v72, v72, v73
    v_add_f32 v74, v74, v75
    v_add_f32 v68, v68, v70
    v_add_f32 v72, v72, v74
    v_mul_f32 v68, 0x3a800000, v68
    v_mul_f32 v64, 0x3a800000, v72
    v_fma_f32 v64, -v68, v68, v64
    v_max_f32 v64, 0, v64
    v_sub_f32 v76, v76, v68
    v_cvt_pk_bf16_f32 v78, v76, v64
    v_lshlrev_b32 v76, 16, v78
    v_and_b32 v64, 0xffff0000, v78
    v_add_f32 v64, 0x3727c5ac, v64
    v_cvt_pk_bf16_f32 v64, v64, v64
    v_and_b32 v64, 0xffff0000, v64
    v_sqrt_f32 v64, v64
    s_nop 0
    v_cvt_pk_bf16_f32 v64, v64, v64
    v_and_b32 v64, 0xffff0000, v64
    v_rcp_f32 v64, v64
    s_nop 0
    v_mov_b32 v77, v76
    v_mov_b32 v65, v64
    v_pk_add_f32 v[80:81], v[32:33], v[76:77]
    v_cvt_pk_bf16_f32 v82, v80, v81
    v_lshlrev_b32 v80, 16, v82
    v_and_b32 v81, 0xffff0000, v82
    v_pk_mul_f32 v[80:81], v[80:81], v[64:65]
    v_cvt_pk_bf16_f32 v88, v80, v81
    v_pk_add_f32 v[84:85], v[34:35], v[76:77]
    v_cvt_pk_bf16_f32 v86, v84, v85
    v_lshlrev_b32 v84, 16, v86
    v_and_b32 v85, 0xffff0000, v86
    v_pk_mul_f32 v[84:85], v[84:85], v[64:65]
    v_cvt_pk_bf16_f32 v89, v84, v85
    v_pk_add_f32 v[80:81], v[36:37], v[76:77]
    v_cvt_pk_bf16_f32 v82, v80, v81
    v_lshlrev_b32 v80, 16, v82
    v_and_b32 v81, 0xffff0000, v82
    v_pk_mul_f32 v[80:81], v[80:81], v[64:65]
    v_cvt_pk_bf16_f32 v90, v80, v81
    v_pk_add_f32 v[84:85], v[38:39], v[76:77]
    v_cvt_pk_bf16_f32 v86, v84, v85
    v_lshlrev_b32 v84, 16, v86
    v_and_b32 v85, 0xffff0000, v86
    v_pk_mul_f32 v[84:85], v[84:85], v[64:65]
    v_cvt_pk_bf16_f32 v91, v84, v85
    v_pk_add_f32 v[80:81], v[40:41], v[76:77]
    v_cvt_pk_bf16_f32 v82, v80, v81
    v_lshlrev_b32 v80, 16, v82
    v_and_b32 v81, 0xffff0000, v82
    v_pk_mul_f32 v[80:81], v[80:81], v[64:65]
    v_cvt_pk_bf16_f32 v92, v80, v81
    v_pk_add_f32 v[84:85], v[42:43], v[76:77]
    v_cvt_pk_bf16_f32 v86, v84, v85
    v_lshlrev_b32 v84, 16, v86
    v_and_b32 v85, 0xffff0000, v86
    v_pk_mul_f32 v[84:85], v[84:85], v[64:65]
    v_cvt_pk_bf16_f32 v93, v84, v85
    v_pk_add_f32 v[80:81], v[44:45], v[76:77]
    v_cvt_pk_bf16_f32 v82, v80, v81
    v_lshlrev_b32 v80, 16, v82
    v_and_b32 v81, 0xffff0000, v82
    v_pk_mul_f32 v[80:81], v[80:81], v[64:65]
    v_cvt_pk_bf16_f32 v94, v80, v81
    v_pk_add_f32 v[84:85], v[46:47], v[76:77]
    v_cvt_pk_bf16_f32 v86, v84, v85
    v_lshlrev_b32 v84, 16, v86
    v_and_b32 v85, 0xffff0000, v86
    v_pk_mul_f32 v[84:85], v[84:85], v[64:65]
    v_cvt_pk_bf16_f32 v95, v84, v85
    v_pk_add_f32 v[80:81], v[48:49], v[76:77]
    v_cvt_pk_bf16_f32 v82, v80, v81
    v_lshlrev_b32 v80, 16, v82
    v_and_b32 v81, 0xffff0000, v82
    v_pk_mul_f32 v[80:81], v[80:81], v[64:65]
    v_cvt_pk_bf16_f32 v96, v80, v81
    v_pk_add_f32 v[84:85], v[50:51], v[76:77]
    v_cvt_pk_bf16_f32 v86, v84, v85
    v_lshlrev_b32 v84, 16, v86
    v_and_b32 v85, 0xffff0000, v86
    v_pk_mul_f32 v[84:85], v[84:85], v[64:65]
    v_cvt_pk_bf16_f32 v97, v84, v85
    v_pk_add_f32 v[80:81], v[52:53], v[76:77]
    v_cvt_pk_bf16_f32 v82, v80, v81
    v_lshlrev_b32 v80, 16, v82
    v_and_b32 v81, 0xffff0000, v82
    v_pk_mul_f32 v[80:81], v[80:81], v[64:65]
    v_cvt_pk_bf16_f32 v98, v80, v81
    v_pk_add_f32 v[84:85], v[54:55], v[76:77]
    v_cvt_pk_bf16_f32 v86, v84, v85
    v_lshlrev_b32 v84, 16, v86
    v_and_b32 v85, 0xffff0000, v86
    v_pk_mul_f32 v[84:85], v[84:85], v[64:65]
    v_cvt_pk_bf16_f32 v99, v84, v85
    v_pk_add_f32 v[80:81], v[56:57], v[76:77]
    v_cvt_pk_bf16_f32 v82, v80, v81
    v_lshlrev_b32 v80, 16, v82
    v_and_b32 v81, 0xffff0000, v82
    v_pk_mul_f32 v[80:81], v[80:81], v[64:65]
    v_cvt_pk_bf16_f32 v100, v80, v81
    v_pk_add_f32 v[84:85], v[58:59], v[76:77]
    v_cvt_pk_bf16_f32 v86, v84, v85
    v_lshlrev_b32 v84, 16, v86
    v_and_b32 v85, 0xffff0000, v86
    v_pk_mul_f32 v[84:85], v[84:85], v[64:65]
    v_cvt_pk_bf16_f32 v101, v84, v85
    v_pk_add_f32 v[80:81], v[60:61], v[76:77]
    v_cvt_pk_bf16_f32 v82, v80, v81
    v_lshlrev_b32 v80, 16, v82
    v_and_b32 v81, 0xffff0000, v82
    v_pk_mul_f32 v[80:81], v[80:81], v[64:65]
    v_cvt_pk_bf16_f32 v102, v80, v81
    v_pk_add_f32 v[84:85], v[62:63], v[76:77]
    v_cvt_pk_bf16_f32 v86, v84, v85
    v_lshlrev_b32 v84, 16, v86
    v_and_b32 v85, 0xffff0000, v86
    v_pk_mul_f32 v[84:85], v[84:85], v[64:65]
    v_cvt_pk_bf16_f32 v103, v84, v85
    buffer_store_dwordx4 v[88:91], v12, s[36:39], s18 offen sc1
    s_add_u32 s18, s18, 16384
    buffer_store_dwordx4 v[92:95], v12, s[36:39], s18 offen sc1
    s_add_u32 s18, s18, 16384
    buffer_store_dwordx4 v[96:99], v12, s[36:39], s18 offen sc1
    s_add_u32 s18, s18, 16384
    buffer_store_dwordx4 v[100:103], v12, s[36:39], s18 offen sc1
    s_lshl_b32 s16, s24, 5
    s_add_u32 s16, s16, s25
    s_lshl_b32 s16, s16, 7
    s_add_u32 s16, s16, 0x2f00000
    v_mov_b32 v12, 1280
    v_mov_b32 v13, 1
    s_waitcnt vmcnt(0)
    s_mov_b64 exec, 1
    ds_add_rtn_u32 v13, v12, v13
    v_mov_b32 v12, s4
    s_waitcnt lgkmcnt(0)
    v_readfirstlane_b32 s21, v13
    v_mov_b32 v13, 0
    s_cmp_lg_u32 s21, 3
    s_cbranch_scc1 fln_nf
    buffer_store_dword v12, v13, s[36:39], s16 offen sc1
fln_nf:
    s_mov_b64 exec, -1
    v_mov_b32 v10, 1536
q_idw:
    ds_read_b32 v11, v10
    s_waitcnt lgkmcnt(0)
    v_readfirstlane_b32 s6, v11
    s_cmp_lg_u32 s6, 0
    s_cbranch_scc1 q_idd
    s_sleep 1
    s_branch q_idw
q_idd:
    s_and_b32 s5, s6, 7
    s_bfe_u32 s6, s6, 0x50003
    s_and_b32 s26, s5, 1
    s_lshl_b32 s26, s26, 2
    s_lshr_b32 s27, s6, 3
    s_add_u32 s24, s26, s27
    s_lshr_b32 s26, s5, 1
    s_lshl_b32 s26, s26, 3
    s_and_b32 s27, s6, 7
    s_add_u32 s25, s26, s27
    s_bfe_u32 s26, s6, 0x10002
    s_lshl_b32 s27, s26, 1
    s_lshr_b32 s25, s5, 1
    s_add_u32 s27, s27, s25
    s_and_b32 s27, s27, 3
    s_lshl_b32 s27, s27, 2
    s_lshl_b32 s26, s26, 4
    s_add_u32 s27, s27, s26
    s_and_b32 s26, s6, 3
    s_add_u32 s25, s27, s26
    v_lshlrev_b32 v10, 4, v9
    s_lshl_b32 s30, s3, 11
    v_add_u32 v5, s30, v10
    s_lshl_b32 s28, s24, 19
    s_lshl_b32 s17, s7, 12
    v_add_u32 v1, s17, v10
    v_bfe_u32 v11, v9, 2, 2
    v_and_b32 v12, 3, v9
    v_bfe_u32 v13, v9, 4, 1
    v_lshrrev_b32 v14, 5, v9
    v_lshlrev_b32 v15, 11, v14
    v_lshl_add_u32 v15, v12, 3, v15
    s_mov_b32 s29, 0
    s_lshl_b32 s17, s7, 11
    s_add_u32 s31, s17, 16384
    v_mul_u32_u24 v96, 800, v13
    v_mul_u32_u24 v97, 192, v11
    v_add3_u32 v2, v15, v96, v97
    s_mul_i32 s20, s7, 49152
    s_add_u32 s17, s25, 0
    s_and_b32 s17, s17, 31
    s_lshl_b32 s17, s17, 6
    s_add_u32 s21, s17, 0
    s_add_u32 s17, s25, 0
    s_and_b32 s17, s17, 31
    s_lshl_b32 s17, s17, 6
    s_add_u32 s22, s17, 1984
    s_add_u32 s17, s25, 0
    s_and_b32 s17, s17, 31
    s_lshl_b32 s17, s17, 6
    s_add_u32 s23, s17, 3968
    v_add_u32 v96, 0, v9
    v_cmp_le_u32 vcc, 50, v96
    v_subrev_u32 v97, 2, v96
    s_nop 0
    v_cndmask_b32 v97, v96, v97, vcc
    v_mul_u32_u24 v98, 43, v97
    v_lshrrev_b32 v98, 9, v98
    v_mul_u32_u24 v99, 12, v98
    v_sub_u32 v99, v97, v99
    v_mul_u32_u24 v98, 6144, v98
    v_lshl_add_u32 v98, v99, 4, v98
    v_add_u32 v98, s20, v98
    v_mov_b32 v101, s21
    v_mov_b32 v102, s22
    v_cmp_le_u32 vcc, 4, v99
    v_mov_b32 v103, s23
    s_nop 0
    v_cndmask_b32 v101, v101, v102, vcc
    v_cmp_le_u32 vcc, 8, v99
    s_nop 1
    v_cndmask_b32 v101, v101, v103, vcc
    v_add_u32 v98, v98, v101
    v_lshrrev_b32 v99, 1, v96
    v_cmp_eq_u32 vcc, 24, v99
    v_mov_b32 v100, 0x40000000
    s_nop 0
    v_cndmask_b32 v98, v98, v100, vcc
    v_cmp_le_u32 vcc, 98, v96
    s_nop 1
    v_cndmask_b32 v6, v98, v100, vcc
    v_add_u32 v96, 64, v9
    v_cmp_le_u32 vcc, 50, v96
    v_subrev_u32 v97, 2, v96
    s_nop 0
    v_cndmask_b32 v97, v96, v97, vcc
    v_mul_u32_u24 v98, 43, v97
    v_lshrrev_b32 v98, 9, v98
    v_mul_u32_u24 v99, 12, v98
    v_sub_u32 v99, v97, v99
    v_mul_u32_u24 v98, 6144, v98
    v_lshl_add_u32 v98, v99, 4, v98
    v_add_u32 v98, s20, v98
    v_mov_b32 v101, s21
    v_mov_b32 v102, s22
    v_cmp_le_u32 vcc, 4, v99
    v_mov_b32 v103, s23
    s_nop 0
    v_cndmask_b32 v101, v101, v102, vcc
    v_cmp_le_u32 vcc, 8, v99
    s_nop 1
    v_cndmask_b32 v101, v101, v103, vcc
    v_add_u32 v98, v98, v101
    v_subrev_u32 v98, 1024, v98
    v_lshrrev_b32 v99, 1, v96
    v_cmp_eq_u32 vcc, 24, v99
    v_mov_b32 v100, 0x40000000
    s_nop 0
    v_cndmask_b32 v98, v98, v100, vcc
    v_cmp_le_u32 vcc, 98, v96
    s_nop 1
    v_cndmask_b32 v7, v98, v100, vcc
    s_lshl_b32 s35, s25, 3
    s_add_u32 s35, s35, s24
    s_lshl_b32 s15, s35, 7
    s_add_u32 s15, s15, 0x2f08000
    s_and_b32 s33, s6, 1
    v_mov_b32 v104, 0
    v_mov_b32 v105, 0
    v_mov_b32 v106, 0
    v_mov_b32 v107, 0
    v_mov_b32 v108, 0
    v_mov_b32 v109, 0
    v_mov_b32 v110, 0
    v_mov_b32 v111, 0
    v_mov_b32 v112, 0
    v_mov_b32 v113, 0
    v_mov_b32 v114, 0
    v_mov_b32 v115, 0
    v_mov_b32 v116, 0
    v_mov_b32 v117, 0
    v_mov_b32 v118, 0
    v_mov_b32 v119, 0
    v_mov_b32 v120, 0
    v_mov_b32 v121, 0
    v_mov_b32 v122, 0
    v_mov_b32 v123, 0
    v_mov_b32 v124, 0
    v_mov_b32 v125, 0
    v_mov_b32 v126, 0
    v_mov_b32 v127, 0
    v_mov_b32 v128, 0
    v_mov_b32 v129, 0
    v_mov_b32 v130, 0
    v_mov_b32 v131, 0
    v_mov_b32 v132, 0
    v_mov_b32 v133, 0
    v_mov_b32 v134, 0
    v_mov_b32 v135, 0
    v_mov_b32 v136, 0
    v_mov_b32 v137, 0
    v_mov_b32 v138, 0
    v_mov_b32 v139, 0
    v_mov_b32 v140, 0
    v_mov_b32 v141, 0
    v_mov_b32 v142, 0
    v_mov_b32 v143, 0
    v_mov_b32 v144, 0
    v_mov_b32 v145, 0
    v_mov_b32 v146, 0
    v_mov_b32 v147, 0
    v_mov_b32 v148, 0
    v_mov_b32 v149, 0
    v_mov_b32 v150, 0
    v_mov_b32 v151, 0
    v_mov_b32 v152, 0
    v_mov_b32 v153, 0
    v_mov_b32 v154, 0
    v_mov_b32 v155, 0
    v_mov_b32 v156, 0
    v_mov_b32 v157, 0
    v_mov_b32 v158, 0
    v_mov_b32 v159, 0
    v_mov_b32 v160, 0
    v_mov_b32 v161, 0
    v_mov_b32 v162, 0
    v_mov_b32 v163, 0
    v_mov_b32 v164, 0
    v_mov_b32 v165, 0
    v_mov_b32 v166, 0
    v_mov_b32 v167, 0
    v_mov_b32 v168, 0
    v_mov_b32 v169, 0
    v_mov_b32 v170, 0
    v_mov_b32 v171, 0
    v_mov_b32 v172, 0
    v_mov_b32 v173, 0
    v_mov_b32 v174, 0
    v_mov_b32 v175, 0
    v_mov_b32 v176, 0
    v_mov_b32 v177, 0
    v_mov_b32 v178, 0
    v_mov_b32 v179, 0
    v_mov_b32 v180, 0
    v_mov_b32 v181, 0
    v_mov_b32 v182, 0
    v_mov_b32 v183, 0
    v_mov_b32 v184, 0
    v_mov_b32 v185, 0
    v_mov_b32 v186, 0
    v_mov_b32 v187, 0
    v_mov_b32 v188, 0
    v_mov_b32 v189, 0
    v_mov_b32 v190, 0
    v_mov_b32 v191, 0
    v_mov_b32 v192, 0
    v_mov_b32 v193, 0
    v_mov_b32 v194, 0
    v_mov_b32 v195, 0
    v_mov_b32 v196, 0
    v_mov_b32 v197, 0
    v_mov_b32 v198, 0
    v_mov_b32 v199, 0
    v_mov_b32 v3, v1
    v_mov_b32 v4, v2
    s_mov_b32 s26, 0
    s_mov_b32 s27, 0
    s_add_u32 m0, s27, s31
    s_nop 0
    buffer_load_dwordx4 v6, s[40:43], s29 offen lds
    buffer_load_dwordx4 v7, s[40:43], s29 offen offset:1024 lds
    s_add_u32 s29, s29, 196608
    s_mov_b32 s27, 32768
    s_add_u32 m0, s27, s31
    s_nop 0
    buffer_load_dwordx4 v6, s[40:43], s29 offen lds
    buffer_load_dwordx4 v7, s[40:43], s29 offen offset:1024 lds
    s_add_u32 s29, s29, 196608
    s_mov_b32 s27, 65536
    s_add_u32 m0, s27, s31
    s_nop 0
    buffer_load_dwordx4 v6, s[40:43], s29 offen lds
    buffer_load_dwordx4 v7, s[40:43], s29 offen offset:1024 lds
    s_add_u32 s29, s29, 196608
    s_mov_b32 s27, 98304
    s_add_u32 m0, s27, s31
    s_nop 0
    buffer_load_dwordx4 v6, s[40:43], s29 offen lds
    buffer_load_dwordx4 v7, s[40:43], s29 offen offset:1024 lds
    s_add_u32 s29, s29, 196608
    s_mov_b32 s27, 131072
    s_add_u32 m0, s27, s31
    s_nop 0
    buffer_load_dwordx4 v6, s[40:43], s29 offen lds
    buffer_load_dwordx4 v7, s[40:43], s29 offen offset:1024 lds
    s_add_u32 s29, s29, 196608
    s_cmp_lg_u32 s3, 0
    s_cbranch_scc1 g1_q_np
    v_and_b32 v10, 31, v9
    v_lshlrev_b32 v10, 7, v10
    s_lshl_b32 s16, s24, 12
    s_add_u32 s16, s16, 0x2f00000
    s_mov_b32 s17, 0x40000
g1_q_pl_l:
    buffer_load_dword v12, v10, s[36:39], s16 offen sc0 sc1
    s_waitcnt vmcnt(0)
    v_xor_b32 v12, s4, v12
    v_cmp_ne_u32 vcc, 0, v12
    s_sub_u32 s17, s17, 1
    s_cselect_b64 vcc, 0, vcc
    s_nop 3
    s_cbranch_vccz g1_q_pl_d
    s_sleep 2
    s_branch g1_q_pl_l
g1_q_pl_d:
g1_q_np:
    s_barrier
    s_mov_b32 s27, 0
    s_add_u32 m0, s27, s30
    s_nop 0
    buffer_load_dwordx4 v5, s[36:39], s28 offen offset:0 sc1 lds
    buffer_load_dwordx4 v5, s[36:39], s28 offen offset:1024 sc1 lds
    s_add_u32 s28, s28, 16384
    s_barrier
    s_mov_b32 s27, 32768
    s_add_u32 m0, s27, s30
    s_nop 0
    buffer_load_dwordx4 v5, s[36:39], s28 offen offset:0 sc1 lds
    buffer_load_dwordx4 v5, s[36:39], s28 offen offset:1024 sc1 lds
    s_add_u32 s28, s28, 16384
    s_mov_b32 s27, 65536
    s_add_u32 m0, s27, s30
    s_nop 0
    buffer_load_dwordx4 v5, s[36:39], s28 offen offset:0 sc1 lds
    buffer_load_dwordx4 v5, s[36:39], s28 offen offset:1024 sc1 lds
    s_add_u32 s28, s28, 16384
    s_waitcnt vmcnt(4)
    s_barrier
    ds_read_b64_tr_b16 v[48:49], v4 offset:16384
    ds_read_b64_tr_b16 v[50:51], v4 offset:20480
    ds_read_b128 v[16:19], v3 offset:0
    ds_read_b128 v[20:23], v3 offset:1024
    ds_read_b128 v[24:27], v3 offset:2048
    ds_read_b128 v[28:31], v3 offset:3072
    ds_read_b64_tr_b16 v[52:53], v4 offset:16416
    ds_read_b64_tr_b16 v[54:55], v4 offset:20512
    ds_read_b64_tr_b16 v[56:57], v4 offset:16448
    ds_read_b64_tr_b16 v[58:59], v4 offset:20544
    ds_read_b64_tr_b16 v[60:61], v4 offset:16480
    ds_read_b64_tr_b16 v[62:63], v4 offset:20576
    ds_read_b64_tr_b16 v[64:65], v4 offset:16512
    ds_read_b64_tr_b16 v[66:67], v4 offset:20608
    ds_read_b64_tr_b16 v[68:69], v4 offset:16544
    ds_read_b64_tr_b16 v[70:71], v4 offset:20640
    s_mov_b32 s27, s26
    s_add_u32 s26, s26, 32768
    s_cmp_eq_u32 s26, 163840
    s_cselect_b32 s26, 0, s26
    v_add_u32 v3, s26, v1
    v_add_u32 v4, s26, v2
    s_waitcnt vmcnt(2) lgkmcnt(0)
    s_barrier
    v_mfma_f32_16x16x32_bf16 v[104:107], v[48:51], v[16:19], v[104:107]
    ds_read_b64_tr_b16 v[76:77], v4 offset:16384
    s_mov_b32 s27, 98304
    s_add_u32 m0, s27, s30
    v_mfma_f32_16x16x32_bf16 v[108:111], v[48:51], v[20:23], v[108:111]
    ds_read_b64_tr_b16 v[78:79], v4 offset:20480
    buffer_load_dwordx4 v5, s[36:39], s28 offen offset:0 sc1 lds
    v_mfma_f32_16x16x32_bf16 v[112:115], v[48:51], v[24:27], v[112:115]
    ds_read_b128 v[32:35], v3 offset:0
    v_mfma_f32_16x16x32_bf16 v[116:119], v[48:51], v[28:31], v[116:119]
    ds_read_b128 v[36:39], v3 offset:1024
    buffer_load_dwordx4 v5, s[36:39], s28 offen offset:1024 sc1 lds
    v_mfma_f32_16x16x32_bf16 v[120:123], v[52:55], v[16:19], v[120:123]
    ds_read_b128 v[40:43], v3 offset:2048
    s_add_u32 s28, s28, 16384
    s_mov_b32 s27, 131072
    s_add_u32 m0, s27, s30
    v_mfma_f32_16x16x32_bf16 v[124:127], v[52:55], v[20:23], v[124:127]
    ds_read_b128 v[44:47], v3 offset:3072
    buffer_load_dwordx4 v5, s[36:39], s28 offen offset:0 sc1 lds
    v_mfma_f32_16x16x32_bf16 v[128:131], v[52:55], v[24:27], v[128:131]
    ds_read_b64_tr_b16 v[80:81], v4 offset:16416
    v_mfma_f32_16x16x32_bf16 v[132:135], v[52:55], v[28:31], v[132:135]
    ds_read_b64_tr_b16 v[82:83], v4 offset:20512
    buffer_load_dwordx4 v5, s[36:39], s28 offen offset:1024 sc1 lds
    v_mfma_f32_16x16x32_bf16 v[136:139], v[56:59], v[16:19], v[136:139]
    ds_read_b64_tr_b16 v[84:85], v4 offset:16448
    s_add_u32 s28, s28, 16384
    s_mov_b32 s27, 0
    s_add_u32 m0, s27, s30
    v_mfma_f32_16x16x32_bf16 v[140:143], v[56:59], v[20:23], v[140:143]
    ds_read_b64_tr_b16 v[86:87], v4 offset:20544
    buffer_load_dwordx4 v5, s[36:39], s28 offen offset:0 sc1 lds
    v_mfma_f32_16x16x32_bf16 v[144:147], v[56:59], v[24:27], v[144:147]
    ds_read_b64_tr_b16 v[88:89], v4 offset:16480
    v_mfma_f32_16x16x32_bf16 v[148:151], v[56:59], v[28:31], v[148:151]
    ds_read_b64_tr_b16 v[90:91], v4 offset:20576
    buffer_load_dwordx4 v5, s[36:39], s28 offen offset:1024 sc1 lds
    v_mfma_f32_16x16x32_bf16 v[152:155], v[60:63], v[16:19], v[152:155]
    ds_read_b64_tr_b16 v[92:93], v4 offset:16512
    s_add_u32 s28, s28, 16384
    s_add_u32 m0, s27, s31
    v_mfma_f32_16x16x32_bf16 v[156:159], v[60:63], v[20:23], v[156:159]
    ds_read_b64_tr_b16 v[94:95], v4 offset:20608
    buffer_load_dwordx4 v6, s[40:43], s29 offen lds
    v_mfma_f32_16x16x32_bf16 v[160:163], v[60:63], v[24:27], v[160:163]
    ds_read_b64_tr_b16 v[96:97], v4 offset:16544
    v_mfma_f32_16x16x32_bf16 v[164:167], v[60:63], v[28:31], v[164:167]
    ds_read_b64_tr_b16 v[98:99], v4 offset:20640
    buffer_load_dwordx4 v7, s[40:43], s29 offen offset:1024 lds
    v_mfma_f32_16x16x32_bf16 v[168:171], v[16:19], v[64:67], v[168:171]
    s_add_u32 s29, s29, 196608
    v_mfma_f32_16x16x32_bf16 v[172:175], v[20:23], v[64:67], v[172:175]
    v_mfma_f32_16x16x32_bf16 v[176:179], v[24:27], v[64:67], v[176:179]
    s_mov_b32 s27, s26
    s_add_u32 s26, s26, 32768
    v_mfma_f32_16x16x32_bf16 v[180:183], v[28:31], v[64:67], v[180:183]
    s_cmp_eq_u32 s26, 163840
    s_cselect_b32 s26, 0, s26
    v_mfma_f32_16x16x32_bf16 v[184:187], v[16:19], v[68:71], v[184:187]
    v_add_u32 v3, s26, v1
    v_add_u32 v4, s26, v2
    v_mfma_f32_16x16x32_bf16 v[188:191], v[20:23], v[68:71], v[188:191]
    v_mfma_f32_16x16x32_bf16 v[192:195], v[24:27], v[68:71], v[192:195]
    v_mfma_f32_16x16x32_bf16 v[196:199], v[28:31], v[68:71], v[196:199]
    s_waitcnt vmcnt(8) lgkmcnt(0)
    s_barrier
    v_mfma_f32_16x16x32_bf16 v[104:107], v[76:79], v[32:35], v[104:107]
    ds_read_b64_tr_b16 v[48:49], v4 offset:16384
    v_mfma_f32_16x16x32_bf16 v[108:111], v[76:79], v[36:39], v[108:111]
    ds_read_b64_tr_b16 v[50:51], v4 offset:20480
    s_mov_b32 s27, 32768
    s_add_u32 m0, s27, s30
    v_mfma_f32_16x16x32_bf16 v[112:115], v[76:79], v[40:43], v[112:115]
    ds_read_b128 v[16:19], v3 offset:0
    buffer_load_dwordx4 v5, s[36:39], s28 offen offset:0 sc1 lds
    v_mfma_f32_16x16x32_bf16 v[116:119], v[76:79], v[44:47], v[116:119]
    ds_read_b128 v[20:23], v3 offset:1024
    v_mfma_f32_16x16x32_bf16 v[120:123], v[80:83], v[32:35], v[120:123]
    ds_read_b128 v[24:27], v3 offset:2048
    v_mfma_f32_16x16x32_bf16 v[124:127], v[80:83], v[36:39], v[124:127]
    ds_read_b128 v[28:31], v3 offset:3072
    v_mfma_f32_16x16x32_bf16 v[128:131], v[80:83], v[40:43], v[128:131]
    ds_read_b64_tr_b16 v[52:53], v4 offset:16416
    v_mfma_f32_16x16x32_bf16 v[132:135], v[80:83], v[44:47], v[132:135]
    ds_read_b64_tr_b16 v[54:55], v4 offset:20512
    buffer_load_dwordx4 v5, s[36:39], s28 offen offset:1024 sc1 lds
    v_mfma_f32_16x16x32_bf16 v[136:139], v[84:87], v[32:35], v[136:139]
    ds_read_b64_tr_b16 v[56:57], v4 offset:16448
    s_add_u32 s28, s28, 16384
    v_mfma_f32_16x16x32_bf16 v[140:143], v[84:87], v[36:39], v[140:143]
    ds_read_b64_tr_b16 v[58:59], v4 offset:20544
    v_mfma_f32_16x16x32_bf16 v[144:147], v[84:87], v[40:43], v[144:147]
    ds_read_b64_tr_b16 v[60:61], v4 offset:16480
    v_mfma_f32_16x16x32_bf16 v[148:151], v[84:87], v[44:47], v[148:151]
    ds_read_b64_tr_b16 v[62:63], v4 offset:20576
    s_add_u32 m0, s27, s31
    v_mfma_f32_16x16x32_bf16 v[152:155], v[88:91], v[32:35], v[152:155]
    ds_read_b64_tr_b16 v[64:65], v4 offset:16512
    buffer_load_dwordx4 v6, s[40:43], s29 offen lds
    v_mfma_f32_16x16x32_bf16 v[156:159], v[88:91], v[36:39], v[156:159]
    ds_read_b64_tr_b16 v[66:67], v4 offset:20608
    v_mfma_f32_16x16x32_bf16 v[160:163], v[88:91], v[40:43], v[160:163]
    ds_read_b64_tr_b16 v[68:69], v4 offset:16544
    v_mfma_f32_16x16x32_bf16 v[164:167], v[88:91], v[44:47], v[164:167]
    ds_read_b64_tr_b16 v[70:71], v4 offset:20640
    v_mfma_f32_16x16x32_bf16 v[168:171], v[32:35], v[92:95], v[168:171]
    v_mfma_f32_16x16x32_bf16 v[172:175], v[36:39], v[92:95], v[172:175]
    buffer_load_dwordx4 v7, s[40:43], s29 offen offset:1024 lds
    v_mfma_f32_16x16x32_bf16 v[176:179], v[40:43], v[92:95], v[176:179]
    s_add_u32 s29, s29, 196608
    s_mov_b32 s27, s26
    s_add_u32 s26, s26, 32768
    v_mfma_f32_16x16x32_bf16 v[180:183], v[44:47], v[92:95], v[180:183]
    s_cmp_eq_u32 s26, 163840
    s_cselect_b32 s26, 0, s26
    v_mfma_f32_16x16x32_bf16 v[184:187], v[32:35], v[96:99], v[184:187]
    v_add_u32 v3, s26, v1
    v_add_u32 v4, s26, v2
    v_mfma_f32_16x16x32_bf16 v[188:191], v[36:39], v[96:99], v[188:191]
    v_mfma_f32_16x16x32_bf16 v[192:195], v[40:43], v[96:99], v[192:195]
    v_mfma_f32_16x16x32_bf16 v[196:199], v[44:47], v[96:99], v[196:199]
    s_waitcnt vmcnt(10) lgkmcnt(0)
    s_barrier
    v_mfma_f32_16x16x32_bf16 v[104:107], v[48:51], v[16:19], v[104:107]
    ds_read_b64_tr_b16 v[76:77], v4 offset:16384
    v_mfma_f32_16x16x32_bf16 v[108:111], v[48:51], v[20:23], v[108:111]
    ds_read_b64_tr_b16 v[78:79], v4 offset:20480
    s_mov_b32 s27, 65536
    s_add_u32 m0, s27, s30
    v_mfma_f32_16x16x32_bf16 v[112:115], v[48:51], v[24:27], v[112:115]
    ds_read_b128 v[32:35], v3 offset:0
    buffer_load_dwordx4 v5, s[36:39], s28 offen offset:0 sc1 lds
    v_mfma_f32_16x16x32_bf16 v[116:119], v[48:51], v[28:31], v[116:119]
    ds_read_b128 v[36:39], v3 offset:1024
    v_mfma_f32_16x16x32_bf16 v[120:123], v[52:55], v[16:19], v[120:123]
    ds_read_b128 v[40:43], v3 offset:2048
    v_mfma_f32_16x16x32_bf16 v[124:127], v[52:55], v[20:23], v[124:127]
    ds_read_b128 v[44:47], v3 offset:3072
    v_mfma_f32_16x16x32_bf16 v[128:131], v[52:55], v[24:27], v[128:131]
    ds_read_b64_tr_b16 v[80:81], v4 offset:16416
    v_mfma_f32_16x16x32_bf16 v[132:135], v[52:55], v[28:31], v[132:135]
    ds_read_b64_tr_b16 v[82:83], v4 offset:20512
    buffer_load_dwordx4 v5, s[36:39], s28 offen offset:1024 sc1 lds
    v_mfma_f32_16x16x32_bf16 v[136:139], v[56:59], v[16:19], v[136:139]
    ds_read_b64_tr_b16 v[84:85], v4 offset:16448
    s_add_u32 s28, s28, 16384
    v_mfma_f32_16x16x32_bf16 v[140:143], v[56:59], v[20:23], v[140:143]
    ds_read_b64_tr_b16 v[86:87], v4 offset:20544
    v_mfma_f32_16x16x32_bf16 v[144:147], v[56:59], v[24:27], v[144:147]
    ds_read_b64_tr_b16 v[88:89], v4 offset:16480
    v_mfma_f32_16x16x32_bf16 v[148:151], v[56:59], v[28:31], v[148:151]
    ds_read_b64_tr_b16 v[90:91], v4 offset:20576
    s_add_u32 m0, s27, s31
    v_mfma_f32_16x16x32_bf16 v[152:155], v[60:63], v[16:19], v[152:155]
    ds_read_b64_tr_b16 v[92:93], v4 offset:16512
    buffer_load_dwordx4 v6, s[40:43], s29 offen lds
    v_mfma_f32_16x16x32_bf16 v[156:159], v[60:63], v[20:23], v[156:159]
    ds_read_b64_tr_b16 v[94:95], v4 offset:20608
    v_mfma_f32_16x16x32_bf16 v[160:163], v[60:63], v[24:27], v[160:163]
    ds_read_b64_tr_b16 v[96:97], v4 offset:16544
    v_mfma_f32_16x16x32_bf16 v[164:167], v[60:63], v[28:31], v[164:167]
    ds_read_b64_tr_b16 v[98:99], v4 offset:20640
    v_mfma_f32_16x16x32_bf16 v[168:171], v[16:19], v[64:67], v[168:171]
    v_mfma_f32_16x16x32_bf16 v[172:175], v[20:23], v[64:67], v[172:175]
    buffer_load_dwordx4 v7, s[40:43], s29 offen offset:1024 lds
    v_mfma_f32_16x16x32_bf16 v[176:179], v[24:27], v[64:67], v[176:179]
    s_add_u32 s29, s29, 196608
    s_mov_b32 s27, s26
    s_add_u32 s26, s26, 32768
    v_mfma_f32_16x16x32_bf16 v[180:183], v[28:31], v[64:67], v[180:183]
    s_cmp_eq_u32 s26, 163840
    s_cselect_b32 s26, 0, s26
    v_mfma_f32_16x16x32_bf16 v[184:187], v[16:19], v[68:71], v[184:187]
    v_add_u32 v3, s26, v1
    v_add_u32 v4, s26, v2
    v_mfma_f32_16x16x32_bf16 v[188:191], v[20:23], v[68:71], v[188:191]
    v_mfma_f32_16x16x32_bf16 v[192:195], v[24:27], v[68:71], v[192:195]
    v_mfma_f32_16x16x32_bf16 v[196:199], v[28:31], v[68:71], v[196:199]
    s_waitcnt vmcnt(12) lgkmcnt(0)
    s_barrier
    v_mfma_f32_16x16x32_bf16 v[104:107], v[76:79], v[32:35], v[104:107]
    ds_read_b64_tr_b16 v[48:49], v4 offset:16384
    v_mfma_f32_16x16x32_bf16 v[108:111], v[76:79], v[36:39], v[108:111]
    ds_read_b64_tr_b16 v[50:51], v4 offset:20480
    s_mov_b32 s27, 98304
    s_add_u32 m0, s27, s30
    v_mfma_f32_16x16x32_bf16 v[112:115], v[76:79], v[40:43], v[112:115]
    ds_read_b128 v[16:19], v3 offset:0
    buffer_load_dwordx4 v5, s[36:39], s28 offen offset:0 sc1 lds
    v_mfma_f32_16x16x32_bf16 v[116:119], v[76:79], v[44:47], v[116:119]
    ds_read_b128 v[20:23], v3 offset:1024
    v_mfma_f32_16x16x32_bf16 v[120:123], v[80:83], v[32:35], v[120:123]
    ds_read_b128 v[24:27], v3 offset:2048
    v_mfma_f32_16x16x32_bf16 v[124:127], v[80:83], v[36:39], v[124:127]
    ds_read_b128 v[28:31], v3 offset:3072
    v_mfma_f32_16x16x32_bf16 v[128:131], v[80:83], v[40:43], v[128:131]
    ds_read_b64_tr_b16 v[52:53], v4 offset:16416
    v_mfma_f32_16x16x32_bf16 v[132:135], v[80:83], v[44:47], v[132:135]
    ds_read_b64_tr_b16 v[54:55], v4 offset:20512
    buffer_load_dwordx4 v5, s[36:39], s28 offen offset:1024 sc1 lds
    v_mfma_f32_16x16x32_bf16 v[136:139], v[84:87], v[32:35], v[136:139]
    ds_read_b64_tr_b16 v[56:57], v4 offset:16448
    s_add_u32 s28, s28, 16384
    v_mfma_f32_16x16x32_bf16 v[140:143], v[84:87], v[36:39], v[140:143]
    ds_read_b64_tr_b16 v[58:59], v4 offset:20544
    v_mfma_f32_16x16x32_bf16 v[144:147], v[84:87], v[40:43], v[144:147]
    ds_read_b64_tr_b16 v[60:61], v4 offset:16480
    v_mfma_f32_16x16x32_bf16 v[148:151], v[84:87], v[44:47], v[148:151]
    ds_read_b64_tr_b16 v[62:63], v4 offset:20576
    s_add_u32 m0, s27, s31
    v_mfma_f32_16x16x32_bf16 v[152:155], v[88:91], v[32:35], v[152:155]
    ds_read_b64_tr_b16 v[64:65], v4 offset:16512
    buffer_load_dwordx4 v6, s[40:43], s29 offen lds
    v_mfma_f32_16x16x32_bf16 v[156:159], v[88:91], v[36:39], v[156:159]
    ds_read_b64_tr_b16 v[66:67], v4 offset:20608
    v_mfma_f32_16x16x32_bf16 v[160:163], v[88:91], v[40:43], v[160:163]
    ds_read_b64_tr_b16 v[68:69], v4 offset:16544
    v_mfma_f32_16x16x32_bf16 v[164:167], v[88:91], v[44:47], v[164:167]
    ds_read_b64_tr_b16 v[70:71], v4 offset:20640
    v_mfma_f32_16x16x32_bf16 v[168:171], v[32:35], v[92:95], v[168:171]
    v_mfma_f32_16x16x32_bf16 v[172:175], v[36:39], v[92:95], v[172:175]
    buffer_load_dwordx4 v7, s[40:43], s29 offen offset:1024 lds
    v_mfma_f32_16x16x32_bf16 v[176:179], v[40:43], v[92:95], v[176:179]
    s_add_u32 s29, s29, 196608
    s_mov_b32 s27, s26
    s_add_u32 s26, s26, 32768
    v_mfma_f32_16x16x32_bf16 v[180:183], v[44:47], v[92:95], v[180:183]
    s_cmp_eq_u32 s26, 163840
    s_cselect_b32 s26, 0, s26
    v_mfma_f32_16x16x32_bf16 v[184:187], v[32:35], v[96:99], v[184:187]
    v_add_u32 v3, s26, v1
    v_add_u32 v4, s26, v2
    v_mfma_f32_16x16x32_bf16 v[188:191], v[36:39], v[96:99], v[188:191]
    v_mfma_f32_16x16x32_bf16 v[192:195], v[40:43], v[96:99], v[192:195]
    v_mfma_f32_16x16x32_bf16 v[196:199], v[44:47], v[96:99], v[196:199]
    s_waitcnt vmcnt(12) lgkmcnt(0)
    s_barrier
    s_mov_b32 s32, 11
.p2align 3
g1_q_loop:
    v_mfma_f32_16x16x32_bf16 v[104:107], v[48:51], v[16:19], v[104:107]
    ds_read_b64_tr_b16 v[76:77], v4 offset:16384
    v_mfma_f32_16x16x32_bf16 v[108:111], v[48:51], v[20:23], v[108:111]
    ds_read_b64_tr_b16 v[78:79], v4 offset:20480
    s_add_u32 m0, s27, s30
    v_mfma_f32_16x16x32_bf16 v[112:115], v[48:51], v[24:27], v[112:115]
    ds_read_b128 v[32:35], v3 offset:0
    buffer_load_dwordx4 v5, s[36:39], s28 offen offset:0 sc1 lds
    v_mfma_f32_16x16x32_bf16 v[116:119], v[48:51], v[28:31], v[116:119]
    ds_read_b128 v[36:39], v3 offset:1024
    v_mfma_f32_16x16x32_bf16 v[120:123], v[52:55], v[16:19], v[120:123]
    ds_read_b128 v[40:43], v3 offset:2048
    v_mfma_f32_16x16x32_bf16 v[124:127], v[52:55], v[20:23], v[124:127]
    ds_read_b128 v[44:47], v3 offset:3072
    v_mfma_f32_16x16x32_bf16 v[128:131], v[52:55], v[24:27], v[128:131]
    ds_read_b64_tr_b16 v[80:81], v4 offset:16416
    v_mfma_f32_16x16x32_bf16 v[132:135], v[52:55], v[28:31], v[132:135]
    ds_read_b64_tr_b16 v[82:83], v4 offset:20512
    buffer_load_dwordx4 v5, s[36:39], s28 offen offset:1024 sc1 lds
    v_mfma_f32_16x16x32_bf16 v[136:139], v[56:59], v[16:19], v[136:139]
    ds_read_b64_tr_b16 v[84:85], v4 offset:16448
    s_add_u32 s28, s28, 16384
    v_mfma_f32_16x16x32_bf16 v[140:143], v[56:59], v[20:23], v[140:143]
    ds_read_b64_tr_b16 v[86:87], v4 offset:20544
    v_mfma_f32_16x16x32_bf16 v[144:147], v[56:59], v[24:27], v[144:147]
    ds_read_b64_tr_b16 v[88:89], v4 offset:16480
    v_mfma_f32_16x16x32_bf16 v[148:151], v[56:59], v[28:31], v[148:151]
    ds_read_b64_tr_b16 v[90:91], v4 offset:20576
    s_add_u32 m0, s27, s31
    v_mfma_f32_16x16x32_bf16 v[152:155], v[60:63], v[16:19], v[152:155]
    ds_read_b64_tr_b16 v[92:93], v4 offset:16512
    buffer_load_dwordx4 v6, s[40:43], s29 offen lds
    v_mfma_f32_16x16x32_bf16 v[156:159], v[60:63], v[20:23], v[156:159]
    ds_read_b64_tr_b16 v[94:95], v4 offset:20608
    v_mfma_f32_16x16x32_bf16 v[160:163], v[60:63], v[24:27], v[160:163]
    ds_read_b64_tr_b16 v[96:97], v4 offset:16544
    v_mfma_f32_16x16x32_bf16 v[164:167], v[60:63], v[28:31], v[164:167]
    ds_read_b64_tr_b16 v[98:99], v4 offset:20640
    v_mfma_f32_16x16x32_bf16 v[168:171], v[16:19], v[64:67], v[168:171]
    v_mfma_f32_16x16x32_bf16 v[172:175], v[20:23], v[64:67], v[172:175]
    buffer_load_dwordx4 v7, s[40:43], s29 offen offset:1024 lds
    v_mfma_f32_16x16x32_bf16 v[176:179], v[24:27], v[64:67], v[176:179]
    s_add_u32 s29, s29, 196608
    s_mov_b32 s27, s26
    s_add_u32 s26, s26, 32768
    v_mfma_f32_16x16x32_bf16 v[180:183], v[28:31], v[64:67], v[180:183]
    s_cmp_eq_u32 s26, 163840
    s_cselect_b32 s26, 0, s26
    v_mfma_f32_16x16x32_bf16 v[184:187], v[16:19], v[68:71], v[184:187]
    v_add_u32 v3, s26, v1
    v_add_u32 v4, s26, v2
    v_mfma_f32_16x16x32_bf16 v[188:191], v[20:23], v[68:71], v[188:191]
    v_mfma_f32_16x16x32_bf16 v[192:195], v[24:27], v[68:71], v[192:195]
    v_mfma_f32_16x16x32_bf16 v[196:199], v[28:31], v[68:71], v[196:199]
    s_waitcnt vmcnt(12) lgkmcnt(0)
    s_barrier
    v_mfma_f32_16x16x32_bf16 v[104:107], v[76:79], v[32:35], v[104:107]
    ds_read_b64_tr_b16 v[48:49], v4 offset:16384
    v_mfma_f32_16x16x32_bf16 v[108:111], v[76:79], v[36:39], v[108:111]
    ds_read_b64_tr_b16 v[50:51], v4 offset:20480
    s_add_u32 m0, s27, s30
    v_mfma_f32_16x16x32_bf16 v[112:115], v[76:79], v[40:43], v[112:115]
    ds_read_b128 v[16:19], v3 offset:0
    buffer_load_dwordx4 v5, s[36:39], s28 offen offset:0 sc1 lds
    v_mfma_f32_16x16x32_bf16 v[116:119], v[76:79], v[44:47], v[116:119]
    ds_read_b128 v[20:23], v3 offset:1024
    v_mfma_f32_16x16x32_bf16 v[120:123], v[80:83], v[32:35], v[120:123]
    ds_read_b128 v[24:27], v3 offset:2048
    v_mfma_f32_16x16x32_bf16 v[124:127], v[80:83], v[36:39], v[124:127]
    ds_read_b128 v[28:31], v3 offset:3072
    v_mfma_f32_16x16x32_bf16 v[128:131], v[80:83], v[40:43], v[128:131]
    ds_read_b64_tr_b16 v[52:53], v4 offset:16416
    v_mfma_f32_16x16x32_bf16 v[132:135], v[80:83], v[44:47], v[132:135]
    ds_read_b64_tr_b16 v[54:55], v4 offset:20512
    buffer_load_dwordx4 v5, s[36:39], s28 offen offset:1024 sc1 lds
    v_mfma_f32_16x16x32_bf16 v[136:139], v[84:87], v[32:35], v[136:139]
    ds_read_b64_tr_b16 v[56:57], v4 offset:16448
    s_add_u32 s28, s28, 16384
    v_mfma_f32_16x16x32_bf16 v[140:143], v[84:87], v[36:39], v[140:143]
    ds_read_b64_tr_b16 v[58:59], v4 offset:20544
    v_mfma_f32_16x16x32_bf16 v[144:147], v[84:87], v[40:43], v[144:147]
    ds_read_b64_tr_b16 v[60:61], v4 offset:16480
    v_mfma_f32_16x16x32_bf16 v[148:151], v[84:87], v[44:47], v[148:151]
    ds_read_b64_tr_b16 v[62:63], v4 offset:20576
    s_add_u32 m0, s27, s31
    v_mfma_f32_16x16x32_bf16 v[152:155], v[88:91], v[32:35], v[152:155]
    ds_read_b64_tr_b16 v[64:65], v4 offset:16512
    buffer_load_dwordx4 v6, s[40:43], s29 offen lds
    v_mfma_f32_16x16x32_bf16 v[156:159], v[88:91], v[36:39], v[156:159]
    ds_read_b64_tr_b16 v[66:67], v4 offset:20608
    v_mfma_f32_16x16x32_bf16 v[160:163], v[88:91], v[40:43], v[160:163]
    ds_read_b64_tr_b16 v[68:69], v4 offset:16544
    v_mfma_f32_16x16x32_bf16 v[164:167], v[88:91], v[44:47], v[164:167]
    ds_read_b64_tr_b16 v[70:71], v4 offset:20640
    v_mfma_f32_16x16x32_bf16 v[168:171], v[32:35], v[92:95], v[168:171]
    v_mfma_f32_16x16x32_bf16 v[172:175], v[36:39], v[92:95], v[172:175]
    buffer_load_dwordx4 v7, s[40:43], s29 offen offset:1024 lds
    v_mfma_f32_16x16x32_bf16 v[176:179], v[40:43], v[92:95], v[176:179]
    s_add_u32 s29, s29, 196608
    s_mov_b32 s27, s26
    s_add_u32 s26, s26, 32768
    v_mfma_f32_16x16x32_bf16 v[180:183], v[44:47], v[92:95], v[180:183]
    s_cmp_eq_u32 s26, 163840
    s_cselect_b32 s26, 0, s26
    v_mfma_f32_16x16x32_bf16 v[184:187], v[32:35], v[96:99], v[184:187]
    v_add_u32 v3, s26, v1
    v_add_u32 v4, s26, v2
    v_mfma_f32_16x16x32_bf16 v[188:191], v[36:39], v[96:99], v[188:191]
    v_mfma_f32_16x16x32_bf16 v[192:195], v[40:43], v[96:99], v[192:195]
    v_mfma_f32_16x16x32_bf16 v[196:199], v[44:47], v[96:99], v[196:199]
    s_waitcnt vmcnt(12) lgkmcnt(0)
    s_barrier
    s_sub_u32 s32, s32, 1
    s_cmp_lg_u32 s32, 0
    s_cbranch_scc1 g1_q_loop
    v_mfma_f32_16x16x32_bf16 v[104:107], v[48:51], v[16:19], v[104:107]
    ds_read_b64_tr_b16 v[76:77], v4 offset:16384
    v_mfma_f32_16x16x32_bf16 v[108:111], v[48:51], v[20:23], v[108:111]
    ds_read_b64_tr_b16 v[78:79], v4 offset:20480
    s_add_u32 m0, s27, s30
    v_mfma_f32_16x16x32_bf16 v[112:115], v[48:51], v[24:27], v[112:115]
    ds_read_b128 v[32:35], v3 offset:0
    buffer_load_dwordx4 v5, s[36:39], s28 offen offset:0 sc1 lds
    v_mfma_f32_16x16x32_bf16 v[116:119], v[48:51], v[28:31], v[116:119]
    ds_read_b128 v[36:39], v3 offset:1024
    v_mfma_f32_16x16x32_bf16 v[120:123], v[52:55], v[16:19], v[120:123]
    ds_read_b128 v[40:43], v3 offset:2048
    v_mfma_f32_16x16x32_bf16 v[124:127], v[52:55], v[20:23], v[124:127]
    ds_read_b128 v[44:47], v3 offset:3072
    v_mfma_f32_16x16x32_bf16 v[128:131], v[52:55], v[24:27], v[128:131]
    ds_read_b64_tr_b16 v[80:81], v4 offset:16416
    v_mfma_f32_16x16x32_bf16 v[132:135], v[52:55], v[28:31], v[132:135]
    ds_read_b64_tr_b16 v[82:83], v4 offset:20512
    buffer_load_dwordx4 v5, s[36:39], s28 offen offset:1024 sc1 lds
    v_mfma_f32_16x16x32_bf16 v[136:139], v[56:59], v[16:19], v[136:139]
    ds_read_b64_tr_b16 v[84:85], v4 offset:16448
    s_add_u32 s28, s28, 16384
    v_mfma_f32_16x16x32_bf16 v[140:143], v[56:59], v[20:23], v[140:143]
    ds_read_b64_tr_b16 v[86:87], v4 offset:20544
    v_mfma_f32_16x16x32_bf16 v[144:147], v[56:59], v[24:27], v[144:147]
    ds_read_b64_tr_b16 v[88:89], v4 offset:16480
    v_mfma_f32_16x16x32_bf16 v[148:151], v[56:59], v[28:31], v[148:151]
    ds_read_b64_tr_b16 v[90:91], v4 offset:20576
    s_add_u32 m0, s27, s31
    v_mfma_f32_16x16x32_bf16 v[152:155], v[60:63], v[16:19], v[152:155]
    ds_read_b64_tr_b16 v[92:93], v4 offset:16512
    buffer_load_dwordx4 v6, s[40:43], s29 offen lds
    v_mfma_f32_16x16x32_bf16 v[156:159], v[60:63], v[20:23], v[156:159]
    ds_read_b64_tr_b16 v[94:95], v4 offset:20608
    v_mfma_f32_16x16x32_bf16 v[160:163], v[60:63], v[24:27], v[160:163]
    ds_read_b64_tr_b16 v[96:97], v4 offset:16544
    v_mfma_f32_16x16x32_bf16 v[164:167], v[60:63], v[28:31], v[164:167]
    ds_read_b64_tr_b16 v[98:99], v4 offset:20640
    v_mfma_f32_16x16x32_bf16 v[168:171], v[16:19], v[64:67], v[168:171]
    v_mfma_f32_16x16x32_bf16 v[172:175], v[20:23], v[64:67], v[172:175]
    buffer_load_dwordx4 v7, s[40:43], s29 offen offset:1024 lds
    v_mfma_f32_16x16x32_bf16 v[176:179], v[24:27], v[64:67], v[176:179]
    s_add_u32 s29, s29, 196608
    s_mov_b32 s27, s26
    s_add_u32 s26, s26, 32768
    v_mfma_f32_16x16x32_bf16 v[180:183], v[28:31], v[64:67], v[180:183]
    s_cmp_eq_u32 s26, 163840
    s_cselect_b32 s26, 0, s26
    v_mfma_f32_16x16x32_bf16 v[184:187], v[16:19], v[68:71], v[184:187]
    v_add_u32 v3, s26, v1
    v_add_u32 v4, s26, v2
    v_mfma_f32_16x16x32_bf16 v[188:191], v[20:23], v[68:71], v[188:191]
    v_mfma_f32_16x16x32_bf16 v[192:195], v[24:27], v[68:71], v[192:195]
    v_mfma_f32_16x16x32_bf16 v[196:199], v[28:31], v[68:71], v[196:199]
    s_waitcnt vmcnt(12) lgkmcnt(0)
    s_barrier
    v_mfma_f32_16x16x32_bf16 v[104:107], v[76:79], v[32:35], v[104:107]
    ds_read_b64_tr_b16 v[48:49], v4 offset:16384
    v_mfma_f32_16x16x32_bf16 v[108:111], v[76:79], v[36:39], v[108:111]
    ds_read_b64_tr_b16 v[50:51], v4 offset:20480
    v_mfma_f32_16x16x32_bf16 v[112:115], v[76:79], v[40:43], v[112:115]
    ds_read_b128 v[16:19], v3 offset:0
    v_mfma_f32_16x16x32_bf16 v[116:119], v[76:79], v[44:47], v[116:119]
    ds_read_b128 v[20:23], v3 offset:1024
    v_mfma_f32_16x16x32_bf16 v[120:123], v[80:83], v[32:35], v[120:123]
    ds_read_b128 v[24:27], v3 offset:2048
    v_mfma_f32_16x16x32_bf16 v[124:127], v[80:83], v[36:39], v[124:127]
    ds_read_b128 v[28:31], v3 offset:3072
    v_mfma_f32_16x16x32_bf16 v[128:131], v[80:83], v[40:43], v[128:131]
    ds_read_b64_tr_b16 v[52:53], v4 offset:16416
    v_mfma_f32_16x16x32_bf16 v[132:135], v[80:83], v[44:47], v[132:135]
    ds_read_b64_tr_b16 v[54:55], v4 offset:20512
    v_mfma_f32_16x16x32_bf16 v[136:139], v[84:87], v[32:35], v[136:139]
    ds_read_b64_tr_b16 v[56:57], v4 offset:16448
    v_mfma_f32_16x16x32_bf16 v[140:143], v[84:87], v[36:39], v[140:143]
    ds_read_b64_tr_b16 v[58:59], v4 offset:20544
    v_mfma_f32_16x16x32_bf16 v[144:147], v[84:87], v[40:43], v[144:147]
    ds_read_b64_tr_b16 v[60:61], v4 offset:16480
    v_mfma_f32_16x16x32_bf16 v[148:151], v[84:87], v[44:47], v[148:151]
    ds_read_b64_tr_b16 v[62:63], v4 offset:20576
    v_mfma_f32_16x16x32_bf16 v[152:155], v[88:91], v[32:35], v[152:155]
    ds_read_b64_tr_b16 v[64:65], v4 offset:16512
    v_mfma_f32_16x16x32_bf16 v[156:159], v[88:91], v[36:39], v[156:159]
    ds_read_b64_tr_b16 v[66:67], v4 offset:20608
    v_mfma_f32_16x16x32_bf16 v[160:163], v[88:91], v[40:43], v[160:163]
    ds_read_b64_tr_b16 v[68:69], v4 offset:16544
    v_mfma_f32_16x16x32_bf16 v[164:167], v[88:91], v[44:47], v[164:167]
    ds_read_b64_tr_b16 v[70:71], v4 offset:20640
    v_mfma_f32_16x16x32_bf16 v[168:171], v[32:35], v[92:95], v[168:171]
    v_mfma_f32_16x16x32_bf16 v[172:175], v[36:39], v[92:95], v[172:175]
    v_mfma_f32_16x16x32_bf16 v[176:179], v[40:43], v[92:95], v[176:179]
    s_mov_b32 s27, s26
    s_add_u32 s26, s26, 32768
    v_mfma_f32_16x16x32_bf16 v[180:183], v[44:47], v[92:95], v[180:183]
    s_cmp_eq_u32 s26, 163840
    s_cselect_b32 s26, 0, s26
    v_mfma_f32_16x16x32_bf16 v[184:187], v[32:35], v[96:99], v[184:187]
    v_add_u32 v3, s26, v1
    v_add_u32 v4, s26, v2
    v_mfma_f32_16x16x32_bf16 v[188:191], v[36:39], v[96:99], v[188:191]
    v_mfma_f32_16x16x32_bf16 v[192:195], v[40:43], v[96:99], v[192:195]
    v_mfma_f32_16x16x32_bf16 v[196:199], v[44:47], v[96:99], v[196:199]
    s_waitcnt vmcnt(8) lgkmcnt(0)
    s_barrier
    v_mfma_f32_16x16x32_bf16 v[104:107], v[48:51], v[16:19], v[104:107]
    ds_read_b64_tr_b16 v[76:77], v4 offset:16384
    v_mfma_f32_16x16x32_bf16 v[108:111], v[48:51], v[20:23], v[108:111]
    ds_read_b64_tr_b16 v[78:79], v4 offset:20480
    v_mfma_f32_16x16x32_bf16 v[112:115], v[48:51], v[24:27], v[112:115]
    ds_read_b128 v[32:35], v3 offset:0
    v_mfma_f32_16x16x32_bf16 v[116:119], v[48:51], v[28:31], v[116:119]
    ds_read_b128 v[36:39], v3 offset:1024
    v_mfma_f32_16x16x32_bf16 v[120:123], v[52:55], v[16:19], v[120:123]
    ds_read_b128 v[40:43], v3 offset:2048
    v_mfma_f32_16x16x32_bf16 v[124:127], v[52:55], v[20:23], v[124:127]
    ds_read_b128 v[44:47], v3 offset:3072
    v_mfma_f32_16x16x32_bf16 v[128:131], v[52:55], v[24:27], v[128:131]
    ds_read_b64_tr_b16 v[80:81], v4 offset:16416
    v_mfma_f32_16x16x32_bf16 v[132:135], v[52:55], v[28:31], v[132:135]
    ds_read_b64_tr_b16 v[82:83], v4 offset:20512
    v_mfma_f32_16x16x32_bf16 v[136:139], v[56:59], v[16:19], v[136:139]
    ds_read_b64_tr_b16 v[84:85], v4 offset:16448
    v_mfma_f32_16x16x32_bf16 v[140:143], v[56:59], v[20:23], v[140:143]
    ds_read_b64_tr_b16 v[86:87], v4 offset:20544
    v_mfma_f32_16x16x32_bf16 v[144:147], v[56:59], v[24:27], v[144:147]
    ds_read_b64_tr_b16 v[88:89], v4 offset:16480
    v_mfma_f32_16x16x32_bf16 v[148:151], v[56:59], v[28:31], v[148:151]
    ds_read_b64_tr_b16 v[90:91], v4 offset:20576
    v_mfma_f32_16x16x32_bf16 v[152:155], v[60:63], v[16:19], v[152:155]
    ds_read_b64_tr_b16 v[92:93], v4 offset:16512
    v_mfma_f32_16x16x32_bf16 v[156:159], v[60:63], v[20:23], v[156:159]
    ds_read_b64_tr_b16 v[94:95], v4 offset:20608
    v_mfma_f32_16x16x32_bf16 v[160:163], v[60:63], v[24:27], v[160:163]
    ds_read_b64_tr_b16 v[96:97], v4 offset:16544
    v_mfma_f32_16x16x32_bf16 v[164:167], v[60:63], v[28:31], v[164:167]
    ds_read_b64_tr_b16 v[98:99], v4 offset:20640
    v_mfma_f32_16x16x32_bf16 v[168:171], v[16:19], v[64:67], v[168:171]
    v_mfma_f32_16x16x32_bf16 v[172:175], v[20:23], v[64:67], v[172:175]
    v_mfma_f32_16x16x32_bf16 v[176:179], v[24:27], v[64:67], v[176:179]
    s_mov_b32 s27, s26
    s_add_u32 s26, s26, 32768
    v_mfma_f32_16x16x32_bf16 v[180:183], v[28:31], v[64:67], v[180:183]
    s_cmp_eq_u32 s26, 163840
    s_cselect_b32 s26, 0, s26
    v_mfma_f32_16x16x32_bf16 v[184:187], v[16:19], v[68:71], v[184:187]
    v_add_u32 v3, s26, v1
    v_add_u32 v4, s26, v2
    v_mfma_f32_16x16x32_bf16 v[188:191], v[20:23], v[68:71], v[188:191]
    v_mfma_f32_16x16x32_bf16 v[192:195], v[24:27], v[68:71], v[192:195]
    v_mfma_f32_16x16x32_bf16 v[196:199], v[28:31], v[68:71], v[196:199]
    s_waitcnt vmcnt(4) lgkmcnt(0)
    s_barrier
    v_mfma_f32_16x16x32_bf16 v[104:107], v[76:79], v[32:35], v[104:107]
    ds_read_b64_tr_b16 v[48:49], v4 offset:16384
    v_mfma_f32_16x16x32_bf16 v[108:111], v[76:79], v[36:39], v[108:111]
    ds_read_b64_tr_b16 v[50:51], v4 offset:20480
    v_mfma_f32_16x16x32_bf16 v[112:115], v[76:79], v[40:43], v[112:115]
    ds_read_b128 v[16:19], v3 offset:0
    v_mfma_f32_16x16x32_bf16 v[116:119], v[76:79], v[44:47], v[116:119]
    ds_read_b128 v[20:23], v3 offset:1024
    v_mfma_f32_16x16x32_bf16 v[120:123], v[80:83], v[32:35], v[120:123]
    ds_read_b128 v[24:27], v3 offset:2048
    v_mfma_f32_16x16x32_bf16 v[124:127], v[80:83], v[36:39], v[124:127]
    ds_read_b128 v[28:31], v3 offset:3072
    v_mfma_f32_16x16x32_bf16 v[128:131], v[80:83], v[40:43], v[128:131]
    ds_read_b64_tr_b16 v[52:53], v4 offset:16416
    v_mfma_f32_16x16x32_bf16 v[132:135], v[80:83], v[44:47], v[132:135]
    ds_read_b64_tr_b16 v[54:55], v4 offset:20512
    v_mfma_f32_16x16x32_bf16 v[136:139], v[84:87], v[32:35], v[136:139]
    ds_read_b64_tr_b16 v[56:57], v4 offset:16448
    v_mfma_f32_16x16x32_bf16 v[140:143], v[84:87], v[36:39], v[140:143]
    ds_read_b64_tr_b16 v[58:59], v4 offset:20544
    v_mfma_f32_16x16x32_bf16 v[144:147], v[84:87], v[40:43], v[144:147]
    ds_read_b64_tr_b16 v[60:61], v4 offset:16480
    v_mfma_f32_16x16x32_bf16 v[148:151], v[84:87], v[44:47], v[148:151]
    ds_read_b64_tr_b16 v[62:63], v4 offset:20576
    v_mfma_f32_16x16x32_bf16 v[152:155], v[88:91], v[32:35], v[152:155]
    ds_read_b64_tr_b16 v[64:65], v4 offset:16512
    v_mfma_f32_16x16x32_bf16 v[156:159], v[88:91], v[36:39], v[156:159]
    ds_read_b64_tr_b16 v[66:67], v4 offset:20608
    v_mfma_f32_16x16x32_bf16 v[160:163], v[88:91], v[40:43], v[160:163]
    ds_read_b64_tr_b16 v[68:69], v4 offset:16544
    v_mfma_f32_16x16x32_bf16 v[164:167], v[88:91], v[44:47], v[164:167]
    ds_read_b64_tr_b16 v[70:71], v4 offset:20640
    v_mfma_f32_16x16x32_bf16 v[168:171], v[32:35], v[92:95], v[168:171]
    v_mfma_f32_16x16x32_bf16 v[172:175], v[36:39], v[92:95], v[172:175]
    v_mfma_f32_16x16x32_bf16 v[176:179], v[40:43], v[92:95], v[176:179]
    s_mov_b32 s27, s26
    s_add_u32 s26, s26, 32768
    v_mfma_f32_16x16x32_bf16 v[180:183], v[44:47], v[92:95], v[180:183]
    s_cmp_eq_u32 s26, 163840
    s_cselect_b32 s26, 0, s26
    v_mfma_f32_16x16x32_bf16 v[184:187], v[32:35], v[96:99], v[184:187]
    v_add_u32 v3, s26, v1
    v_add_u32 v4, s26, v2
    v_mfma_f32_16x16x32_bf16 v[188:191], v[36:39], v[96:99], v[188:191]
    v_mfma_f32_16x16x32_bf16 v[192:195], v[40:43], v[96:99], v[192:195]
    v_mfma_f32_16x16x32_bf16 v[196:199], v[44:47], v[96:99], v[196:199]
    s_waitcnt vmcnt(0) lgkmcnt(0)
    s_barrier
    v_mfma_f32_16x16x32_bf16 v[104:107], v[48:51], v[16:19], v[104:107]
    ds_read_b64_tr_b16 v[76:77], v4 offset:16384
    v_mfma_f32_16x16x32_bf16 v[108:111], v[48:51], v[20:23], v[108:111]
    ds_read_b64_tr_b16 v[78:79], v4 offset:20480
    v_mfma_f32_16x16x32_bf16 v[112:115], v[48:51], v[24:27], v[112:115]
    ds_read_b128 v[32:35], v3 offset:0
    v_mfma_f32_16x16x32_bf16 v[116:119], v[48:51], v[28:31], v[116:119]
    ds_read_b128 v[36:39], v3 offset:1024
    v_mfma_f32_16x16x32_bf16 v[120:123], v[52:55], v[16:19], v[120:123]
    ds_read_b128 v[40:43], v3 offset:2048
    v_mfma_f32_16x16x32_bf16 v[124:127], v[52:55], v[20:23], v[124:127]
    ds_read_b128 v[44:47], v3 offset:3072
    v_mfma_f32_16x16x32_bf16 v[128:131], v[52:55], v[24:27], v[128:131]
    ds_read_b64_tr_b16 v[80:81], v4 offset:16416
    v_mfma_f32_16x16x32_bf16 v[132:135], v[52:55], v[28:31], v[132:135]
    ds_read_b64_tr_b16 v[82:83], v4 offset:20512
    v_mfma_f32_16x16x32_bf16 v[136:139], v[56:59], v[16:19], v[136:139]
    ds_read_b64_tr_b16 v[84:85], v4 offset:16448
    v_mfma_f32_16x16x32_bf16 v[140:143], v[56:59], v[20:23], v[140:143]
    ds_read_b64_tr_b16 v[86:87], v4 offset:20544
    v_mfma_f32_16x16x32_bf16 v[144:147], v[56:59], v[24:27], v[144:147]
    ds_read_b64_tr_b16 v[88:89], v4 offset:16480
    v_mfma_f32_16x16x32_bf16 v[148:151], v[56:59], v[28:31], v[148:151]
    ds_read_b64_tr_b16 v[90:91], v4 offset:20576
    v_mfma_f32_16x16x32_bf16 v[152:155], v[60:63], v[16:19], v[152:155]
    ds_read_b64_tr_b16 v[92:93], v4 offset:16512
    v_mfma_f32_16x16x32_bf16 v[156:159], v[60:63], v[20:23], v[156:159]
    ds_read_b64_tr_b16 v[94:95], v4 offset:20608
    v_mfma_f32_16x16x32_bf16 v[160:163], v[60:63], v[24:27], v[160:163]
    ds_read_b64_tr_b16 v[96:97], v4 offset:16544
    v_mfma_f32_16x16x32_bf16 v[164:167], v[60:63], v[28:31], v[164:167]
    ds_read_b64_tr_b16 v[98:99], v4 offset:20640
    v_mfma_f32_16x16x32_bf16 v[168:171], v[16:19], v[64:67], v[168:171]
    v_mfma_f32_16x16x32_bf16 v[172:175], v[20:23], v[64:67], v[172:175]
    v_mfma_f32_16x16x32_bf16 v[176:179], v[24:27], v[64:67], v[176:179]
    s_mov_b32 s27, s26
    s_add_u32 s26, s26, 32768
    v_mfma_f32_16x16x32_bf16 v[180:183], v[28:31], v[64:67], v[180:183]
    s_cmp_eq_u32 s26, 163840
    s_cselect_b32 s26, 0, s26
    v_mfma_f32_16x16x32_bf16 v[184:187], v[16:19], v[68:71], v[184:187]
    v_add_u32 v3, s26, v1
    v_add_u32 v4, s26, v2
    v_mfma_f32_16x16x32_bf16 v[188:191], v[20:23], v[68:71], v[188:191]
    v_mfma_f32_16x16x32_bf16 v[192:195], v[24:27], v[68:71], v[192:195]
    v_mfma_f32_16x16x32_bf16 v[196:199], v[28:31], v[68:71], v[196:199]
    v_lshlrev_b32 v10, 2, v9
    v_add_u32 v10, 157696, v10
    v_mov_b32 v11, 0
    ds_write_b32 v10, v11
    ds_write_b32 v10, v11 offset:256
    ds_write_b32 v10, v11 offset:512
    s_waitcnt lgkmcnt(0)
    s_barrier
    v_mfma_f32_16x16x32_bf16 v[104:107], v[76:79], v[32:35], v[104:107]
    v_mfma_f32_16x16x32_bf16 v[108:111], v[76:79], v[36:39], v[108:111]
    v_mfma_f32_16x16x32_bf16 v[112:115], v[76:79], v[40:43], v[112:115]
    v_mfma_f32_16x16x32_bf16 v[116:119], v[76:79], v[44:47], v[116:119]
    v_mfma_f32_16x16x32_bf16 v[120:123], v[80:83], v[32:35], v[120:123]
    v_mfma_f32_16x16x32_bf16 v[124:127], v[80:83], v[36:39], v[124:127]
    v_mfma_f32_16x16x32_bf16 v[128:131], v[80:83], v[40:43], v[128:131]
    v_mfma_f32_16x16x32_bf16 v[132:135], v[80:83], v[44:47], v[132:135]
    v_mfma_f32_16x16x32_bf16 v[136:139], v[84:87], v[32:35], v[136:139]
    v_mfma_f32_16x16x32_bf16 v[140:143], v[84:87], v[36:39], v[140:143]
    v_mfma_f32_16x16x32_bf16 v[144:147], v[84:87], v[40:43], v[144:147]
    v_mfma_f32_16x16x32_bf16 v[148:151], v[84:87], v[44:47], v[148:151]
    v_mfma_f32_16x16x32_bf16 v[152:155], v[88:91], v[32:35], v[152:155]
    v_mfma_f32_16x16x32_bf16 v[156:159], v[88:91], v[36:39], v[156:159]
    v_mfma_f32_16x16x32_bf16 v[160:163], v[88:91], v[40:43], v[160:163]
    v_mfma_f32_16x16x32_bf16 v[164:167], v[88:91], v[44:47], v[164:167]
    v_mfma_f32_16x16x32_bf16 v[168:171], v[32:35], v[92:95], v[168:171]
    v_mfma_f32_16x16x32_bf16 v[172:175], v[36:39], v[92:95], v[172:175]
    v_mfma_f32_16x16x32_bf16 v[176:179], v[40:43], v[92:95], v[176:179]
    v_mfma_f32_16x16x32_bf16 v[180:183], v[44:47], v[92:95], v[180:183]
    v_mfma_f32_16x16x32_bf16 v[184:187], v[32:35], v[96:99], v[184:187]
    v_mfma_f32_16x16x32_bf16 v[188:191], v[36:39], v[96:99], v[188:191]
    v_mfma_f32_16x16x32_bf16 v[192:195], v[40:43], v[96:99], v[192:195]
    v_mfma_f32_16x16x32_bf16 v[196:199], v[44:47], v[96:99], v[196:199]
    s_nop 7
    s_setprio 2
    v_and_b32 v8, 15, v9
    v_lshrrev_b32 v10, 4, v9
    v_lshlrev_b32 v10, 9, v10
    v_lshl_add_u32 v12, v8, 4, v10
    v_lshrrev_b32 v11, 3, v8
    v_lshl_add_u32 v11, v11, 8, v10
    v_and_b32 v8, 7, v9
    v_lshl_add_u32 v11, v8, 4, v11
    s_lshl_b32 s16, s24, 14
    s_lshl_b32 s17, s7, 12
    s_add_u32 s16, s16, s17
    s_add_u32 s18, s17, 32768
    v_add_u32 v13, s18, v11
    v_lshlrev_b32 v14, 4, v9
    v_add_u32 v14, s18, v14
    s_add_u32 s19, s25, 0
    s_and_b32 s19, s19, 31
    s_lshl_b32 s19, s19, 17
    s_add_u32 s19, s19, s16
    s_add_u32 s19, s19, 0x800000
    s_add_u32 s17, s25, 0
    s_and_b32 s17, s17, 31
    s_lshl_b32 s17, s17, 17
    s_add_u32 s17, s17, s16
    s_add_u32 s17, s17, 0xc00000
    s_mov_b32 s20, 0x3e8293ee
    v_cvt_pk_bf16_f32 v32, v136, v137
    v_cvt_pk_bf16_f32 v33, v138, v139
    v_cvt_pk_bf16_f32 v34, v152, v153
    v_cvt_pk_bf16_f32 v35, v154, v155
    buffer_store_dwordx4 v[32:35], v11, s[36:39], s19 offen offset:0 sc1
    v_cvt_pk_bf16_f32 v36, v140, v141
    v_cvt_pk_bf16_f32 v37, v142, v143
    v_cvt_pk_bf16_f32 v38, v156, v157
    v_cvt_pk_bf16_f32 v39, v158, v159
    buffer_store_dwordx4 v[36:39], v11, s[36:39], s19 offen offset:128 sc1
    v_cvt_pk_bf16_f32 v40, v144, v145
    v_cvt_pk_bf16_f32 v41, v146, v147
    v_cvt_pk_bf16_f32 v42, v160, v161
    v_cvt_pk_bf16_f32 v43, v162, v163
    buffer_store_dwordx4 v[40:43], v11, s[36:39], s19 offen offset:2048 sc1
    v_cvt_pk_bf16_f32 v44, v148, v149
    v_cvt_pk_bf16_f32 v45, v150, v151
    v_cvt_pk_bf16_f32 v46, v164, v165
    v_cvt_pk_bf16_f32 v47, v166, v167
    buffer_store_dwordx4 v[44:47], v11, s[36:39], s19 offen offset:2176 sc1
    v_cvt_pk_bf16_f32 v48, v168, v169
    v_cvt_pk_bf16_f32 v49, v170, v171
    v_cvt_pk_bf16_f32 v50, v172, v173
    v_cvt_pk_bf16_f32 v51, v174, v175
    buffer_store_dwordx4 v[48:51], v12, s[36:39], s17 offen offset:0 sc1
    v_cvt_pk_bf16_f32 v52, v184, v185
    v_cvt_pk_bf16_f32 v53, v186, v187
    v_cvt_pk_bf16_f32 v54, v188, v189
    v_cvt_pk_bf16_f32 v55, v190, v191
    buffer_store_dwordx4 v[52:55], v12, s[36:39], s17 offen offset:256 sc1
    v_cvt_pk_bf16_f32 v56, v176, v177
    v_cvt_pk_bf16_f32 v57, v178, v179
    v_cvt_pk_bf16_f32 v58, v180, v181
    v_cvt_pk_bf16_f32 v59, v182, v183
    buffer_store_dwordx4 v[56:59], v12, s[36:39], s17 offen offset:2048 sc1
    v_cvt_pk_bf16_f32 v60, v192, v193
    v_cvt_pk_bf16_f32 v61, v194, v195
    v_cvt_pk_bf16_f32 v62, v196, v197
    v_cvt_pk_bf16_f32 v63, v198, v199
    buffer_store_dwordx4 v[60:63], v12, s[36:39], s17 offen offset:2304 sc1
    ds_write_b128 v13, v[32:35] offset:0
    ds_write_b128 v13, v[36:39] offset:128
    s_waitcnt lgkmcnt(0)
    ds_read_b128 v[64:67], v14 offset:0
    ds_read_b128 v[68:71], v14 offset:1024
    v_mul_f32 v104, s20, v104
    v_mul_f32 v105, s20, v105
    v_mul_f32 v106, s20, v106
    v_mul_f32 v107, s20, v107
    v_cvt_pk_bf16_f32 v16, v104, v105
    v_cvt_pk_bf16_f32 v17, v106, v107
    v_mul_f32 v120, s20, v120
    v_mul_f32 v121, s20, v121
    v_mul_f32 v122, s20, v122
    v_mul_f32 v123, s20, v123
    v_cvt_pk_bf16_f32 v18, v120, v121
    v_cvt_pk_bf16_f32 v19, v122, v123
    v_mul_f32 v108, s20, v108
    v_mul_f32 v109, s20, v109
    v_mul_f32 v110, s20, v110
    v_mul_f32 v111, s20, v111
    v_cvt_pk_bf16_f32 v20, v108, v109
    v_cvt_pk_bf16_f32 v21, v110, v111
    v_mul_f32 v124, s20, v124
    v_mul_f32 v125, s20, v125
    v_mul_f32 v126, s20, v126
    v_mul_f32 v127, s20, v127
    v_cvt_pk_bf16_f32 v22, v124, v125
    v_cvt_pk_bf16_f32 v23, v126, v127
    v_mul_f32 v112, s20, v112
    v_mul_f32 v113, s20, v113
    v_mul_f32 v114, s20, v114
    v_mul_f32 v115, s20, v115
    v_cvt_pk_bf16_f32 v24, v112, v113
    v_cvt_pk_bf16_f32 v25, v114, v115
    v_mul_f32 v128, s20, v128
    v_mul_f32 v129, s20, v129
    v_mul_f32 v130, s20, v130
    v_mul_f32 v131, s20, v131
    v_cvt_pk_bf16_f32 v26, v128, v129
    v_cvt_pk_bf16_f32 v27, v130, v131
    v_mul_f32 v116, s20, v116
    v_mul_f32 v117, s20, v117
    v_mul_f32 v118, s20, v118
    v_mul_f32 v119, s20, v119
    v_cvt_pk_bf16_f32 v28, v116, v117
    v_cvt_pk_bf16_f32 v29, v118, v119
    v_mul_f32 v132, s20, v132
    v_mul_f32 v133, s20, v133
    v_mul_f32 v134, s20, v134
    v_mul_f32 v135, s20, v135
    v_cvt_pk_bf16_f32 v30, v132, v133
    v_cvt_pk_bf16_f32 v31, v134, v135
    s_waitcnt lgkmcnt(0)
    ds_write_b128 v13, v[16:19] offset:0
    ds_write_b128 v13, v[20:23] offset:128
    ds_write_b128 v13, v[24:27] offset:2048
    ds_write_b128 v13, v[28:31] offset:2176
    s_waitcnt lgkmcnt(0)
    ds_read_b128 v[200:203], v14 offset:0
    ds_read_b128 v[204:207], v14 offset:1024
    ds_read_b128 v[208:211], v14 offset:2048
    ds_read_b128 v[212:215], v14 offset:3072
    v_mov_b32 v152, v64
    v_mov_b32 v153, v65
    v_mov_b32 v154, v66
    v_mov_b32 v155, v67
    v_mov_b32 v156, v68
    v_mov_b32 v157, v69
    v_mov_b32 v158, v70
    v_mov_b32 v159, v71
    s_mov_b32 s31, s25
    s_mov_b32 s32, s24
    v_lshlrev_b32 v4, 4, v9
    s_lshl_b32 s30, s3, 11
    v_add_u32 v6, s30, v4
    s_lshl_b32 s33, s31, 17
    s_add_u32 s33, s33, 0x800000
    s_mov_b32 s29, 1
    s_mov_b32 s34, 0
    v_lshlrev_b32 v7, 2, v9
    v_add_u32 v7, 157696, v7
    v_mov_b32 v3, 1
    v_and_b32 v184, 2, v9
    v_cmp_eq_u32 vcc, 0, v184
    v_mov_b32 v185, 0x3f803f80
    v_and_b32 v184, 1, v9
    v_cndmask_b32 v176, 0, v185, vcc
    v_cndmask_b32 v177, 0, v185, vcc
    v_xor_b32 v178, v176, v185
    v_xor_b32 v179, v176, v185
    v_mul_u32_u24 v180, 0xaaaa, v184
    v_add_u32 v180, 0x4444, v180
    v_lshrrev_b32 v184, 3, v9
    v_bfe_u32 v185, v9, 1, 2
    v_bfe_u32 v186, v9, 4, 2
    v_xor_b32 v185, v185, v186
    v_and_b32 v186, 1, v9
    v_lshlrev_b32 v186, 4, v186
    v_lshl_add_u32 v185, v185, 5, v186
    v_lshl_add_u32 v1, v184, 11, v185
    s_lshl_b32 s12, s35, 2
    s_add_u32 s12, s12, s3
    s_lshr_b32 s17, s12, 6
    s_and_b32 s18, s12, 63
    s_lshl_b32 s8, s18, 15
    s_lshl_b32 s20, s17, 7
    s_add_u32 s8, s8, s20
    s_mul_i32 s11, s17, 360448
    s_lshl_b32 s20, s18, 11
    s_add_u32 s11, s11, s20
    s_add_u32 s11, s11, 0x3800000
    s_mul_i32 s17, s12, 1171
    s_lshr_b32 s17, s17, 16
    s_mul_i32 s18, s17, 56
    s_sub_u32 s18, s12, s18
    s_lshl_b32 s9, s18, 16
    s_lshl_b32 s20, s17, 7
    s_add_u32 s9, s9, s20
    s_mul_i32 s14, s17, 360448
    s_lshl_b32 s20, s18, 12
    s_add_u32 s14, s14, s20
    s_add_u32 s14, s14, 0x3820000
    s_cmp_lt_u32 s12, 896
    s_cselect_b32 s14, s14, 0x40000000
    s_cselect_b32 s9, s9, 0x40000000
    s_and_b32 s16, s6, 1
    s_sub_u32 s17, s31, 0
    s_and_b32 s17, s17, 31
    s_lshl_b32 s17, s17, 10
    s_add_u32 s17, s17, 32768
    s_sub_u32 s10, s31, 0
    s_and_b32 s10, s10, 31
    s_lshl_b32 s10, s10, 10
    s_add_u32 s10, s10, 32768
    v_mov_b32 v10, 158212
    v_mov_b32 v11, 1
    s_waitcnt vmcnt(0)
    s_mov_b64 exec, 1
    ds_add_rtn_u32 v11, v10, v11
    v_mov_b32 v10, s4
    s_waitcnt lgkmcnt(0)
    v_readfirstlane_b32 s12, v11
    v_mov_b32 v11, 0
    s_cmp_lg_u32 s12, 3
    s_cbranch_scc1 f1q_nf
    buffer_store_dword v10, v11, s[36:39], s15 offen sc1
f1q_nf:
    s_mov_b64 exec, -1
    v_mov_b32 v188, 0xff800000
    v_mov_b32 v189, 0xff800000
    s_waitcnt lgkmcnt(0)
    v_mfma_f32_32x32x16_bf16 v[56:71], v[152:155], v[200:203], 0
    v_mfma_f32_32x32x16_bf16 v[56:71], v[156:159], v[204:207], v[56:71]
    v_mfma_f32_32x32x16_bf16 v[72:87], v[152:155], v[208:211], 0
    v_mfma_f32_32x32x16_bf16 v[72:87], v[156:159], v[212:215], v[72:87]
    s_nop 15
    v_max3_f32 v188, v56, v57, v188
    v_max3_f32 v188, v58, v59, v188
    v_max3_f32 v188, v60, v61, v188
    v_max3_f32 v188, v62, v63, v188
    v_max3_f32 v188, v64, v65, v188
    v_max3_f32 v188, v66, v67, v188
    v_max3_f32 v188, v68, v69, v188
    v_max3_f32 v188, v70, v71, v188
    v_max3_f32 v189, v72, v73, v189
    v_max3_f32 v189, v74, v75, v189
    v_max3_f32 v189, v76, v77, v189
    v_max3_f32 v189, v78, v79, v189
    v_max3_f32 v189, v80, v81, v189
    v_max3_f32 v189, v82, v83, v189
    v_max3_f32 v189, v84, v85, v189
    v_max3_f32 v189, v86, v87, v189
    v_mov_b32 v190, v188
    s_nop 1
    v_permlane32_swap_b32 v188, v190
    s_nop 1
    v_max_f32 v188, v188, v190
    v_sub_f32 v24, 0, v188
    v_sub_f32 v25, 0, v188
    v_sub_f32 v26, 0, v188
    v_sub_f32 v27, 0, v188
    v_sub_f32 v28, 0, v188
    v_sub_f32 v29, 0, v188
    v_sub_f32 v30, 0, v188
    v_sub_f32 v31, 0, v188
    v_sub_f32 v32, 0, v188
    v_sub_f32 v33, 0, v188
    v_sub_f32 v34, 0, v188
    v_sub_f32 v35, 0, v188
    v_sub_f32 v36, 0, v188
    v_sub_f32 v37, 0, v188
    v_sub_f32 v38, 0, v188
    v_sub_f32 v39, 0, v188
    v_mov_b32 v190, v189
    s_nop 1
    v_permlane32_swap_b32 v189, v190
    s_nop 1
    v_max_f32 v189, v189, v190
    v_sub_f32 v40, 0, v189
    v_sub_f32 v41, 0, v189
    v_sub_f32 v42, 0, v189
    v_sub_f32 v43, 0, v189
    v_sub_f32 v44, 0, v189
    v_sub_f32 v45, 0, v189
    v_sub_f32 v46, 0, v189
    v_sub_f32 v47, 0, v189
    v_sub_f32 v48, 0, v189
    v_sub_f32 v49, 0, v189
    v_sub_f32 v50, 0, v189
    v_sub_f32 v51, 0, v189
    v_sub_f32 v52, 0, v189
    v_sub_f32 v53, 0, v189
    v_sub_f32 v54, 0, v189
    v_sub_f32 v55, 0, v189
    s_cmp_gt_u32 s3, 0
    s_cbranch_scc1 a_np
    s_mov_b32 s13, 0x80000
a_pl_l:
    s_load_dword s18, s[100:101], s17 glc
    s_add_u32 s19, s17, 128
    s_load_dword s19, s[100:101], s19 glc
    s_add_u32 s20, s17, 256
    s_load_dword s20, s[100:101], s20 glc
    s_add_u32 s21, s17, 384
    s_load_dword s21, s[100:101], s21 glc
    s_add_u32 s22, s17, 512
    s_load_dword s22, s[100:101], s22 glc
    s_add_u32 s23, s17, 640
    s_load_dword s23, s[100:101], s23 glc
    s_add_u32 s24, s17, 768
    s_load_dword s24, s[100:101], s24 glc
    s_add_u32 s25, s17, 896
    s_load_dword s25, s[100:101], s25 glc
    s_sub_u32 s13, s13, 1
    s_cbranch_scc1 a_pl_d
    s_waitcnt lgkmcnt(0)
    s_cmp_eq_u32 s18, s4
    s_cbranch_scc0 a_pl_w
    s_cmp_eq_u32 s19, s4
    s_cbranch_scc0 a_pl_w
    s_cmp_eq_u32 s20, s4
    s_cbranch_scc0 a_pl_w
    s_cmp_eq_u32 s21, s4
    s_cbranch_scc0 a_pl_w
    s_cmp_eq_u32 s22, s4
    s_cbranch_scc0 a_pl_w
    s_cmp_eq_u32 s23, s4
    s_cbranch_scc0 a_pl_w
    s_cmp_eq_u32 s24, s4
    s_cbranch_scc0 a_pl_w
    s_cmp_eq_u32 s25, s4
    s_cbranch_scc0 a_pl_w
    s_branch a_pl_d
a_pl_w:
    s_sleep 2
    s_branch a_pl_l
a_pl_d:
    s_waitcnt lgkmcnt(0)
a_np:
    s_add_u32 s34, s34, 4
    ds_add_u32 v7, v3
a_sp_s:
    ds_read_b32 v5, v7
    s_waitcnt lgkmcnt(0)
    v_readfirstlane_b32 s12, v5
    s_cmp_ge_u32 s12, s34
    s_cbranch_scc1 a_sp_x
    s_sleep 2
    s_branch a_sp_s
a_sp_x:
p2_restart:
    buffer_load_dwordx4 v[152:155], v4, s[36:39], s33 offen offset:0 sc1
    buffer_load_dwordx4 v[156:159], v4, s[36:39], s33 offen offset:1024 sc1
    s_add_u32 s26, s33, 2048
    s_add_u32 s27, s33, 0x400000
    s_add_u32 m0, 0, s30
    s_nop 0
    buffer_load_dwordx4 v6, s[36:39], s26 offen offset:0 sc1 lds
    buffer_load_dwordx4 v6, s[36:39], s26 offen offset:1024 sc1 lds
    s_add_u32 s26, s26, 8192
    s_add_u32 m0, m0, 8192
    s_nop 0
    buffer_load_dwordx4 v6, s[36:39], s27 offen offset:0 sc1 lds
    buffer_load_dwordx4 v6, s[36:39], s27 offen offset:1024 sc1 lds
    s_add_u32 s27, s27, 8192
    s_add_u32 m0, 16384, s30
    s_nop 0
    buffer_load_dwordx4 v6, s[36:39], s26 offen offset:0 sc1 lds
    buffer_load_dwordx4 v6, s[36:39], s26 offen offset:1024 sc1 lds
    s_add_u32 s26, s26, 8192
    s_add_u32 m0, m0, 8192
    s_nop 0
    buffer_load_dwordx4 v6, s[36:39], s27 offen offset:0 sc1 lds
    buffer_load_dwordx4 v6, s[36:39], s27 offen offset:1024 sc1 lds
    s_add_u32 s27, s27, 8192
    v_mov_b32 v104, 0
    v_mov_b32 v105, 0
    v_mov_b32 v106, 0
    v_mov_b32 v107, 0
    v_mov_b32 v108, 0
    v_mov_b32 v109, 0
    v_mov_b32 v110, 0
    v_mov_b32 v111, 0
    v_mov_b32 v112, 0
    v_mov_b32 v113, 0
    v_mov_b32 v114, 0
    v_mov_b32 v115, 0
    v_mov_b32 v116, 0
    v_mov_b32 v117, 0
    v_mov_b32 v118, 0
    v_mov_b32 v119, 0
    v_mov_b32 v136, 0
    v_mov_b32 v137, 0
    v_mov_b32 v138, 0
    v_mov_b32 v139, 0
    v_mov_b32 v120, 0
    v_mov_b32 v121, 0
    v_mov_b32 v122, 0
    v_mov_b32 v123, 0
    v_mov_b32 v124, 0
    v_mov_b32 v125, 0
    v_mov_b32 v126, 0
    v_mov_b32 v127, 0
    v_mov_b32 v128, 0
    v_mov_b32 v129, 0
    v_mov_b32 v130, 0
    v_mov_b32 v131, 0
    v_mov_b32 v132, 0
    v_mov_b32 v133, 0
    v_mov_b32 v134, 0
    v_mov_b32 v135, 0
    v_mov_b32 v140, 0
    v_mov_b32 v141, 0
    v_mov_b32 v142, 0
    v_mov_b32 v143, 0
    s_waitcnt vmcnt(8)
    v_mfma_f32_32x32x16_bf16 v[56:71], v[152:155], v[200:203], v[24:39]
    v_mfma_f32_32x32x16_bf16 v[56:71], v[156:159], v[204:207], v[56:71]
    s_mov_b32 s24, 0
    s_mov_b32 s25, 32768
    v_mov_b32 v2, v4
    s_waitcnt vmcnt(4)
    s_add_u32 s34, s34, 4
    ds_add_u32 v7, v3
a_s0_s:
    ds_read_b32 v5, v7
    s_waitcnt lgkmcnt(0)
    v_readfirstlane_b32 s12, v5
    s_cmp_ge_u32 s12, s34
    s_cbranch_scc0 a_s0_s
    v_mfma_f32_32x32x16_bf16 v[72:87], v[152:155], v[208:211], v[40:55]
    ds_read_b128 v[144:147], v2 offset:0
    ds_read_b128 v[148:151], v2 offset:1024
    v_exp_f32 v56, v56
    v_exp_f32 v57, v57
    v_exp_f32 v58, v58
    v_exp_f32 v59, v59
    v_mfma_f32_32x32x16_bf16 v[72:87], v[156:159], v[212:215], v[72:87]
    ds_read_b128 v[160:163], v2 offset:8192
    ds_read_b128 v[164:167], v2 offset:9216
    v_cvt_pk_bf16_f32 v88, v56, v57
    v_exp_f32 v60, v60
    v_exp_f32 v61, v61
    v_cvt_pk_bf16_f32 v89, v58, v59
    v_exp_f32 v62, v62
    v_exp_f32 v63, v63
    v_cvt_pk_bf16_f32 v90, v60, v61
    v_exp_f32 v64, v64
    v_exp_f32 v65, v65
    v_cvt_pk_bf16_f32 v91, v62, v63
    v_exp_f32 v66, v66
    v_exp_f32 v67, v67
    v_cvt_pk_bf16_f32 v92, v64, v65
    v_exp_f32 v68, v68
    v_exp_f32 v69, v69
    v_cvt_pk_bf16_f32 v93, v66, v67
    v_exp_f32 v70, v70
    v_exp_f32 v71, v71
    v_cvt_pk_bf16_f32 v94, v68, v69
    v_cvt_pk_bf16_f32 v95, v70, v71
    s_waitcnt lgkmcnt(0)
    s_mov_b32 s28, 15
    s_setprio 0
.p2align 3
p2_aloop:
    v_mfma_f32_32x32x16_bf16 v[56:71], v[144:147], v[200:203], v[24:39]
    v_exp_f32 v72, v72
    v_exp_f32 v73, v73
    v_exp_f32 v74, v74
    v_exp_f32 v75, v75
    v_mfma_f32_32x32x16_bf16 v[56:71], v[148:151], v[204:207], v[56:71]
    ds_read_b128 v[152:155], v2 offset:2048
    v_cvt_pk_bf16_f32 v96, v72, v73
    v_exp_f32 v76, v76
    v_exp_f32 v77, v77
    v_cvt_pk_bf16_f32 v97, v74, v75
    v_exp_f32 v78, v78
    v_exp_f32 v79, v79
    v_mfma_f32_32x32x16_bf16 v[104:119], v[160:163], v[88:91], v[104:119]
    ds_read_b128 v[156:159], v2 offset:3072
    v_cvt_pk_bf16_f32 v98, v76, v77
    v_exp_f32 v80, v80
    v_exp_f32 v81, v81
    v_cvt_pk_bf16_f32 v99, v78, v79
    v_exp_f32 v82, v82
    v_exp_f32 v83, v83
    v_mfma_f32_32x32x16_bf16 v[104:119], v[164:167], v[92:95], v[104:119]
    v_cvt_pk_bf16_f32 v100, v80, v81
    v_exp_f32 v84, v84
    v_exp_f32 v85, v85
    v_cvt_pk_bf16_f32 v101, v82, v83
    v_exp_f32 v86, v86
    v_smfmac_f32_16x16x64_bf16 v[136:139], v[176:179], v[88:95], v180
    ds_read_b128 v[168:171], v2 offset:10240
    ds_read_b128 v[172:175], v2 offset:11264
    v_exp_f32 v87, v87
    v_cvt_pk_bf16_f32 v102, v84, v85
    v_cvt_pk_bf16_f32 v103, v86, v87
    v_mfma_f32_32x32x16_bf16 v[72:87], v[144:147], v[208:211], v[40:55]
    s_add_u32 s34, s34, 4
    v_exp_f32 v56, v56
    v_exp_f32 v57, v57
    v_exp_f32 v58, v58
    v_exp_f32 v59, v59
    v_mfma_f32_32x32x16_bf16 v[72:87], v[148:151], v[212:215], v[72:87]
    s_add_u32 s24, s24, 16384
    v_cvt_pk_bf16_f32 v88, v56, v57
    v_exp_f32 v60, v60
    v_exp_f32 v61, v61
    v_cvt_pk_bf16_f32 v89, v58, v59
    v_exp_f32 v62, v62
    v_exp_f32 v63, v63
    v_mfma_f32_32x32x16_bf16 v[120:135], v[160:163], v[96:99], v[120:135]
    s_cmp_eq_u32 s24, 49152
    v_cvt_pk_bf16_f32 v90, v60, v61
    v_exp_f32 v64, v64
    v_exp_f32 v65, v65
    v_cvt_pk_bf16_f32 v91, v62, v63
    v_exp_f32 v66, v66
    v_exp_f32 v67, v67
    v_mfma_f32_32x32x16_bf16 v[120:135], v[164:167], v[100:103], v[120:135]
    s_cselect_b32 s24, 0, s24
    v_cvt_pk_bf16_f32 v92, v64, v65
    v_exp_f32 v68, v68
    v_exp_f32 v69, v69
    v_cvt_pk_bf16_f32 v93, v66, v67
    v_exp_f32 v70, v70
    v_smfmac_f32_16x16x64_bf16 v[140:143], v[176:179], v[96:103], v180
    s_waitcnt lgkmcnt(0)
    v_exp_f32 v71, v71
    v_cvt_pk_bf16_f32 v94, v68, v69
    v_cvt_pk_bf16_f32 v95, v70, v71
    v_mfma_f32_32x32x16_bf16 v[56:71], v[152:155], v[200:203], v[24:39]
    v_exp_f32 v72, v72
    v_exp_f32 v73, v73
    v_exp_f32 v74, v74
    v_exp_f32 v75, v75
    v_mfma_f32_32x32x16_bf16 v[56:71], v[156:159], v[204:207], v[56:71]
    ds_read_b128 v[144:147], v2 offset:4096
    v_cvt_pk_bf16_f32 v96, v72, v73
    v_exp_f32 v76, v76
    v_exp_f32 v77, v77
    v_cvt_pk_bf16_f32 v97, v74, v75
    v_exp_f32 v78, v78
    v_exp_f32 v79, v79
    v_mfma_f32_32x32x16_bf16 v[104:119], v[168:171], v[88:91], v[104:119]
    ds_read_b128 v[148:151], v2 offset:5120
    v_cvt_pk_bf16_f32 v98, v76, v77
    v_exp_f32 v80, v80
    v_exp_f32 v81, v81
    v_cvt_pk_bf16_f32 v99, v78, v79
    v_exp_f32 v82, v82
    v_exp_f32 v83, v83
    v_mfma_f32_32x32x16_bf16 v[104:119], v[172:175], v[92:95], v[104:119]
    v_cvt_pk_bf16_f32 v100, v80, v81
    v_exp_f32 v84, v84
    v_exp_f32 v85, v85
    v_cvt_pk_bf16_f32 v101, v82, v83
    v_exp_f32 v86, v86
    v_smfmac_f32_16x16x64_bf16 v[136:139], v[176:179], v[88:95], v180
    ds_read_b128 v[160:163], v2 offset:12288
    ds_read_b128 v[164:167], v2 offset:13312
    v_exp_f32 v87, v87
    v_cvt_pk_bf16_f32 v102, v84, v85
    v_cvt_pk_bf16_f32 v103, v86, v87
    v_mfma_f32_32x32x16_bf16 v[72:87], v[152:155], v[208:211], v[40:55]
    v_exp_f32 v56, v56
    v_exp_f32 v57, v57
    v_exp_f32 v58, v58
    v_exp_f32 v59, v59
    v_mfma_f32_32x32x16_bf16 v[72:87], v[156:159], v[212:215], v[72:87]
    s_cmp_le_u32 s28, 1
    v_cvt_pk_bf16_f32 v88, v56, v57
    v_exp_f32 v60, v60
    v_exp_f32 v61, v61
    v_cvt_pk_bf16_f32 v89, v58, v59
    v_exp_f32 v62, v62
    v_exp_f32 v63, v63
    v_mfma_f32_32x32x16_bf16 v[120:135], v[168:171], v[96:99], v[120:135]
    s_cselect_b32 s26, 0x40000000, s26
    v_cvt_pk_bf16_f32 v90, v60, v61
    v_exp_f32 v64, v64
    v_exp_f32 v65, v65
    v_cvt_pk_bf16_f32 v91, v62, v63
    v_exp_f32 v66, v66
    v_exp_f32 v67, v67
    v_mfma_f32_32x32x16_bf16 v[120:135], v[172:175], v[100:103], v[120:135]
    s_cselect_b32 s27, 0x40000000, s27
    v_cvt_pk_bf16_f32 v92, v64, v65
    v_exp_f32 v68, v68
    v_exp_f32 v69, v69
    v_cvt_pk_bf16_f32 v93, v66, v67
    v_exp_f32 v70, v70
    v_smfmac_f32_16x16x64_bf16 v[140:143], v[176:179], v[96:103], v180
    s_waitcnt lgkmcnt(0)
    v_exp_f32 v71, v71
    v_cvt_pk_bf16_f32 v94, v68, v69
    v_cvt_pk_bf16_f32 v95, v70, v71
    v_mfma_f32_32x32x16_bf16 v[56:71], v[144:147], v[200:203], v[24:39]
    v_exp_f32 v72, v72
    v_exp_f32 v73, v73
    v_exp_f32 v74, v74
    v_exp_f32 v75, v75
    v_mfma_f32_32x32x16_bf16 v[56:71], v[148:151], v[204:207], v[56:71]
    ds_read_b128 v[152:155], v2 offset:6144
    v_cvt_pk_bf16_f32 v96, v72, v73
    v_exp_f32 v76, v76
    v_exp_f32 v77, v77
    v_cvt_pk_bf16_f32 v97, v74, v75
    v_exp_f32 v78, v78
    v_exp_f32 v79, v79
    v_mfma_f32_32x32x16_bf16 v[104:119], v[160:163], v[88:91], v[104:119]
    ds_read_b128 v[156:159], v2 offset:7168
    v_cvt_pk_bf16_f32 v98, v76, v77
    v_exp_f32 v80, v80
    v_exp_f32 v81, v81
    v_cvt_pk_bf16_f32 v99, v78, v79
    v_exp_f32 v82, v82
    v_exp_f32 v83, v83
    v_mfma_f32_32x32x16_bf16 v[104:119], v[164:167], v[92:95], v[104:119]
    s_waitcnt vmcnt(0)
    ds_add_u32 v7, v3
    v_cvt_pk_bf16_f32 v100, v80, v81
    v_exp_f32 v84, v84
    v_exp_f32 v85, v85
    v_cvt_pk_bf16_f32 v101, v82, v83
    v_exp_f32 v86, v86
    v_smfmac_f32_16x16x64_bf16 v[136:139], v[176:179], v[88:95], v180
    ds_read_b128 v[168:171], v2 offset:14336
    ds_read_b128 v[172:175], v2 offset:15360
    v_exp_f32 v87, v87
    v_cvt_pk_bf16_f32 v102, v84, v85
    v_cvt_pk_bf16_f32 v103, v86, v87
    v_mfma_f32_32x32x16_bf16 v[72:87], v[144:147], v[208:211], v[40:55]
    s_add_u32 s10, s28, s16
    s_bitcmp1_b32 0xe74, s10
    s_cbranch_scc1 a_cp_r
a_cp_b:
    v_exp_f32 v56, v56
    v_exp_f32 v57, v57
    v_exp_f32 v58, v58
    v_exp_f32 v59, v59
    v_mfma_f32_32x32x16_bf16 v[72:87], v[148:151], v[212:215], v[72:87]
    v_cvt_pk_bf16_f32 v88, v56, v57
    v_exp_f32 v60, v60
    v_exp_f32 v61, v61
    v_cvt_pk_bf16_f32 v89, v58, v59
    v_exp_f32 v62, v62
    v_exp_f32 v63, v63
    v_mfma_f32_32x32x16_bf16 v[120:135], v[160:163], v[96:99], v[120:135]
    ds_read_b32 v5, v7
    v_cvt_pk_bf16_f32 v90, v60, v61
    v_exp_f32 v64, v64
    v_exp_f32 v65, v65
    v_cvt_pk_bf16_f32 v91, v62, v63
    v_exp_f32 v66, v66
    v_exp_f32 v67, v67
    v_mfma_f32_32x32x16_bf16 v[120:135], v[164:167], v[100:103], v[120:135]
    v_cvt_pk_bf16_f32 v92, v64, v65
    v_exp_f32 v68, v68
    v_exp_f32 v69, v69
    v_cvt_pk_bf16_f32 v93, v66, v67
    v_exp_f32 v70, v70
    v_smfmac_f32_16x16x64_bf16 v[140:143], v[176:179], v[96:103], v180
    s_waitcnt lgkmcnt(0)
    v_exp_f32 v71, v71
    v_readfirstlane_b32 s12, v5
    v_add_u32 v2, s24, v4
    v_cvt_pk_bf16_f32 v94, v68, v69
    v_cvt_pk_bf16_f32 v95, v70, v71
    v_mfma_f32_32x32x16_bf16 v[56:71], v[152:155], v[200:203], v[24:39]
    s_cmp_ge_u32 s12, s34
    s_cbranch_scc0 a_ck_s
a_ck_b:
    s_add_u32 m0, s25, s30
    v_exp_f32 v72, v72
    v_exp_f32 v73, v73
    v_exp_f32 v74, v74
    v_exp_f32 v75, v75
    v_mfma_f32_32x32x16_bf16 v[56:71], v[156:159], v[204:207], v[56:71]
    ds_read_b128 v[144:147], v2 offset:0
    v_cvt_pk_bf16_f32 v96, v72, v73
    v_exp_f32 v76, v76
    v_exp_f32 v77, v77
    v_cvt_pk_bf16_f32 v97, v74, v75
    v_exp_f32 v78, v78
    v_exp_f32 v79, v79
    v_mfma_f32_32x32x16_bf16 v[104:119], v[168:171], v[88:91], v[104:119]
    ds_read_b128 v[148:151], v2 offset:1024
    v_cvt_pk_bf16_f32 v98, v76, v77
    v_exp_f32 v80, v80
    v_exp_f32 v81, v81
    v_cvt_pk_bf16_f32 v99, v78, v79
    v_exp_f32 v82, v82
    v_exp_f32 v83, v83
    v_mfma_f32_32x32x16_bf16 v[104:119], v[172:175], v[92:95], v[104:119]
    buffer_load_dwordx4 v6, s[36:39], s26 offen offset:0 sc1 lds
    buffer_load_dwordx4 v6, s[36:39], s26 offen offset:1024 sc1 lds
    s_add_u32 s26, s26, 8192
    s_add_u32 m0, m0, 8192
    v_cvt_pk_bf16_f32 v100, v80, v81
    v_exp_f32 v84, v84
    v_exp_f32 v85, v85
    v_cvt_pk_bf16_f32 v101, v82, v83
    v_exp_f32 v86, v86
    v_smfmac_f32_16x16x64_bf16 v[136:139], v[176:179], v[88:95], v180
    ds_read_b128 v[160:163], v2 offset:8192
    ds_read_b128 v[164:167], v2 offset:9216
    v_exp_f32 v87, v87
    v_cvt_pk_bf16_f32 v102, v84, v85
    v_cvt_pk_bf16_f32 v103, v86, v87
    v_mfma_f32_32x32x16_bf16 v[72:87], v[152:155], v[208:211], v[40:55]
    buffer_load_dwordx4 v6, s[36:39], s27 offen offset:0 sc1 lds
    buffer_load_dwordx4 v6, s[36:39], s27 offen offset:1024 sc1 lds
    s_add_u32 s27, s27, 8192
    v_exp_f32 v56, v56
    v_exp_f32 v57, v57
    v_exp_f32 v58, v58
    v_exp_f32 v59, v59
    v_mfma_f32_32x32x16_bf16 v[72:87], v[156:159], v[212:215], v[72:87]
    s_add_u32 s25, s25, 16384
    v_cvt_pk_bf16_f32 v88, v56, v57
    v_exp_f32 v60, v60
    v_exp_f32 v61, v61
    v_cvt_pk_bf16_f32 v89, v58, v59
    v_exp_f32 v62, v62
    v_exp_f32 v63, v63
    v_mfma_f32_32x32x16_bf16 v[120:135], v[168:171], v[96:99], v[120:135]
    s_cmp_eq_u32 s25, 49152
    v_cvt_pk_bf16_f32 v90, v60, v61
    v_exp_f32 v64, v64
    v_exp_f32 v65, v65
    v_cvt_pk_bf16_f32 v91, v62, v63
    v_exp_f32 v66, v66
    v_exp_f32 v67, v67
    v_mfma_f32_32x32x16_bf16 v[120:135], v[172:175], v[100:103], v[120:135]
    s_cselect_b32 s25, 0, s25
    v_cvt_pk_bf16_f32 v92, v64, v65
    v_exp_f32 v68, v68
    v_exp_f32 v69, v69
    v_cvt_pk_bf16_f32 v93, v66, v67
    v_exp_f32 v70, v70
    v_smfmac_f32_16x16x64_bf16 v[140:143], v[176:179], v[96:103], v180
    s_waitcnt lgkmcnt(0)
    v_exp_f32 v71, v71
    v_cvt_pk_bf16_f32 v94, v68, v69
    v_cvt_pk_bf16_f32 v95, v70, v71
    s_sub_u32 s28, s28, 1
    s_cmp_lg_u32 s28, 0
    s_cbranch_scc1 p2_aloop
    v_mfma_f32_32x32x16_bf16 v[56:71], v[144:147], v[200:203], v[24:39]
    v_exp_f32 v72, v72
    v_exp_f32 v73, v73
    v_exp_f32 v74, v74
    v_exp_f32 v75, v75
    v_mfma_f32_32x32x16_bf16 v[56:71], v[148:151], v[204:207], v[56:71]
    ds_read_b128 v[152:155], v2 offset:2048
    v_cvt_pk_bf16_f32 v96, v72, v73
    v_exp_f32 v76, v76
    v_exp_f32 v77, v77
    v_cvt_pk_bf16_f32 v97, v74, v75
    v_exp_f32 v78, v78
    v_exp_f32 v79, v79
    v_mfma_f32_32x32x16_bf16 v[104:119], v[160:163], v[88:91], v[104:119]
    ds_read_b128 v[156:159], v2 offset:3072
    v_cvt_pk_bf16_f32 v98, v76, v77
    v_exp_f32 v80, v80
    v_exp_f32 v81, v81
    v_cvt_pk_bf16_f32 v99, v78, v79
    v_exp_f32 v82, v82
    v_exp_f32 v83, v83
    v_mfma_f32_32x32x16_bf16 v[104:119], v[164:167], v[92:95], v[104:119]
    v_cvt_pk_bf16_f32 v100, v80, v81
    v_exp_f32 v84, v84
    v_exp_f32 v85, v85
    v_cvt_pk_bf16_f32 v101, v82, v83
    v_exp_f32 v86, v86
    v_smfmac_f32_16x16x64_bf16 v[136:139], v[176:179], v[88:95], v180
    ds_read_b128 v[168:171], v2 offset:10240
    ds_read_b128 v[172:175], v2 offset:11264
    v_exp_f32 v87, v87
    v_cvt_pk_bf16_f32 v102, v84, v85
    v_cvt_pk_bf16_f32 v103, v86, v87
    v_mfma_f32_32x32x16_bf16 v[72:87], v[144:147], v[208:211], v[40:55]
    v_exp_f32 v56, v56
    v_exp_f32 v57, v57
    v_exp_f32 v58, v58
    v_exp_f32 v59, v59
    v_mfma_f32_32x32x16_bf16 v[72:87], v[148:151], v[212:215], v[72:87]
    v_cvt_pk_bf16_f32 v88, v56, v57
    v_exp_f32 v60, v60
    v_exp_f32 v61, v61
    v_cvt_pk_bf16_f32 v89, v58, v59
    v_exp_f32 v62, v62
    v_exp_f32 v63, v63
    v_mfma_f32_32x32x16_bf16 v[120:135], v[160:163], v[96:99], v[120:135]
    v_cvt_pk_bf16_f32 v90, v60, v61
    v_exp_f32 v64, v64
    v_exp_f32 v65, v65
    v_cvt_pk_bf16_f32 v91, v62, v63
    v_exp_f32 v66, v66
    v_exp_f32 v67, v67
    v_mfma_f32_32x32x16_bf16 v[120:135], v[164:167], v[100:103], v[120:135]
    v_cvt_pk_bf16_f32 v92, v64, v65
    v_exp_f32 v68, v68
    v_exp_f32 v69, v69
    v_cvt_pk_bf16_f32 v93, v66, v67
    v_exp_f32 v70, v70
    v_smfmac_f32_16x16x64_bf16 v[140:143], v[176:179], v[96:103], v180
    s_waitcnt lgkmcnt(0)
    v_exp_f32 v71, v71
    v_cvt_pk_bf16_f32 v94, v68, v69
    v_cvt_pk_bf16_f32 v95, v70, v71
    v_mfma_f32_32x32x16_bf16 v[56:71], v[152:155], v[200:203], v[24:39]
    v_exp_f32 v72, v72
    v_exp_f32 v73, v73
    v_exp_f32 v74, v74
    v_exp_f32 v75, v75
    v_mfma_f32_32x32x16_bf16 v[56:71], v[156:159], v[204:207], v[56:71]
    ds_read_b128 v[144:147], v2 offset:4096
    v_cvt_pk_bf16_f32 v96, v72, v73
    v_exp_f32 v76, v76
    v_exp_f32 v77, v77
    v_cvt_pk_bf16_f32 v97, v74, v75
    v_exp_f32 v78, v78
    v_exp_f32 v79, v79
    v_mfma_f32_32x32x16_bf16 v[104:119], v[168:171], v[88:91], v[104:119]
    ds_read_b128 v[148:151], v2 offset:5120
    v_cvt_pk_bf16_f32 v98, v76, v77
    v_exp_f32 v80, v80
    v_exp_f32 v81, v81
    v_cvt_pk_bf16_f32 v99, v78, v79
    v_exp_f32 v82, v82
    v_exp_f32 v83, v83
    v_mfma_f32_32x32x16_bf16 v[104:119], v[172:175], v[92:95], v[104:119]
    v_cvt_pk_bf16_f32 v100, v80, v81
    v_exp_f32 v84, v84
    v_exp_f32 v85, v85
    v_cvt_pk_bf16_f32 v101, v82, v83
    v_exp_f32 v86, v86
    v_smfmac_f32_16x16x64_bf16 v[136:139], v[176:179], v[88:95], v180
    ds_read_b128 v[160:163], v2 offset:12288
    ds_read_b128 v[164:167], v2 offset:13312
    v_exp_f32 v87, v87
    v_cvt_pk_bf16_f32 v102, v84, v85
    v_cvt_pk_bf16_f32 v103, v86, v87
    v_mfma_f32_32x32x16_bf16 v[72:87], v[152:155], v[208:211], v[40:55]
    v_exp_f32 v56, v56
    v_exp_f32 v57, v57
    v_exp_f32 v58, v58
    v_exp_f32 v59, v59
    v_mfma_f32_32x32x16_bf16 v[72:87], v[156:159], v[212:215], v[72:87]
    v_cvt_pk_bf16_f32 v88, v56, v57
    v_exp_f32 v60, v60
    v_exp_f32 v61, v61
    v_cvt_pk_bf16_f32 v89, v58, v59
    v_exp_f32 v62, v62
    v_exp_f32 v63, v63
    v_mfma_f32_32x32x16_bf16 v[120:135], v[168:171], v[96:99], v[120:135]
    v_cvt_pk_bf16_f32 v90, v60, v61
    v_exp_f32 v64, v64
    v_exp_f32 v65, v65
    v_cvt_pk_bf16_f32 v91, v62, v63
    v_exp_f32 v66, v66
    v_exp_f32 v67, v67
    v_mfma_f32_32x32x16_bf16 v[120:135], v[172:175], v[100:103], v[120:135]
    v_cvt_pk_bf16_f32 v92, v64, v65
    v_exp_f32 v68, v68
    v_exp_f32 v69, v69
    v_cvt_pk_bf16_f32 v93, v66, v67
    v_exp_f32 v70, v70
    v_smfmac_f32_16x16x64_bf16 v[140:143], v[176:179], v[96:103], v180
    s_waitcnt lgkmcnt(0)
    v_exp_f32 v71, v71
    v_cvt_pk_bf16_f32 v94, v68, v69
    v_cvt_pk_bf16_f32 v95, v70, v71
    v_mfma_f32_32x32x16_bf16 v[56:71], v[144:147], v[200:203], v[24:39]
    v_exp_f32 v72, v72
    v_exp_f32 v73, v73
    v_exp_f32 v74, v74
    v_exp_f32 v75, v75
    v_mfma_f32_32x32x16_bf16 v[56:71], v[148:151], v[204:207], v[56:71]
    ds_read_b128 v[168:171], v2 offset:14336
    v_cvt_pk_bf16_f32 v96, v72, v73
    v_exp_f32 v76, v76
    v_exp_f32 v77, v77
    v_cvt_pk_bf16_f32 v97, v74, v75
    v_exp_f32 v78, v78
    v_exp_f32 v79, v79
    v_mfma_f32_32x32x16_bf16 v[104:119], v[160:163], v[88:91], v[104:119]
    ds_read_b128 v[172:175], v2 offset:15360
    v_cvt_pk_bf16_f32 v98, v76, v77
    v_exp_f32 v80, v80
    v_exp_f32 v81, v81
    v_cvt_pk_bf16_f32 v99, v78, v79
    v_exp_f32 v82, v82
    v_exp_f32 v83, v83
    v_mfma_f32_32x32x16_bf16 v[104:119], v[164:167], v[92:95], v[104:119]
    v_cvt_pk_bf16_f32 v100, v80, v81
    v_exp_f32 v84, v84
    v_exp_f32 v85, v85
    v_cvt_pk_bf16_f32 v101, v82, v83
    v_exp_f32 v86, v86
    v_smfmac_f32_16x16x64_bf16 v[136:139], v[176:179], v[88:95], v180
    v_exp_f32 v87, v87
    v_cvt_pk_bf16_f32 v102, v84, v85
    v_cvt_pk_bf16_f32 v103, v86, v87
    v_mfma_f32_32x32x16_bf16 v[72:87], v[144:147], v[208:211], v[40:55]
    v_exp_f32 v56, v56
    v_exp_f32 v57, v57
    v_exp_f32 v58, v58
    v_exp_f32 v59, v59
    v_mfma_f32_32x32x16_bf16 v[72:87], v[148:151], v[212:215], v[72:87]
    v_cvt_pk_bf16_f32 v88, v56, v57
    v_exp_f32 v60, v60
    v_exp_f32 v61, v61
    v_cvt_pk_bf16_f32 v89, v58, v59
    v_exp_f32 v62, v62
    v_exp_f32 v63, v63
    v_mfma_f32_32x32x16_bf16 v[120:135], v[160:163], v[96:99], v[120:135]
    v_cvt_pk_bf16_f32 v90, v60, v61
    v_exp_f32 v64, v64
    v_exp_f32 v65, v65
    v_cvt_pk_bf16_f32 v91, v62, v63
    v_exp_f32 v66, v66
    v_exp_f32 v67, v67
    v_mfma_f32_32x32x16_bf16 v[120:135], v[164:167], v[100:103], v[120:135]
    v_cvt_pk_bf16_f32 v92, v64, v65
    v_exp_f32 v68, v68
    v_exp_f32 v69, v69
    v_cvt_pk_bf16_f32 v93, v66, v67
    v_exp_f32 v70, v70
    v_smfmac_f32_16x16x64_bf16 v[140:143], v[176:179], v[96:103], v180
    s_waitcnt lgkmcnt(0)
    v_exp_f32 v71, v71
    v_cvt_pk_bf16_f32 v94, v68, v69
    v_cvt_pk_bf16_f32 v95, v70, v71
    v_exp_f32 v72, v72
    v_exp_f32 v73, v73
    v_exp_f32 v74, v74
    v_exp_f32 v75, v75
    v_cvt_pk_bf16_f32 v96, v72, v73
    v_exp_f32 v76, v76
    v_exp_f32 v77, v77
    v_cvt_pk_bf16_f32 v97, v74, v75
    v_exp_f32 v78, v78
    v_exp_f32 v79, v79
    v_mfma_f32_32x32x16_bf16 v[104:119], v[168:171], v[88:91], v[104:119]
    v_cvt_pk_bf16_f32 v98, v76, v77
    v_exp_f32 v80, v80
    v_exp_f32 v81, v81
    v_cvt_pk_bf16_f32 v99, v78, v79
    v_exp_f32 v82, v82
    v_exp_f32 v83, v83
    v_mfma_f32_32x32x16_bf16 v[104:119], v[172:175], v[92:95], v[104:119]
    v_cvt_pk_bf16_f32 v100, v80, v81
    v_exp_f32 v84, v84
    v_exp_f32 v85, v85
    v_cvt_pk_bf16_f32 v101, v82, v83
    v_exp_f32 v86, v86
    v_smfmac_f32_16x16x64_bf16 v[136:139], v[176:179], v[88:95], v180
    v_exp_f32 v87, v87
    v_cvt_pk_bf16_f32 v102, v84, v85
    v_cvt_pk_bf16_f32 v103, v86, v87
    s_nop 0
    v_mfma_f32_32x32x16_bf16 v[120:135], v[168:171], v[96:99], v[120:135]
    v_mfma_f32_32x32x16_bf16 v[120:135], v[172:175], v[100:103], v[120:135]
    v_smfmac_f32_16x16x64_bf16 v[140:143], v[176:179], v[96:103], v180
    v_and_b32 v184, 16, v9
    v_cmp_eq_u32 vcc, 0, v184
    s_nop 7
    v_add_f32 v136, v136, v137
    v_add_f32 v138, v138, v139
    v_cndmask_b32 v136, v138, v136, vcc
    v_add_f32 v140, v140, v141
    v_add_f32 v142, v142, v143
    v_cndmask_b32 v140, v142, v140, vcc
    s_cmp_lg_u32 s29, 1
    s_cbranch_scc1 p2_afin
    v_add_f32 v184, v136, v140
    s_mov_b32 s12, 0x5d800000
    v_cmp_ngt_f32 vcc, s12, v184
    v_mov_b32 v184, 158208
    s_nop 3
    s_cbranch_vccz p2_nobad
    ds_write_b32 v184, v3
p2_nobad:
    s_waitcnt vmcnt(0) lgkmcnt(0)
    s_add_u32 s34, s34, 4
    ds_add_u32 v7, v3
a_s1_s:
    ds_read_b32 v5, v7
    s_waitcnt lgkmcnt(0)
    v_readfirstlane_b32 s12, v5
    s_cmp_ge_u32 s12, s34
    s_cbranch_scc0 a_s1_s
    ds_read_b32 v185, v184
    s_waitcnt lgkmcnt(0)
    v_readfirstlane_b32 s12, v185
    s_cmp_eq_u32 s12, 0
    s_cbranch_scc1 p2_afin
    s_mov_b32 s29, 64
    s_mov_b32 s16, 16
    v_mov_b32 v188, 0xff800000
    v_mov_b32 v189, 0xff800000
    s_mov_b32 s28, 64
    s_mov_b32 s12, s33
p2_maxloop:
    buffer_load_dwordx4 v[152:155], v4, s[36:39], s12 offen offset:0 sc1
    buffer_load_dwordx4 v[156:159], v4, s[36:39], s12 offen offset:1024 sc1
    s_waitcnt vmcnt(0)
    v_mfma_f32_32x32x16_bf16 v[56:71], v[152:155], v[200:203], 0
    v_mfma_f32_32x32x16_bf16 v[56:71], v[156:159], v[204:207], v[56:71]
    v_mfma_f32_32x32x16_bf16 v[72:87], v[152:155], v[208:211], 0
    v_mfma_f32_32x32x16_bf16 v[72:87], v[156:159], v[212:215], v[72:87]
    s_nop 15
    v_max3_f32 v188, v56, v57, v188
    v_max3_f32 v188, v58, v59, v188
    v_max3_f32 v188, v60, v61, v188
    v_max3_f32 v188, v62, v63, v188
    v_max3_f32 v188, v64, v65, v188
    v_max3_f32 v188, v66, v67, v188
    v_max3_f32 v188, v68, v69, v188
    v_max3_f32 v188, v70, v71, v188
    v_max3_f32 v189, v72, v73, v189
    v_max3_f32 v189, v74, v75, v189
    v_max3_f32 v189, v76, v77, v189
    v_max3_f32 v189, v78, v79, v189
    v_max3_f32 v189, v80, v81, v189
    v_max3_f32 v189, v82, v83, v189
    v_max3_f32 v189, v84, v85, v189
    v_max3_f32 v189, v86, v87, v189
    s_add_u32 s12, s12, 2048
    s_sub_u32 s28, s28, 1
    s_cmp_lg_u32 s28, 0
    s_cbranch_scc1 p2_maxloop
    v_mov_b32 v190, v188
    s_nop 1
    v_permlane32_swap_b32 v188, v190
    s_nop 1
    v_max_f32 v188, v188, v190
    v_sub_f32 v24, 0, v188
    v_sub_f32 v25, 0, v188
    v_sub_f32 v26, 0, v188
    v_sub_f32 v27, 0, v188
    v_sub_f32 v28, 0, v188
    v_sub_f32 v29, 0, v188
    v_sub_f32 v30, 0, v188
    v_sub_f32 v31, 0, v188
    v_sub_f32 v32, 0, v188
    v_sub_f32 v33, 0, v188
    v_sub_f32 v34, 0, v188
    v_sub_f32 v35, 0, v188
    v_sub_f32 v36, 0, v188
    v_sub_f32 v37, 0, v188
    v_sub_f32 v38, 0, v188
    v_sub_f32 v39, 0, v188
    v_mov_b32 v190, v189
    s_nop 1
    v_permlane32_swap_b32 v189, v190
    s_nop 1
    v_max_f32 v189, v189, v190
    v_sub_f32 v40, 0, v189
    v_sub_f32 v41, 0, v189
    v_sub_f32 v42, 0, v189
    v_sub_f32 v43, 0, v189
    v_sub_f32 v44, 0, v189
    v_sub_f32 v45, 0, v189
    v_sub_f32 v46, 0, v189
    v_sub_f32 v47, 0, v189
    v_sub_f32 v48, 0, v189
    v_sub_f32 v49, 0, v189
    v_sub_f32 v50, 0, v189
    v_sub_f32 v51, 0, v189
    v_sub_f32 v52, 0, v189
    v_sub_f32 v53, 0, v189
    v_sub_f32 v54, 0, v189
    v_sub_f32 v55, 0, v189
    s_branch p2_restart
p2_afin:
    v_rcp_f32 v136, v136
    v_rcp_f32 v140, v140
    v_bfe_u32 v184, v9, 3, 1
    v_lshlrev_b32 v184, 10, v184
    v_lshrrev_b32 v185, 4, v9
    v_lshl_add_u32 v184, v185, 7, v184
    v_and_b32 v185, 7, v9
    v_lshl_add_u32 v184, v185, 4, v184
    s_lshl_b32 s12, s32, 1
    s_lshr_b32 s13, s3, 1
    s_add_u32 s12, s12, s13
    s_mul_i32 s12, s12, 720896
    s_lshl_b32 s13, s31, 13
    s_add_u32 s12, s12, s13
    s_and_b32 s13, s3, 1
    s_lshl_b32 s13, s13, 12
    s_add_u32 s12, s12, s13
    s_add_u32 s12, s12, 0x2000000
    v_mul_f32 v104, v104, v136
    v_mul_f32 v105, v105, v136
    v_mul_f32 v106, v106, v136
    v_mul_f32 v107, v107, v136
    v_mul_f32 v108, v108, v136
    v_mul_f32 v109, v109, v136
    v_mul_f32 v110, v110, v136
    v_mul_f32 v111, v111, v136
    v_mul_f32 v112, v112, v136
    v_mul_f32 v113, v113, v136
    v_mul_f32 v114, v114, v136
    v_mul_f32 v115, v115, v136
    v_mul_f32 v116, v116, v136
    v_mul_f32 v117, v117, v136
    v_mul_f32 v118, v118, v136
    v_mul_f32 v119, v119, v136
    v_cvt_pk_bf16_f32 v56, v104, v105
    v_cvt_pk_bf16_f32 v57, v106, v107
    v_cvt_pk_bf16_f32 v58, v112, v113
    v_cvt_pk_bf16_f32 v59, v114, v115
    buffer_store_dwordx4 v[56:59], v184, s[36:39], s12 offen offset:0 sc1
    v_cvt_pk_bf16_f32 v60, v108, v109
    v_cvt_pk_bf16_f32 v61, v110, v111
    v_cvt_pk_bf16_f32 v62, v116, v117
    v_cvt_pk_bf16_f32 v63, v118, v119
    buffer_store_dwordx4 v[60:63], v184, s[36:39], s12 offen offset:512 sc1
    v_mul_f32 v120, v120, v140
    v_mul_f32 v121, v121, v140
    v_mul_f32 v122, v122, v140
    v_mul_f32 v123, v123, v140
    v_mul_f32 v124, v124, v140
    v_mul_f32 v125, v125, v140
    v_mul_f32 v126, v126, v140
    v_mul_f32 v127, v127, v140
    v_mul_f32 v128, v128, v140
    v_mul_f32 v129, v129, v140
    v_mul_f32 v130, v130, v140
    v_mul_f32 v131, v131, v140
    v_mul_f32 v132, v132, v140
    v_mul_f32 v133, v133, v140
    v_mul_f32 v134, v134, v140
    v_mul_f32 v135, v135, v140
    v_cvt_pk_bf16_f32 v72, v120, v121
    v_cvt_pk_bf16_f32 v73, v122, v123
    v_cvt_pk_bf16_f32 v74, v128, v129
    v_cvt_pk_bf16_f32 v75, v130, v131
    buffer_store_dwordx4 v[72:75], v184, s[36:39], s12 offen offset:2048 sc1
    v_cvt_pk_bf16_f32 v76, v124, v125
    v_cvt_pk_bf16_f32 v77, v126, v127
    v_cvt_pk_bf16_f32 v78, v132, v133
    v_cvt_pk_bf16_f32 v79, v134, v135
    buffer_store_dwordx4 v[76:79], v184, s[36:39], s12 offen offset:2560 sc1
    s_lshl_b32 s14, s31, 3
    s_add_u32 s14, s14, s32
    s_lshl_b32 s14, s14, 7
    s_add_u32 s14, s14, 0x2f18000
    s_mov_b32 s15, 158220
    s_branch m_out
m_zwave:
    s_mov_b32 s40, s16
    s_mov_b32 s41, s17
    s_mov_b32 s42, 0x700000
    s_mov_b32 s43, 0x20000
    s_cmp_lg_u32 s3, 4
    s_cbranch_scc1 tk_done
    s_or_b32 s16, s2, 0x100
    v_mov_b32 v10, 1536
    v_mov_b32 v11, s16
    ds_write_b32 v10, v11
tk_done:
    v_cmp_gt_u32 vcc, 16, v9
    v_mov_b32 v11, 0x40000000
    v_lshlrev_b32 v229, 7, v9
    s_lshl_b32 s8, s2, 13
    s_lshl_b32 s17, s7, 11
    v_cndmask_b32 v229, v11, v229, vcc
    s_add_u32 s8, s8, s17
    s_mov_b32 s12, s10
    s_mov_b32 s13, s11
    s_mov_b32 s20, s10
    s_mov_b32 s21, s11
    s_mov_b32 s22, 0x600000
    s_mov_b32 s23, 0x20000
    buffer_load_dword v248, v229, s[40:43], s8 offen
    buffer_load_dword v249, v229, s[20:23], s8 offen
    s_add_u32 s8, s8, 0x200000
    buffer_load_dword v250, v229, s[96:99], s17 offen
    v_mov_b32 v10, 1536
z_idw:
    ds_read_b32 v11, v10
    s_waitcnt lgkmcnt(0)
    v_readfirstlane_b32 s6, v11
    s_cmp_lg_u32 s6, 0
    s_cbranch_scc1 z_idd
    s_sleep 1
    s_branch z_idw
z_idd:
    s_and_b32 s5, s6, 7
    s_bfe_u32 s6, s6, 0x50003
    s_and_b32 s26, s5, 1
    s_lshl_b32 s26, s26, 2
    s_lshr_b32 s27, s6, 3
    s_add_u32 s24, s26, s27
    s_lshr_b32 s26, s5, 1
    s_lshl_b32 s26, s26, 3
    s_and_b32 s27, s6, 7
    s_add_u32 s25, s26, s27
    s_bfe_u32 s26, s6, 0x10002
    s_lshl_b32 s27, s26, 1
    s_lshr_b32 s25, s5, 1
    s_add_u32 s27, s27, s25
    s_and_b32 s27, s27, 3
    s_lshl_b32 s27, s27, 2
    s_lshl_b32 s26, s26, 4
    s_add_u32 s27, s27, s26
    s_and_b32 s26, s6, 3
    s_add_u32 s25, s27, s26
    v_lshlrev_b32 v10, 4, v9
    s_lshl_b32 s30, s3, 11
    v_add_u32 v5, s30, v10
    s_lshl_b32 s28, s24, 19
    s_lshl_b32 s17, s7, 12
    v_add_u32 v1, s17, v10
    v_bfe_u32 v11, v9, 2, 2
    v_and_b32 v12, 3, v9
    v_bfe_u32 v13, v9, 4, 1
    v_lshrrev_b32 v14, 5, v9
    v_lshlrev_b32 v15, 11, v14
    v_lshl_add_u32 v15, v12, 3, v15
    s_mov_b32 s29, 0
    s_lshl_b32 s17, s7, 11
    s_add_u32 s31, s17, 24576
    v_lshl_add_u32 v96, v13, 2, v11
    v_mul_u32_u24 v96, 224, v96
    v_add_u32 v2, v15, v96
    s_mul_i32 s20, s7, 57344
    s_mul_i32 s17, s25, 224
    s_add_u32 s20, s20, s17
    s_and_b32 s21, s25, 1
    s_lshl_b32 s21, s21, 1
    v_add_u32 v96, 0, v9
    v_mul_u32_u24 v98, 147, v96
    v_lshrrev_b32 v98, 11, v98
    v_mul_u32_u24 v99, 14, v98
    v_sub_u32 v99, v96, v99
    v_add_u32 v99, s21, v99
    v_cmp_le_u32 vcc, 14, v99
    v_subrev_u32 v97, 14, v99
    s_nop 0
    v_cndmask_b32 v99, v99, v97, vcc
    v_mul_u32_u24 v98, 7168, v98
    v_lshl_add_u32 v98, v99, 4, v98
    v_add_u32 v98, s20, v98
    v_mov_b32 v100, 0x40000000
    v_cmp_le_u32 vcc, 112, v96
    s_nop 1
    v_cndmask_b32 v6, v98, v100, vcc
    v_add_u32 v96, 64, v9
    v_mul_u32_u24 v98, 147, v96
    v_lshrrev_b32 v98, 11, v98
    v_mul_u32_u24 v99, 14, v98
    v_sub_u32 v99, v96, v99
    v_add_u32 v99, s21, v99
    v_cmp_le_u32 vcc, 14, v99
    v_subrev_u32 v97, 14, v99
    s_nop 0
    v_cndmask_b32 v99, v99, v97, vcc
    v_mul_u32_u24 v98, 7168, v98
    v_lshl_add_u32 v98, v99, 4, v98
    v_add_u32 v98, s20, v98
    v_subrev_u32 v98, 1024, v98
    v_mov_b32 v100, 0x40000000
    v_cmp_le_u32 vcc, 112, v96
    s_nop 1
    v_cndmask_b32 v7, v98, v100, vcc
    s_lshl_b32 s35, s25, 3
    s_add_u32 s35, s35, s24
    s_lshl_b32 s15, s35, 7
    s_add_u32 s15, s15, 0x2f10000
    s_and_b32 s33, s6, 1
    s_mov_b32 s20, s12
    s_mov_b32 s21, s13
    s_mov_b32 s22, 0x600000
    s_mov_b32 s23, 0x20000
    s_cmp_ge_u32 s25, 16
    s_cbranch_scc1 m_z2wave
    v_mov_b32 v104, 0
    v_mov_b32 v105, 0
    v_mov_b32 v106, 0
    v_mov_b32 v107, 0
    v_mov_b32 v108, 0
    v_mov_b32 v109, 0
    v_mov_b32 v110, 0
    v_mov_b32 v111, 0
    v_mov_b32 v112, 0
    v_mov_b32 v113, 0
    v_mov_b32 v114, 0
    v_mov_b32 v115, 0
    v_mov_b32 v116, 0
    v_mov_b32 v117, 0
    v_mov_b32 v118, 0
    v_mov_b32 v119, 0
    v_mov_b32 v120, 0
    v_mov_b32 v121, 0
    v_mov_b32 v122, 0
    v_mov_b32 v123, 0
    v_mov_b32 v124, 0
    v_mov_b32 v125, 0
    v_mov_b32 v126, 0
    v_mov_b32 v127, 0
    v_mov_b32 v128, 0
    v_mov_b32 v129, 0
    v_mov_b32 v130, 0
    v_mov_b32 v131, 0
    v_mov_b32 v132, 0
    v_mov_b32 v133, 0
    v_mov_b32 v134, 0
    v_mov_b32 v135, 0
    v_mov_b32 v136, 0
    v_mov_b32 v137, 0
    v_mov_b32 v138, 0
    v_mov_b32 v139, 0
    v_mov_b32 v140, 0
    v_mov_b32 v141, 0
    v_mov_b32 v142, 0
    v_mov_b32 v143, 0
    v_mov_b32 v144, 0
    v_mov_b32 v145, 0
    v_mov_b32 v146, 0
    v_mov_b32 v147, 0
    v_mov_b32 v148, 0
    v_mov_b32 v149, 0
    v_mov_b32 v150, 0
    v_mov_b32 v151, 0
    v_mov_b32 v152, 0
    v_mov_b32 v153, 0
    v_mov_b32 v154, 0
    v_mov_b32 v155, 0
    v_mov_b32 v156, 0
    v_mov_b32 v157, 0
    v_mov_b32 v158, 0
    v_mov_b32 v159, 0
    v_mov_b32 v160, 0
    v_mov_b32 v161, 0
    v_mov_b32 v162, 0
    v_mov_b32 v163, 0
    v_mov_b32 v164, 0
    v_mov_b32 v165, 0
    v_mov_b32 v166, 0
    v_mov_b32 v167, 0
    v_mov_b32 v168, 0
    v_mov_b32 v169, 0
    v_mov_b32 v170, 0
    v_mov_b32 v171, 0
    v_mov_b32 v172, 0
    v_mov_b32 v173, 0
    v_mov_b32 v174, 0
    v_mov_b32 v175, 0
    v_mov_b32 v176, 0
    v_mov_b32 v177, 0
    v_mov_b32 v178, 0
    v_mov_b32 v179, 0
    v_mov_b32 v180, 0
    v_mov_b32 v181, 0
    v_mov_b32 v182, 0
    v_mov_b32 v183, 0
    v_mov_b32 v184, 0
    v_mov_b32 v185, 0
    v_mov_b32 v186, 0
    v_mov_b32 v187, 0
    v_mov_b32 v188, 0
    v_mov_b32 v189, 0
    v_mov_b32 v190, 0
    v_mov_b32 v191, 0
    v_mov_b32 v192, 0
    v_mov_b32 v193, 0
    v_mov_b32 v194, 0
    v_mov_b32 v195, 0
    v_mov_b32 v196, 0
    v_mov_b32 v197, 0
    v_mov_b32 v198, 0
    v_mov_b32 v199, 0
    v_mov_b32 v200, 0
    v_mov_b32 v201, 0
    v_mov_b32 v202, 0
    v_mov_b32 v203, 0
    v_mov_b32 v204, 0
    v_mov_b32 v205, 0
    v_mov_b32 v206, 0
    v_mov_b32 v207, 0
    v_mov_b32 v208, 0
    v_mov_b32 v209, 0
    v_mov_b32 v210, 0
    v_mov_b32 v211, 0
    v_mov_b32 v212, 0
    v_mov_b32 v213, 0
    v_mov_b32 v214, 0
    v_mov_b32 v215, 0
    v_mov_b32 v3, v1
    v_mov_b32 v4, v2
    s_mov_b32 s26, 0
    s_mov_b32 s27, 0
    s_add_u32 m0, s27, s31
    s_nop 0
    buffer_load_dwordx4 v6, s[40:43], s29 offen lds
    buffer_load_dwordx4 v7, s[40:43], s29 offen offset:1024 lds
    s_add_u32 s29, s29, 229376
    s_mov_b32 s27, 32768
    s_add_u32 m0, s27, s31
    s_nop 0
    buffer_load_dwordx4 v6, s[40:43], s29 offen lds
    buffer_load_dwordx4 v7, s[40:43], s29 offen offset:1024 lds
    s_add_u32 s29, s29, 229376
    s_mov_b32 s27, 65536
    s_add_u32 m0, s27, s31
    s_nop 0
    buffer_load_dwordx4 v6, s[40:43], s29 offen lds
    buffer_load_dwordx4 v7, s[40:43], s29 offen offset:1024 lds
    s_add_u32 s29, s29, 229376
    s_mov_b32 s27, 98304
    s_add_u32 m0, s27, s31
    s_nop 0
    buffer_load_dwordx4 v6, s[40:43], s29 offen lds
    buffer_load_dwordx4 v7, s[40:43], s29 offen offset:1024 lds
    s_add_u32 s29, s29, 229376
    s_mov_b32 s27, 131072
    s_add_u32 m0, s27, s31
    s_nop 0
    buffer_load_dwordx4 v6, s[40:43], s29 offen lds
    buffer_load_dwordx4 v7, s[40:43], s29 offen offset:1024 lds
    s_add_u32 s29, s29, 229376
    s_barrier
    s_mov_b32 s27, 0
    s_add_u32 m0, s27, s30
    s_nop 0
    buffer_load_dwordx4 v5, s[36:39], s28 offen offset:0 sc1 lds
    buffer_load_dwordx4 v5, s[36:39], s28 offen offset:1024 sc1 lds
    s_add_u32 s28, s28, 16384
    s_barrier
    s_mov_b32 s27, 32768
    s_add_u32 m0, s27, s30
    s_nop 0
    buffer_load_dwordx4 v5, s[36:39], s28 offen offset:0 sc1 lds
    buffer_load_dwordx4 v5, s[36:39], s28 offen offset:1024 sc1 lds
    s_add_u32 s28, s28, 16384
    s_mov_b32 s27, 65536
    s_add_u32 m0, s27, s30
    s_nop 0
    buffer_load_dwordx4 v5, s[36:39], s28 offen offset:0 sc1 lds
    buffer_load_dwordx4 v5, s[36:39], s28 offen offset:1024 sc1 lds
    s_add_u32 s28, s28, 16384
    s_waitcnt vmcnt(4)
    s_barrier
    ds_read_b64_tr_b16 v[48:49], v4 offset:24576
    ds_read_b64_tr_b16 v[50:51], v4 offset:28672
    ds_read_b128 v[16:19], v3 offset:0
    ds_read_b128 v[20:23], v3 offset:1024
    ds_read_b128 v[24:27], v3 offset:2048
    ds_read_b128 v[28:31], v3 offset:3072
    ds_read_b64_tr_b16 v[52:53], v4 offset:24608
    ds_read_b64_tr_b16 v[54:55], v4 offset:28704
    ds_read_b64_tr_b16 v[56:57], v4 offset:24640
    ds_read_b64_tr_b16 v[58:59], v4 offset:28736
    ds_read_b64_tr_b16 v[60:61], v4 offset:24672
    ds_read_b64_tr_b16 v[62:63], v4 offset:28768
    ds_read_b64_tr_b16 v[64:65], v4 offset:24704
    ds_read_b64_tr_b16 v[66:67], v4 offset:28800
    ds_read_b64_tr_b16 v[68:69], v4 offset:24736
    ds_read_b64_tr_b16 v[70:71], v4 offset:28832
    ds_read_b64_tr_b16 v[72:73], v4 offset:24768
    ds_read_b64_tr_b16 v[74:75], v4 offset:28864
    s_mov_b32 s27, s26
    s_add_u32 s26, s26, 32768
    s_cmp_eq_u32 s26, 163840
    s_cselect_b32 s26, 0, s26
    v_add_u32 v3, s26, v1
    v_add_u32 v4, s26, v2
    s_waitcnt vmcnt(2) lgkmcnt(0)
    s_barrier
    v_mfma_f32_16x16x32_bf16 v[104:107], v[48:51], v[16:19], v[104:107]
    ds_read_b64_tr_b16 v[76:77], v4 offset:24576
    s_mov_b32 s27, 98304
    s_add_u32 m0, s27, s30
    v_mfma_f32_16x16x32_bf16 v[108:111], v[48:51], v[20:23], v[108:111]
    ds_read_b64_tr_b16 v[78:79], v4 offset:28672
    buffer_load_dwordx4 v5, s[36:39], s28 offen offset:0 sc1 lds
    v_mfma_f32_16x16x32_bf16 v[112:115], v[48:51], v[24:27], v[112:115]
    ds_read_b128 v[32:35], v3 offset:0
    v_mfma_f32_16x16x32_bf16 v[116:119], v[48:51], v[28:31], v[116:119]
    ds_read_b128 v[36:39], v3 offset:1024
    buffer_load_dwordx4 v5, s[36:39], s28 offen offset:1024 sc1 lds
    v_mfma_f32_16x16x32_bf16 v[120:123], v[52:55], v[16:19], v[120:123]
    ds_read_b128 v[40:43], v3 offset:2048
    s_add_u32 s28, s28, 16384
    s_mov_b32 s27, 131072
    s_add_u32 m0, s27, s30
    v_mfma_f32_16x16x32_bf16 v[124:127], v[52:55], v[20:23], v[124:127]
    ds_read_b128 v[44:47], v3 offset:3072
    buffer_load_dwordx4 v5, s[36:39], s28 offen offset:0 sc1 lds
    v_mfma_f32_16x16x32_bf16 v[128:131], v[52:55], v[24:27], v[128:131]
    ds_read_b64_tr_b16 v[80:81], v4 offset:24608
    v_mfma_f32_16x16x32_bf16 v[132:135], v[52:55], v[28:31], v[132:135]
    ds_read_b64_tr_b16 v[82:83], v4 offset:28704
    v_mfma_f32_16x16x32_bf16 v[136:139], v[56:59], v[16:19], v[136:139]
    ds_read_b64_tr_b16 v[84:85], v4 offset:24640
    buffer_load_dwordx4 v5, s[36:39], s28 offen offset:1024 sc1 lds
    v_mfma_f32_16x16x32_bf16 v[140:143], v[56:59], v[20:23], v[140:143]
    ds_read_b64_tr_b16 v[86:87], v4 offset:28736
    s_add_u32 s28, s28, 16384
    s_mov_b32 s27, 0
    s_add_u32 m0, s27, s30
    v_mfma_f32_16x16x32_bf16 v[144:147], v[56:59], v[24:27], v[144:147]
    ds_read_b64_tr_b16 v[88:89], v4 offset:24672
    buffer_load_dwordx4 v5, s[36:39], s28 offen offset:0 sc1 lds
    v_mfma_f32_16x16x32_bf16 v[148:151], v[56:59], v[28:31], v[148:151]
    ds_read_b64_tr_b16 v[90:91], v4 offset:28768
    v_mfma_f32_16x16x32_bf16 v[152:155], v[60:63], v[16:19], v[152:155]
    ds_read_b64_tr_b16 v[92:93], v4 offset:24704
    buffer_load_dwordx4 v5, s[36:39], s28 offen offset:1024 sc1 lds
    v_mfma_f32_16x16x32_bf16 v[156:159], v[60:63], v[20:23], v[156:159]
    ds_read_b64_tr_b16 v[94:95], v4 offset:28800
    s_add_u32 s28, s28, 16384
    v_mfma_f32_16x16x32_bf16 v[160:163], v[60:63], v[24:27], v[160:163]
    ds_read_b64_tr_b16 v[96:97], v4 offset:24736
    s_add_u32 m0, s27, s31
    v_mfma_f32_16x16x32_bf16 v[164:167], v[60:63], v[28:31], v[164:167]
    ds_read_b64_tr_b16 v[98:99], v4 offset:28832
    buffer_load_dwordx4 v6, s[40:43], s29 offen lds
    v_mfma_f32_16x16x32_bf16 v[168:171], v[64:67], v[16:19], v[168:171]
    ds_read_b64_tr_b16 v[100:101], v4 offset:24768
    v_mfma_f32_16x16x32_bf16 v[172:175], v[64:67], v[20:23], v[172:175]
    ds_read_b64_tr_b16 v[102:103], v4 offset:28864
    buffer_load_dwordx4 v7, s[40:43], s29 offen offset:1024 lds
    v_mfma_f32_16x16x32_bf16 v[176:179], v[64:67], v[24:27], v[176:179]
    s_add_u32 s29, s29, 229376
    v_mfma_f32_16x16x32_bf16 v[180:183], v[64:67], v[28:31], v[180:183]
    v_mfma_f32_16x16x32_bf16 v[184:187], v[68:71], v[16:19], v[184:187]
    s_mov_b32 s27, s26
    s_add_u32 s26, s26, 32768
    v_mfma_f32_16x16x32_bf16 v[188:191], v[68:71], v[20:23], v[188:191]
    s_cmp_eq_u32 s26, 163840
    s_cselect_b32 s26, 0, s26
    v_mfma_f32_16x16x32_bf16 v[192:195], v[68:71], v[24:27], v[192:195]
    v_add_u32 v3, s26, v1
    v_add_u32 v4, s26, v2
    v_mfma_f32_16x16x32_bf16 v[196:199], v[68:71], v[28:31], v[196:199]
    s_waitcnt vmcnt(8) lgkmcnt(0)
    s_barrier
    v_mfma_f32_16x16x32_bf16 v[200:203], v[72:75], v[16:19], v[200:203]
    v_mfma_f32_16x16x32_bf16 v[204:207], v[72:75], v[20:23], v[204:207]
    v_mfma_f32_16x16x32_bf16 v[208:211], v[72:75], v[24:27], v[208:211]
    v_mfma_f32_16x16x32_bf16 v[212:215], v[72:75], v[28:31], v[212:215]
    v_mfma_f32_16x16x32_bf16 v[104:107], v[76:79], v[32:35], v[104:107]
    ds_read_b64_tr_b16 v[48:49], v4 offset:24576
    v_mfma_f32_16x16x32_bf16 v[108:111], v[76:79], v[36:39], v[108:111]
    ds_read_b64_tr_b16 v[50:51], v4 offset:28672
    v_mfma_f32_16x16x32_bf16 v[112:115], v[76:79], v[40:43], v[112:115]
    ds_read_b128 v[16:19], v3 offset:0
    s_mov_b32 s27, 32768
    s_add_u32 m0, s27, s30
    v_mfma_f32_16x16x32_bf16 v[116:119], v[76:79], v[44:47], v[116:119]
    ds_read_b128 v[20:23], v3 offset:1024
    buffer_load_dwordx4 v5, s[36:39], s28 offen offset:0 sc1 lds
    v_mfma_f32_16x16x32_bf16 v[120:123], v[80:83], v[32:35], v[120:123]
    ds_read_b128 v[24:27], v3 offset:2048
    v_mfma_f32_16x16x32_bf16 v[124:127], v[80:83], v[36:39], v[124:127]
    ds_read_b128 v[28:31], v3 offset:3072
    v_mfma_f32_16x16x32_bf16 v[128:131], v[80:83], v[40:43], v[128:131]
    ds_read_b64_tr_b16 v[52:53], v4 offset:24608
    v_mfma_f32_16x16x32_bf16 v[132:135], v[80:83], v[44:47], v[132:135]
    ds_read_b64_tr_b16 v[54:55], v4 offset:28704
    v_mfma_f32_16x16x32_bf16 v[136:139], v[84:87], v[32:35], v[136:139]
    ds_read_b64_tr_b16 v[56:57], v4 offset:24640
    v_mfma_f32_16x16x32_bf16 v[140:143], v[84:87], v[36:39], v[140:143]
    ds_read_b64_tr_b16 v[58:59], v4 offset:28736
    buffer_load_dwordx4 v5, s[36:39], s28 offen offset:1024 sc1 lds
    v_mfma_f32_16x16x32_bf16 v[144:147], v[84:87], v[40:43], v[144:147]
    ds_read_b64_tr_b16 v[60:61], v4 offset:24672
    s_add_u32 s28, s28, 16384
    v_mfma_f32_16x16x32_bf16 v[148:151], v[84:87], v[44:47], v[148:151]
    ds_read_b64_tr_b16 v[62:63], v4 offset:28768
    v_mfma_f32_16x16x32_bf16 v[152:155], v[88:91], v[32:35], v[152:155]
    ds_read_b64_tr_b16 v[64:65], v4 offset:24704
    v_mfma_f32_16x16x32_bf16 v[156:159], v[88:91], v[36:39], v[156:159]
    ds_read_b64_tr_b16 v[66:67], v4 offset:28800
    s_add_u32 m0, s27, s31
    v_mfma_f32_16x16x32_bf16 v[160:163], v[88:91], v[40:43], v[160:163]
    ds_read_b64_tr_b16 v[68:69], v4 offset:24736
    buffer_load_dwordx4 v6, s[40:43], s29 offen lds
    v_mfma_f32_16x16x32_bf16 v[164:167], v[88:91], v[44:47], v[164:167]
    ds_read_b64_tr_b16 v[70:71], v4 offset:28832
    v_mfma_f32_16x16x32_bf16 v[168:171], v[92:95], v[32:35], v[168:171]
    ds_read_b64_tr_b16 v[72:73], v4 offset:24768
    v_mfma_f32_16x16x32_bf16 v[172:175], v[92:95], v[36:39], v[172:175]
    ds_read_b64_tr_b16 v[74:75], v4 offset:28864
    v_mfma_f32_16x16x32_bf16 v[176:179], v[92:95], v[40:43], v[176:179]
    v_mfma_f32_16x16x32_bf16 v[180:183], v[92:95], v[44:47], v[180:183]
    buffer_load_dwordx4 v7, s[40:43], s29 offen offset:1024 lds
    v_mfma_f32_16x16x32_bf16 v[184:187], v[96:99], v[32:35], v[184:187]
    s_add_u32 s29, s29, 229376
    s_mov_b32 s27, s26
    s_add_u32 s26, s26, 32768
    v_mfma_f32_16x16x32_bf16 v[188:191], v[96:99], v[36:39], v[188:191]
    s_cmp_eq_u32 s26, 163840
    s_cselect_b32 s26, 0, s26
    v_mfma_f32_16x16x32_bf16 v[192:195], v[96:99], v[40:43], v[192:195]
    v_add_u32 v3, s26, v1
    v_add_u32 v4, s26, v2
    v_mfma_f32_16x16x32_bf16 v[196:199], v[96:99], v[44:47], v[196:199]
    s_waitcnt vmcnt(10) lgkmcnt(0)
    s_barrier
    v_mfma_f32_16x16x32_bf16 v[200:203], v[100:103], v[32:35], v[200:203]
    v_mfma_f32_16x16x32_bf16 v[204:207], v[100:103], v[36:39], v[204:207]
    v_mfma_f32_16x16x32_bf16 v[208:211], v[100:103], v[40:43], v[208:211]
    v_mfma_f32_16x16x32_bf16 v[212:215], v[100:103], v[44:47], v[212:215]
    v_mfma_f32_16x16x32_bf16 v[104:107], v[48:51], v[16:19], v[104:107]
    ds_read_b64_tr_b16 v[76:77], v4 offset:24576
    v_mfma_f32_16x16x32_bf16 v[108:111], v[48:51], v[20:23], v[108:111]
    ds_read_b64_tr_b16 v[78:79], v4 offset:28672
    v_mfma_f32_16x16x32_bf16 v[112:115], v[48:51], v[24:27], v[112:115]
    ds_read_b128 v[32:35], v3 offset:0
    s_mov_b32 s27, 65536
    s_add_u32 m0, s27, s30
    v_mfma_f32_16x16x32_bf16 v[116:119], v[48:51], v[28:31], v[116:119]
    ds_read_b128 v[36:39], v3 offset:1024
    buffer_load_dwordx4 v5, s[36:39], s28 offen offset:0 sc1 lds
    v_mfma_f32_16x16x32_bf16 v[120:123], v[52:55], v[16:19], v[120:123]
    ds_read_b128 v[40:43], v3 offset:2048
    v_mfma_f32_16x16x32_bf16 v[124:127], v[52:55], v[20:23], v[124:127]
    ds_read_b128 v[44:47], v3 offset:3072
    v_mfma_f32_16x16x32_bf16 v[128:131], v[52:55], v[24:27], v[128:131]
    ds_read_b64_tr_b16 v[80:81], v4 offset:24608
    v_mfma_f32_16x16x32_bf16 v[132:135], v[52:55], v[28:31], v[132:135]
    ds_read_b64_tr_b16 v[82:83], v4 offset:28704
    v_mfma_f32_16x16x32_bf16 v[136:139], v[56:59], v[16:19], v[136:139]
    ds_read_b64_tr_b16 v[84:85], v4 offset:24640
    v_mfma_f32_16x16x32_bf16 v[140:143], v[56:59], v[20:23], v[140:143]
    ds_read_b64_tr_b16 v[86:87], v4 offset:28736
    buffer_load_dwordx4 v5, s[36:39], s28 offen offset:1024 sc1 lds
    v_mfma_f32_16x16x32_bf16 v[144:147], v[56:59], v[24:27], v[144:147]
    ds_read_b64_tr_b16 v[88:89], v4 offset:24672
    s_add_u32 s28, s28, 16384
    v_mfma_f32_16x16x32_bf16 v[148:151], v[56:59], v[28:31], v[148:151]
    ds_read_b64_tr_b16 v[90:91], v4 offset:28768
    v_mfma_f32_16x16x32_bf16 v[152:155], v[60:63], v[16:19], v[152:155]
    ds_read_b64_tr_b16 v[92:93], v4 offset:24704
    v_mfma_f32_16x16x32_bf16 v[156:159], v[60:63], v[20:23], v[156:159]
    ds_read_b64_tr_b16 v[94:95], v4 offset:28800
    s_add_u32 m0, s27, s31
    v_mfma_f32_16x16x32_bf16 v[160:163], v[60:63], v[24:27], v[160:163]
    ds_read_b64_tr_b16 v[96:97], v4 offset:24736
    buffer_load_dwordx4 v6, s[40:43], s29 offen lds
    v_mfma_f32_16x16x32_bf16 v[164:167], v[60:63], v[28:31], v[164:167]
    ds_read_b64_tr_b16 v[98:99], v4 offset:28832
    v_mfma_f32_16x16x32_bf16 v[168:171], v[64:67], v[16:19], v[168:171]
    ds_read_b64_tr_b16 v[100:101], v4 offset:24768
    v_mfma_f32_16x16x32_bf16 v[172:175], v[64:67], v[20:23], v[172:175]
    ds_read_b64_tr_b16 v[102:103], v4 offset:28864
    v_mfma_f32_16x16x32_bf16 v[176:179], v[64:67], v[24:27], v[176:179]
    v_mfma_f32_16x16x32_bf16 v[180:183], v[64:67], v[28:31], v[180:183]
    buffer_load_dwordx4 v7, s[40:43], s29 offen offset:1024 lds
    v_mfma_f32_16x16x32_bf16 v[184:187], v[68:71], v[16:19], v[184:187]
    s_add_u32 s29, s29, 229376
    s_mov_b32 s27, s26
    s_add_u32 s26, s26, 32768
    v_mfma_f32_16x16x32_bf16 v[188:191], v[68:71], v[20:23], v[188:191]
    s_cmp_eq_u32 s26, 163840
    s_cselect_b32 s26, 0, s26
    v_mfma_f32_16x16x32_bf16 v[192:195], v[68:71], v[24:27], v[192:195]
    v_add_u32 v3, s26, v1
    v_add_u32 v4, s26, v2
    v_mfma_f32_16x16x32_bf16 v[196:199], v[68:71], v[28:31], v[196:199]
    s_waitcnt vmcnt(12) lgkmcnt(0)
    s_barrier
    v_mfma_f32_16x16x32_bf16 v[200:203], v[72:75], v[16:19], v[200:203]
    v_mfma_f32_16x16x32_bf16 v[204:207], v[72:75], v[20:23], v[204:207]
    v_mfma_f32_16x16x32_bf16 v[208:211], v[72:75], v[24:27], v[208:211]
    v_mfma_f32_16x16x32_bf16 v[212:215], v[72:75], v[28:31], v[212:215]
    v_mfma_f32_16x16x32_bf16 v[104:107], v[76:79], v[32:35], v[104:107]
    ds_read_b64_tr_b16 v[48:49], v4 offset:24576
    buffer_load_dword v248, v229, s[40:43], s8 offen
    buffer_load_dword v249, v229, s[20:23], s8 offen
    s_add_u32 s8, s8, 0x200000
    v_mfma_f32_16x16x32_bf16 v[108:111], v[76:79], v[36:39], v[108:111]
    ds_read_b64_tr_b16 v[50:51], v4 offset:28672
    v_mfma_f32_16x16x32_bf16 v[112:115], v[76:79], v[40:43], v[112:115]
    ds_read_b128 v[16:19], v3 offset:0
    s_mov_b32 s27, 98304
    s_add_u32 m0, s27, s30
    v_mfma_f32_16x16x32_bf16 v[116:119], v[76:79], v[44:47], v[116:119]
    ds_read_b128 v[20:23], v3 offset:1024
    buffer_load_dwordx4 v5, s[36:39], s28 offen offset:0 sc1 lds
    v_mfma_f32_16x16x32_bf16 v[120:123], v[80:83], v[32:35], v[120:123]
    ds_read_b128 v[24:27], v3 offset:2048
    v_mfma_f32_16x16x32_bf16 v[124:127], v[80:83], v[36:39], v[124:127]
    ds_read_b128 v[28:31], v3 offset:3072
    v_mfma_f32_16x16x32_bf16 v[128:131], v[80:83], v[40:43], v[128:131]
    ds_read_b64_tr_b16 v[52:53], v4 offset:24608
    v_mfma_f32_16x16x32_bf16 v[132:135], v[80:83], v[44:47], v[132:135]
    ds_read_b64_tr_b16 v[54:55], v4 offset:28704
    v_mfma_f32_16x16x32_bf16 v[136:139], v[84:87], v[32:35], v[136:139]
    ds_read_b64_tr_b16 v[56:57], v4 offset:24640
    v_mfma_f32_16x16x32_bf16 v[140:143], v[84:87], v[36:39], v[140:143]
    ds_read_b64_tr_b16 v[58:59], v4 offset:28736
    buffer_load_dwordx4 v5, s[36:39], s28 offen offset:1024 sc1 lds
    v_mfma_f32_16x16x32_bf16 v[144:147], v[84:87], v[40:43], v[144:147]
    ds_read_b64_tr_b16 v[60:61], v4 offset:24672
    s_add_u32 s28, s28, 16384
    v_mfma_f32_16x16x32_bf16 v[148:151], v[84:87], v[44:47], v[148:151]
    ds_read_b64_tr_b16 v[62:63], v4 offset:28768
    v_mfma_f32_16x16x32_bf16 v[152:155], v[88:91], v[32:35], v[152:155]
    ds_read_b64_tr_b16 v[64:65], v4 offset:24704
    v_mfma_f32_16x16x32_bf16 v[156:159], v[88:91], v[36:39], v[156:159]
    ds_read_b64_tr_b16 v[66:67], v4 offset:28800
    s_add_u32 m0, s27, s31
    v_mfma_f32_16x16x32_bf16 v[160:163], v[88:91], v[40:43], v[160:163]
    ds_read_b64_tr_b16 v[68:69], v4 offset:24736
    buffer_load_dwordx4 v6, s[40:43], s29 offen lds
    v_mfma_f32_16x16x32_bf16 v[164:167], v[88:91], v[44:47], v[164:167]
    ds_read_b64_tr_b16 v[70:71], v4 offset:28832
    v_mfma_f32_16x16x32_bf16 v[168:171], v[92:95], v[32:35], v[168:171]
    ds_read_b64_tr_b16 v[72:73], v4 offset:24768
    v_mfma_f32_16x16x32_bf16 v[172:175], v[92:95], v[36:39], v[172:175]
    ds_read_b64_tr_b16 v[74:75], v4 offset:28864
    v_mfma_f32_16x16x32_bf16 v[176:179], v[92:95], v[40:43], v[176:179]
    v_mfma_f32_16x16x32_bf16 v[180:183], v[92:95], v[44:47], v[180:183]
    buffer_load_dwordx4 v7, s[40:43], s29 offen offset:1024 lds
    v_mfma_f32_16x16x32_bf16 v[184:187], v[96:99], v[32:35], v[184:187]
    s_add_u32 s29, s29, 229376
    s_mov_b32 s27, s26
    s_add_u32 s26, s26, 32768
    v_mfma_f32_16x16x32_bf16 v[188:191], v[96:99], v[36:39], v[188:191]
    s_cmp_eq_u32 s26, 163840
    s_cselect_b32 s26, 0, s26
    v_mfma_f32_16x16x32_bf16 v[192:195], v[96:99], v[40:43], v[192:195]
    v_add_u32 v3, s26, v1
    v_add_u32 v4, s26, v2
    v_mfma_f32_16x16x32_bf16 v[196:199], v[96:99], v[44:47], v[196:199]
    s_waitcnt vmcnt(12) lgkmcnt(0)
    s_barrier
    v_mfma_f32_16x16x32_bf16 v[200:203], v[100:103], v[32:35], v[200:203]
    v_mfma_f32_16x16x32_bf16 v[204:207], v[100:103], v[36:39], v[204:207]
    v_mfma_f32_16x16x32_bf16 v[208:211], v[100:103], v[40:43], v[208:211]
    v_mfma_f32_16x16x32_bf16 v[212:215], v[100:103], v[44:47], v[212:215]
    s_mov_b32 s32, 11
.p2align 3
g1_z1_loop:
    v_mfma_f32_16x16x32_bf16 v[104:107], v[48:51], v[16:19], v[104:107]
    ds_read_b64_tr_b16 v[76:77], v4 offset:24576
    s_add_u32 s10, s32, s33
    s_bitcmp1_b32 0x550, s10
    s_cbranch_scc1 g1_z1_cp_r
g1_z1_cp_b:
    v_mfma_f32_16x16x32_bf16 v[108:111], v[48:51], v[20:23], v[108:111]
    ds_read_b64_tr_b16 v[78:79], v4 offset:28672
    v_mfma_f32_16x16x32_bf16 v[112:115], v[48:51], v[24:27], v[112:115]
    ds_read_b128 v[32:35], v3 offset:0
    s_add_u32 m0, s27, s30
    v_mfma_f32_16x16x32_bf16 v[116:119], v[48:51], v[28:31], v[116:119]
    ds_read_b128 v[36:39], v3 offset:1024
    buffer_load_dwordx4 v5, s[36:39], s28 offen offset:0 sc1 lds
    v_mfma_f32_16x16x32_bf16 v[120:123], v[52:55], v[16:19], v[120:123]
    ds_read_b128 v[40:43], v3 offset:2048
    v_mfma_f32_16x16x32_bf16 v[124:127], v[52:55], v[20:23], v[124:127]
    ds_read_b128 v[44:47], v3 offset:3072
    v_mfma_f32_16x16x32_bf16 v[128:131], v[52:55], v[24:27], v[128:131]
    ds_read_b64_tr_b16 v[80:81], v4 offset:24608
    v_mfma_f32_16x16x32_bf16 v[132:135], v[52:55], v[28:31], v[132:135]
    ds_read_b64_tr_b16 v[82:83], v4 offset:28704
    v_mfma_f32_16x16x32_bf16 v[136:139], v[56:59], v[16:19], v[136:139]
    ds_read_b64_tr_b16 v[84:85], v4 offset:24640
    v_mfma_f32_16x16x32_bf16 v[140:143], v[56:59], v[20:23], v[140:143]
    ds_read_b64_tr_b16 v[86:87], v4 offset:28736
    buffer_load_dwordx4 v5, s[36:39], s28 offen offset:1024 sc1 lds
    v_mfma_f32_16x16x32_bf16 v[144:147], v[56:59], v[24:27], v[144:147]
    ds_read_b64_tr_b16 v[88:89], v4 offset:24672
    s_add_u32 s28, s28, 16384
    v_mfma_f32_16x16x32_bf16 v[148:151], v[56:59], v[28:31], v[148:151]
    ds_read_b64_tr_b16 v[90:91], v4 offset:28768
    v_mfma_f32_16x16x32_bf16 v[152:155], v[60:63], v[16:19], v[152:155]
    ds_read_b64_tr_b16 v[92:93], v4 offset:24704
    v_mfma_f32_16x16x32_bf16 v[156:159], v[60:63], v[20:23], v[156:159]
    ds_read_b64_tr_b16 v[94:95], v4 offset:28800
    s_add_u32 m0, s27, s31
    v_mfma_f32_16x16x32_bf16 v[160:163], v[60:63], v[24:27], v[160:163]
    ds_read_b64_tr_b16 v[96:97], v4 offset:24736
    buffer_load_dwordx4 v6, s[40:43], s29 offen lds
    v_mfma_f32_16x16x32_bf16 v[164:167], v[60:63], v[28:31], v[164:167]
    ds_read_b64_tr_b16 v[98:99], v4 offset:28832
    v_mfma_f32_16x16x32_bf16 v[168:171], v[64:67], v[16:19], v[168:171]
    ds_read_b64_tr_b16 v[100:101], v4 offset:24768
    v_mfma_f32_16x16x32_bf16 v[172:175], v[64:67], v[20:23], v[172:175]
    ds_read_b64_tr_b16 v[102:103], v4 offset:28864
    v_mfma_f32_16x16x32_bf16 v[176:179], v[64:67], v[24:27], v[176:179]
    v_mfma_f32_16x16x32_bf16 v[180:183], v[64:67], v[28:31], v[180:183]
    buffer_load_dwordx4 v7, s[40:43], s29 offen offset:1024 lds
    v_mfma_f32_16x16x32_bf16 v[184:187], v[68:71], v[16:19], v[184:187]
    s_add_u32 s29, s29, 229376
    s_mov_b32 s27, s26
    s_add_u32 s26, s26, 32768
    v_mfma_f32_16x16x32_bf16 v[188:191], v[68:71], v[20:23], v[188:191]
    s_cmp_eq_u32 s26, 163840
    s_cselect_b32 s26, 0, s26
    v_mfma_f32_16x16x32_bf16 v[192:195], v[68:71], v[24:27], v[192:195]
    v_add_u32 v3, s26, v1
    v_add_u32 v4, s26, v2
    v_mfma_f32_16x16x32_bf16 v[196:199], v[68:71], v[28:31], v[196:199]
    s_waitcnt vmcnt(12) lgkmcnt(0)
    s_barrier
    v_mfma_f32_16x16x32_bf16 v[200:203], v[72:75], v[16:19], v[200:203]
    v_mfma_f32_16x16x32_bf16 v[204:207], v[72:75], v[20:23], v[204:207]
    v_mfma_f32_16x16x32_bf16 v[208:211], v[72:75], v[24:27], v[208:211]
    v_mfma_f32_16x16x32_bf16 v[212:215], v[72:75], v[28:31], v[212:215]
    v_mfma_f32_16x16x32_bf16 v[104:107], v[76:79], v[32:35], v[104:107]
    ds_read_b64_tr_b16 v[48:49], v4 offset:24576
    v_mfma_f32_16x16x32_bf16 v[108:111], v[76:79], v[36:39], v[108:111]
    ds_read_b64_tr_b16 v[50:51], v4 offset:28672
    v_mfma_f32_16x16x32_bf16 v[112:115], v[76:79], v[40:43], v[112:115]
    ds_read_b128 v[16:19], v3 offset:0
    s_add_u32 m0, s27, s30
    v_mfma_f32_16x16x32_bf16 v[116:119], v[76:79], v[44:47], v[116:119]
    ds_read_b128 v[20:23], v3 offset:1024
    buffer_load_dwordx4 v5, s[36:39], s28 offen offset:0 sc1 lds
    v_mfma_f32_16x16x32_bf16 v[120:123], v[80:83], v[32:35], v[120:123]
    ds_read_b128 v[24:27], v3 offset:2048
    v_mfma_f32_16x16x32_bf16 v[124:127], v[80:83], v[36:39], v[124:127]
    ds_read_b128 v[28:31], v3 offset:3072
    v_mfma_f32_16x16x32_bf16 v[128:131], v[80:83], v[40:43], v[128:131]
    ds_read_b64_tr_b16 v[52:53], v4 offset:24608
    v_mfma_f32_16x16x32_bf16 v[132:135], v[80:83], v[44:47], v[132:135]
    ds_read_b64_tr_b16 v[54:55], v4 offset:28704
    v_mfma_f32_16x16x32_bf16 v[136:139], v[84:87], v[32:35], v[136:139]
    ds_read_b64_tr_b16 v[56:57], v4 offset:24640
    v_mfma_f32_16x16x32_bf16 v[140:143], v[84:87], v[36:39], v[140:143]
    ds_read_b64_tr_b16 v[58:59], v4 offset:28736
    buffer_load_dwordx4 v5, s[36:39], s28 offen offset:1024 sc1 lds
    v_mfma_f32_16x16x32_bf16 v[144:147], v[84:87], v[40:43], v[144:147]
    ds_read_b64_tr_b16 v[60:61], v4 offset:24672
    s_add_u32 s28, s28, 16384
    v_mfma_f32_16x16x32_bf16 v[148:151], v[84:87], v[44:47], v[148:151]
    ds_read_b64_tr_b16 v[62:63], v4 offset:28768
    v_mfma_f32_16x16x32_bf16 v[152:155], v[88:91], v[32:35], v[152:155]
    ds_read_b64_tr_b16 v[64:65], v4 offset:24704
    v_mfma_f32_16x16x32_bf16 v[156:159], v[88:91], v[36:39], v[156:159]
    ds_read_b64_tr_b16 v[66:67], v4 offset:28800
    s_add_u32 m0, s27, s31
    v_mfma_f32_16x16x32_bf16 v[160:163], v[88:91], v[40:43], v[160:163]
    ds_read_b64_tr_b16 v[68:69], v4 offset:24736
    buffer_load_dwordx4 v6, s[40:43], s29 offen lds
    v_mfma_f32_16x16x32_bf16 v[164:167], v[88:91], v[44:47], v[164:167]
    ds_read_b64_tr_b16 v[70:71], v4 offset:28832
    v_mfma_f32_16x16x32_bf16 v[168:171], v[92:95], v[32:35], v[168:171]
    ds_read_b64_tr_b16 v[72:73], v4 offset:24768
    v_mfma_f32_16x16x32_bf16 v[172:175], v[92:95], v[36:39], v[172:175]
    ds_read_b64_tr_b16 v[74:75], v4 offset:28864
    v_mfma_f32_16x16x32_bf16 v[176:179], v[92:95], v[40:43], v[176:179]
    v_mfma_f32_16x16x32_bf16 v[180:183], v[92:95], v[44:47], v[180:183]
    buffer_load_dwordx4 v7, s[40:43], s29 offen offset:1024 lds
    v_mfma_f32_16x16x32_bf16 v[184:187], v[96:99], v[32:35], v[184:187]
    s_add_u32 s29, s29, 229376
    s_mov_b32 s27, s26
    s_add_u32 s26, s26, 32768
    v_mfma_f32_16x16x32_bf16 v[188:191], v[96:99], v[36:39], v[188:191]
    s_cmp_eq_u32 s26, 163840
    s_cselect_b32 s26, 0, s26
    v_mfma_f32_16x16x32_bf16 v[192:195], v[96:99], v[40:43], v[192:195]
    v_add_u32 v3, s26, v1
    v_add_u32 v4, s26, v2
    v_mfma_f32_16x16x32_bf16 v[196:199], v[96:99], v[44:47], v[196:199]
    s_waitcnt vmcnt(12) lgkmcnt(0)
    s_barrier
    v_mfma_f32_16x16x32_bf16 v[200:203], v[100:103], v[32:35], v[200:203]
    v_mfma_f32_16x16x32_bf16 v[204:207], v[100:103], v[36:39], v[204:207]
    v_mfma_f32_16x16x32_bf16 v[208:211], v[100:103], v[40:43], v[208:211]
    v_mfma_f32_16x16x32_bf16 v[212:215], v[100:103], v[44:47], v[212:215]
    s_sub_u32 s32, s32, 1
    s_cmp_lg_u32 s32, 0
    s_cbranch_scc1 g1_z1_loop
    v_mfma_f32_16x16x32_bf16 v[104:107], v[48:51], v[16:19], v[104:107]
    ds_read_b64_tr_b16 v[76:77], v4 offset:24576
    v_mfma_f32_16x16x32_bf16 v[108:111], v[48:51], v[20:23], v[108:111]
    ds_read_b64_tr_b16 v[78:79], v4 offset:28672
    v_mfma_f32_16x16x32_bf16 v[112:115], v[48:51], v[24:27], v[112:115]
    ds_read_b128 v[32:35], v3 offset:0
    s_add_u32 m0, s27, s30
    v_mfma_f32_16x16x32_bf16 v[116:119], v[48:51], v[28:31], v[116:119]
    ds_read_b128 v[36:39], v3 offset:1024
    buffer_load_dwordx4 v5, s[36:39], s28 offen offset:0 sc1 lds
    v_mfma_f32_16x16x32_bf16 v[120:123], v[52:55], v[16:19], v[120:123]
    ds_read_b128 v[40:43], v3 offset:2048
    v_mfma_f32_16x16x32_bf16 v[124:127], v[52:55], v[20:23], v[124:127]
    ds_read_b128 v[44:47], v3 offset:3072
    v_mfma_f32_16x16x32_bf16 v[128:131], v[52:55], v[24:27], v[128:131]
    ds_read_b64_tr_b16 v[80:81], v4 offset:24608
    v_mfma_f32_16x16x32_bf16 v[132:135], v[52:55], v[28:31], v[132:135]
    ds_read_b64_tr_b16 v[82:83], v4 offset:28704
    v_mfma_f32_16x16x32_bf16 v[136:139], v[56:59], v[16:19], v[136:139]
    ds_read_b64_tr_b16 v[84:85], v4 offset:24640
    v_mfma_f32_16x16x32_bf16 v[140:143], v[56:59], v[20:23], v[140:143]
    ds_read_b64_tr_b16 v[86:87], v4 offset:28736
    buffer_load_dwordx4 v5, s[36:39], s28 offen offset:1024 sc1 lds
    v_mfma_f32_16x16x32_bf16 v[144:147], v[56:59], v[24:27], v[144:147]
    ds_read_b64_tr_b16 v[88:89], v4 offset:24672
    s_add_u32 s28, s28, 16384
    v_mfma_f32_16x16x32_bf16 v[148:151], v[56:59], v[28:31], v[148:151]
    ds_read_b64_tr_b16 v[90:91], v4 offset:28768
    v_mfma_f32_16x16x32_bf16 v[152:155], v[60:63], v[16:19], v[152:155]
    ds_read_b64_tr_b16 v[92:93], v4 offset:24704
    v_mfma_f32_16x16x32_bf16 v[156:159], v[60:63], v[20:23], v[156:159]
    ds_read_b64_tr_b16 v[94:95], v4 offset:28800
    s_add_u32 m0, s27, s31
    v_mfma_f32_16x16x32_bf16 v[160:163], v[60:63], v[24:27], v[160:163]
    ds_read_b64_tr_b16 v[96:97], v4 offset:24736
    buffer_load_dwordx4 v6, s[40:43], s29 offen lds
    v_mfma_f32_16x16x32_bf16 v[164:167], v[60:63], v[28:31], v[164:167]
    ds_read_b64_tr_b16 v[98:99], v4 offset:28832
    v_mfma_f32_16x16x32_bf16 v[168:171], v[64:67], v[16:19], v[168:171]
    ds_read_b64_tr_b16 v[100:101], v4 offset:24768
    v_mfma_f32_16x16x32_bf16 v[172:175], v[64:67], v[20:23], v[172:175]
    ds_read_b64_tr_b16 v[102:103], v4 offset:28864
    v_mfma_f32_16x16x32_bf16 v[176:179], v[64:67], v[24:27], v[176:179]
    v_mfma_f32_16x16x32_bf16 v[180:183], v[64:67], v[28:31], v[180:183]
    buffer_load_dwordx4 v7, s[40:43], s29 offen offset:1024 lds
    v_mfma_f32_16x16x32_bf16 v[184:187], v[68:71], v[16:19], v[184:187]
    s_add_u32 s29, s29, 229376
    s_mov_b32 s27, s26
    s_add_u32 s26, s26, 32768
    v_mfma_f32_16x16x32_bf16 v[188:191], v[68:71], v[20:23], v[188:191]
    s_cmp_eq_u32 s26, 163840
    s_cselect_b32 s26, 0, s26
    v_mfma_f32_16x16x32_bf16 v[192:195], v[68:71], v[24:27], v[192:195]
    v_add_u32 v3, s26, v1
    v_add_u32 v4, s26, v2
    v_mfma_f32_16x16x32_bf16 v[196:199], v[68:71], v[28:31], v[196:199]
    s_waitcnt vmcnt(12) lgkmcnt(0)
    s_barrier
    v_mfma_f32_16x16x32_bf16 v[200:203], v[72:75], v[16:19], v[200:203]
    v_mfma_f32_16x16x32_bf16 v[204:207], v[72:75], v[20:23], v[204:207]
    v_mfma_f32_16x16x32_bf16 v[208:211], v[72:75], v[24:27], v[208:211]
    v_mfma_f32_16x16x32_bf16 v[212:215], v[72:75], v[28:31], v[212:215]
    v_mfma_f32_16x16x32_bf16 v[104:107], v[76:79], v[32:35], v[104:107]
    ds_read_b64_tr_b16 v[48:49], v4 offset:24576
    v_mfma_f32_16x16x32_bf16 v[108:111], v[76:79], v[36:39], v[108:111]
    ds_read_b64_tr_b16 v[50:51], v4 offset:28672
    v_mfma_f32_16x16x32_bf16 v[112:115], v[76:79], v[40:43], v[112:115]
    ds_read_b128 v[16:19], v3 offset:0
    v_mfma_f32_16x16x32_bf16 v[116:119], v[76:79], v[44:47], v[116:119]
    ds_read_b128 v[20:23], v3 offset:1024
    v_mfma_f32_16x16x32_bf16 v[120:123], v[80:83], v[32:35], v[120:123]
    ds_read_b128 v[24:27], v3 offset:2048
    v_mfma_f32_16x16x32_bf16 v[124:127], v[80:83], v[36:39], v[124:127]
    ds_read_b128 v[28:31], v3 offset:3072
    v_mfma_f32_16x16x32_bf16 v[128:131], v[80:83], v[40:43], v[128:131]
    ds_read_b64_tr_b16 v[52:53], v4 offset:24608
    v_mfma_f32_16x16x32_bf16 v[132:135], v[80:83], v[44:47], v[132:135]
    ds_read_b64_tr_b16 v[54:55], v4 offset:28704
    v_mfma_f32_16x16x32_bf16 v[136:139], v[84:87], v[32:35], v[136:139]
    ds_read_b64_tr_b16 v[56:57], v4 offset:24640
    v_mfma_f32_16x16x32_bf16 v[140:143], v[84:87], v[36:39], v[140:143]
    ds_read_b64_tr_b16 v[58:59], v4 offset:28736
    v_mfma_f32_16x16x32_bf16 v[144:147], v[84:87], v[40:43], v[144:147]
    ds_read_b64_tr_b16 v[60:61], v4 offset:24672
    v_mfma_f32_16x16x32_bf16 v[148:151], v[84:87], v[44:47], v[148:151]
    ds_read_b64_tr_b16 v[62:63], v4 offset:28768
    v_mfma_f32_16x16x32_bf16 v[152:155], v[88:91], v[32:35], v[152:155]
    ds_read_b64_tr_b16 v[64:65], v4 offset:24704
    v_mfma_f32_16x16x32_bf16 v[156:159], v[88:91], v[36:39], v[156:159]
    ds_read_b64_tr_b16 v[66:67], v4 offset:28800
    v_mfma_f32_16x16x32_bf16 v[160:163], v[88:91], v[40:43], v[160:163]
    ds_read_b64_tr_b16 v[68:69], v4 offset:24736
    v_mfma_f32_16x16x32_bf16 v[164:167], v[88:91], v[44:47], v[164:167]
    ds_read_b64_tr_b16 v[70:71], v4 offset:28832
    v_mfma_f32_16x16x32_bf16 v[168:171], v[92:95], v[32:35], v[168:171]
    ds_read_b64_tr_b16 v[72:73], v4 offset:24768
    v_mfma_f32_16x16x32_bf16 v[172:175], v[92:95], v[36:39], v[172:175]
    ds_read_b64_tr_b16 v[74:75], v4 offset:28864
    v_mfma_f32_16x16x32_bf16 v[176:179], v[92:95], v[40:43], v[176:179]
    v_mfma_f32_16x16x32_bf16 v[180:183], v[92:95], v[44:47], v[180:183]
    v_mfma_f32_16x16x32_bf16 v[184:187], v[96:99], v[32:35], v[184:187]
    s_mov_b32 s27, s26
    s_add_u32 s26, s26, 32768
    v_mfma_f32_16x16x32_bf16 v[188:191], v[96:99], v[36:39], v[188:191]
    s_cmp_eq_u32 s26, 163840
    s_cselect_b32 s26, 0, s26
    v_mfma_f32_16x16x32_bf16 v[192:195], v[96:99], v[40:43], v[192:195]
    v_add_u32 v3, s26, v1
    v_add_u32 v4, s26, v2
    v_mfma_f32_16x16x32_bf16 v[196:199], v[96:99], v[44:47], v[196:199]
    s_waitcnt vmcnt(8) lgkmcnt(0)
    s_barrier
    v_mfma_f32_16x16x32_bf16 v[200:203], v[100:103], v[32:35], v[200:203]
    v_mfma_f32_16x16x32_bf16 v[204:207], v[100:103], v[36:39], v[204:207]
    v_mfma_f32_16x16x32_bf16 v[208:211], v[100:103], v[40:43], v[208:211]
    v_mfma_f32_16x16x32_bf16 v[212:215], v[100:103], v[44:47], v[212:215]
    v_mfma_f32_16x16x32_bf16 v[104:107], v[48:51], v[16:19], v[104:107]
    ds_read_b64_tr_b16 v[76:77], v4 offset:24576
    v_mfma_f32_16x16x32_bf16 v[108:111], v[48:51], v[20:23], v[108:111]
    ds_read_b64_tr_b16 v[78:79], v4 offset:28672
    v_mfma_f32_16x16x32_bf16 v[112:115], v[48:51], v[24:27], v[112:115]
    ds_read_b128 v[32:35], v3 offset:0
    v_mfma_f32_16x16x32_bf16 v[116:119], v[48:51], v[28:31], v[116:119]
    ds_read_b128 v[36:39], v3 offset:1024
    v_mfma_f32_16x16x32_bf16 v[120:123], v[52:55], v[16:19], v[120:123]
    ds_read_b128 v[40:43], v3 offset:2048
    v_mfma_f32_16x16x32_bf16 v[124:127], v[52:55], v[20:23], v[124:127]
    ds_read_b128 v[44:47], v3 offset:3072
    v_mfma_f32_16x16x32_bf16 v[128:131], v[52:55], v[24:27], v[128:131]
    ds_read_b64_tr_b16 v[80:81], v4 offset:24608
    v_mfma_f32_16x16x32_bf16 v[132:135], v[52:55], v[28:31], v[132:135]
    ds_read_b64_tr_b16 v[82:83], v4 offset:28704
    v_mfma_f32_16x16x32_bf16 v[136:139], v[56:59], v[16:19], v[136:139]
    ds_read_b64_tr_b16 v[84:85], v4 offset:24640
    v_mfma_f32_16x16x32_bf16 v[140:143], v[56:59], v[20:23], v[140:143]
    ds_read_b64_tr_b16 v[86:87], v4 offset:28736
    v_mfma_f32_16x16x32_bf16 v[144:147], v[56:59], v[24:27], v[144:147]
    ds_read_b64_tr_b16 v[88:89], v4 offset:24672
    v_mfma_f32_16x16x32_bf16 v[148:151], v[56:59], v[28:31], v[148:151]
    ds_read_b64_tr_b16 v[90:91], v4 offset:28768
    v_mfma_f32_16x16x32_bf16 v[152:155], v[60:63], v[16:19], v[152:155]
    ds_read_b64_tr_b16 v[92:93], v4 offset:24704
    v_mfma_f32_16x16x32_bf16 v[156:159], v[60:63], v[20:23], v[156:159]
    ds_read_b64_tr_b16 v[94:95], v4 offset:28800
    v_mfma_f32_16x16x32_bf16 v[160:163], v[60:63], v[24:27], v[160:163]
    ds_read_b64_tr_b16 v[96:97], v4 offset:24736
    v_mfma_f32_16x16x32_bf16 v[164:167], v[60:63], v[28:31], v[164:167]
    ds_read_b64_tr_b16 v[98:99], v4 offset:28832
    v_mfma_f32_16x16x32_bf16 v[168:171], v[64:67], v[16:19], v[168:171]
    ds_read_b64_tr_b16 v[100:101], v4 offset:24768
    v_mfma_f32_16x16x32_bf16 v[172:175], v[64:67], v[20:23], v[172:175]
    ds_read_b64_tr_b16 v[102:103], v4 offset:28864
    v_mfma_f32_16x16x32_bf16 v[176:179], v[64:67], v[24:27], v[176:179]
    v_mfma_f32_16x16x32_bf16 v[180:183], v[64:67], v[28:31], v[180:183]
    v_mfma_f32_16x16x32_bf16 v[184:187], v[68:71], v[16:19], v[184:187]
    s_mov_b32 s27, s26
    s_add_u32 s26, s26, 32768
    v_mfma_f32_16x16x32_bf16 v[188:191], v[68:71], v[20:23], v[188:191]
    s_cmp_eq_u32 s26, 163840
    s_cselect_b32 s26, 0, s26
    v_mfma_f32_16x16x32_bf16 v[192:195], v[68:71], v[24:27], v[192:195]
    v_add_u32 v3, s26, v1
    v_add_u32 v4, s26, v2
    v_mfma_f32_16x16x32_bf16 v[196:199], v[68:71], v[28:31], v[196:199]
    s_waitcnt vmcnt(4) lgkmcnt(0)
    s_barrier
    v_mfma_f32_16x16x32_bf16 v[200:203], v[72:75], v[16:19], v[200:203]
    v_mfma_f32_16x16x32_bf16 v[204:207], v[72:75], v[20:23], v[204:207]
    v_mfma_f32_16x16x32_bf16 v[208:211], v[72:75], v[24:27], v[208:211]
    v_mfma_f32_16x16x32_bf16 v[212:215], v[72:75], v[28:31], v[212:215]
    v_mfma_f32_16x16x32_bf16 v[104:107], v[76:79], v[32:35], v[104:107]
    ds_read_b64_tr_b16 v[48:49], v4 offset:24576
    v_mfma_f32_16x16x32_bf16 v[108:111], v[76:79], v[36:39], v[108:111]
    ds_read_b64_tr_b16 v[50:51], v4 offset:28672
    v_mfma_f32_16x16x32_bf16 v[112:115], v[76:79], v[40:43], v[112:115]
    ds_read_b128 v[16:19], v3 offset:0
    v_mfma_f32_16x16x32_bf16 v[116:119], v[76:79], v[44:47], v[116:119]
    ds_read_b128 v[20:23], v3 offset:1024
    v_mfma_f32_16x16x32_bf16 v[120:123], v[80:83], v[32:35], v[120:123]
    ds_read_b128 v[24:27], v3 offset:2048
    v_mfma_f32_16x16x32_bf16 v[124:127], v[80:83], v[36:39], v[124:127]
    ds_read_b128 v[28:31], v3 offset:3072
    v_mfma_f32_16x16x32_bf16 v[128:131], v[80:83], v[40:43], v[128:131]
    ds_read_b64_tr_b16 v[52:53], v4 offset:24608
    v_mfma_f32_16x16x32_bf16 v[132:135], v[80:83], v[44:47], v[132:135]
    ds_read_b64_tr_b16 v[54:55], v4 offset:28704
    v_mfma_f32_16x16x32_bf16 v[136:139], v[84:87], v[32:35], v[136:139]
    ds_read_b64_tr_b16 v[56:57], v4 offset:24640
    v_mfma_f32_16x16x32_bf16 v[140:143], v[84:87], v[36:39], v[140:143]
    ds_read_b64_tr_b16 v[58:59], v4 offset:28736
    v_mfma_f32_16x16x32_bf16 v[144:147], v[84:87], v[40:43], v[144:147]
    ds_read_b64_tr_b16 v[60:61], v4 offset:24672
    v_mfma_f32_16x16x32_bf16 v[148:151], v[84:87], v[44:47], v[148:151]
    ds_read_b64_tr_b16 v[62:63], v4 offset:28768
    v_mfma_f32_16x16x32_bf16 v[152:155], v[88:91], v[32:35], v[152:155]
    ds_read_b64_tr_b16 v[64:65], v4 offset:24704
    v_mfma_f32_16x16x32_bf16 v[156:159], v[88:91], v[36:39], v[156:159]
    ds_read_b64_tr_b16 v[66:67], v4 offset:28800
    v_mfma_f32_16x16x32_bf16 v[160:163], v[88:91], v[40:43], v[160:163]
    ds_read_b64_tr_b16 v[68:69], v4 offset:24736
    v_mfma_f32_16x16x32_bf16 v[164:167], v[88:91], v[44:47], v[164:167]
    ds_read_b64_tr_b16 v[70:71], v4 offset:28832
    v_mfma_f32_16x16x32_bf16 v[168:171], v[92:95], v[32:35], v[168:171]
    ds_read_b64_tr_b16 v[72:73], v4 offset:24768
    v_mfma_f32_16x16x32_bf16 v[172:175], v[92:95], v[36:39], v[172:175]
    ds_read_b64_tr_b16 v[74:75], v4 offset:28864
    v_mfma_f32_16x16x32_bf16 v[176:179], v[92:95], v[40:43], v[176:179]
    v_mfma_f32_16x16x32_bf16 v[180:183], v[92:95], v[44:47], v[180:183]
    v_mfma_f32_16x16x32_bf16 v[184:187], v[96:99], v[32:35], v[184:187]
    s_mov_b32 s27, s26
    s_add_u32 s26, s26, 32768
    v_mfma_f32_16x16x32_bf16 v[188:191], v[96:99], v[36:39], v[188:191]
    s_cmp_eq_u32 s26, 163840
    s_cselect_b32 s26, 0, s26
    v_mfma_f32_16x16x32_bf16 v[192:195], v[96:99], v[40:43], v[192:195]
    v_add_u32 v3, s26, v1
    v_add_u32 v4, s26, v2
    v_mfma_f32_16x16x32_bf16 v[196:199], v[96:99], v[44:47], v[196:199]
    s_waitcnt vmcnt(0) lgkmcnt(0)
    s_barrier
    v_mfma_f32_16x16x32_bf16 v[200:203], v[100:103], v[32:35], v[200:203]
    v_mfma_f32_16x16x32_bf16 v[204:207], v[100:103], v[36:39], v[204:207]
    v_mfma_f32_16x16x32_bf16 v[208:211], v[100:103], v[40:43], v[208:211]
    v_mfma_f32_16x16x32_bf16 v[212:215], v[100:103], v[44:47], v[212:215]
    v_mfma_f32_16x16x32_bf16 v[104:107], v[48:51], v[16:19], v[104:107]
    ds_read_b64_tr_b16 v[76:77], v4 offset:24576
    v_mfma_f32_16x16x32_bf16 v[108:111], v[48:51], v[20:23], v[108:111]
    ds_read_b64_tr_b16 v[78:79], v4 offset:28672
    v_mfma_f32_16x16x32_bf16 v[112:115], v[48:51], v[24:27], v[112:115]
    ds_read_b128 v[32:35], v3 offset:0
    v_mfma_f32_16x16x32_bf16 v[116:119], v[48:51], v[28:31], v[116:119]
    ds_read_b128 v[36:39], v3 offset:1024
    v_mfma_f32_16x16x32_bf16 v[120:123], v[52:55], v[16:19], v[120:123]
    ds_read_b128 v[40:43], v3 offset:2048
    v_mfma_f32_16x16x32_bf16 v[124:127], v[52:55], v[20:23], v[124:127]
    ds_read_b128 v[44:47], v3 offset:3072
    v_mfma_f32_16x16x32_bf16 v[128:131], v[52:55], v[24:27], v[128:131]
    ds_read_b64_tr_b16 v[80:81], v4 offset:24608
    v_mfma_f32_16x16x32_bf16 v[132:135], v[52:55], v[28:31], v[132:135]
    ds_read_b64_tr_b16 v[82:83], v4 offset:28704
    v_mfma_f32_16x16x32_bf16 v[136:139], v[56:59], v[16:19], v[136:139]
    ds_read_b64_tr_b16 v[84:85], v4 offset:24640
    v_mfma_f32_16x16x32_bf16 v[140:143], v[56:59], v[20:23], v[140:143]
    ds_read_b64_tr_b16 v[86:87], v4 offset:28736
    v_mfma_f32_16x16x32_bf16 v[144:147], v[56:59], v[24:27], v[144:147]
    ds_read_b64_tr_b16 v[88:89], v4 offset:24672
    v_mfma_f32_16x16x32_bf16 v[148:151], v[56:59], v[28:31], v[148:151]
    ds_read_b64_tr_b16 v[90:91], v4 offset:28768
    v_mfma_f32_16x16x32_bf16 v[152:155], v[60:63], v[16:19], v[152:155]
    ds_read_b64_tr_b16 v[92:93], v4 offset:24704
    v_mfma_f32_16x16x32_bf16 v[156:159], v[60:63], v[20:23], v[156:159]
    ds_read_b64_tr_b16 v[94:95], v4 offset:28800
    v_mfma_f32_16x16x32_bf16 v[160:163], v[60:63], v[24:27], v[160:163]
    ds_read_b64_tr_b16 v[96:97], v4 offset:24736
    v_mfma_f32_16x16x32_bf16 v[164:167], v[60:63], v[28:31], v[164:167]
    ds_read_b64_tr_b16 v[98:99], v4 offset:28832
    v_mfma_f32_16x16x32_bf16 v[168:171], v[64:67], v[16:19], v[168:171]
    ds_read_b64_tr_b16 v[100:101], v4 offset:24768
    v_mfma_f32_16x16x32_bf16 v[172:175], v[64:67], v[20:23], v[172:175]
    ds_read_b64_tr_b16 v[102:103], v4 offset:28864
    v_mfma_f32_16x16x32_bf16 v[176:179], v[64:67], v[24:27], v[176:179]
    v_mfma_f32_16x16x32_bf16 v[180:183], v[64:67], v[28:31], v[180:183]
    v_mfma_f32_16x16x32_bf16 v[184:187], v[68:71], v[16:19], v[184:187]
    s_mov_b32 s27, s26
    s_add_u32 s26, s26, 32768
    v_mfma_f32_16x16x32_bf16 v[188:191], v[68:71], v[20:23], v[188:191]
    s_cmp_eq_u32 s26, 163840
    s_cselect_b32 s26, 0, s26
    v_mfma_f32_16x16x32_bf16 v[192:195], v[68:71], v[24:27], v[192:195]
    v_add_u32 v3, s26, v1
    v_add_u32 v4, s26, v2
    v_mfma_f32_16x16x32_bf16 v[196:199], v[68:71], v[28:31], v[196:199]
    v_lshlrev_b32 v10, 2, v9
    v_add_u32 v10, 157696, v10
    v_mov_b32 v11, 0
    ds_write_b32 v10, v11
    ds_write_b32 v10, v11 offset:256
    ds_write_b32 v10, v11 offset:512
    s_waitcnt lgkmcnt(0)
    s_barrier
    v_mfma_f32_16x16x32_bf16 v[200:203], v[72:75], v[16:19], v[200:203]
    v_mfma_f32_16x16x32_bf16 v[204:207], v[72:75], v[20:23], v[204:207]
    v_mfma_f32_16x16x32_bf16 v[208:211], v[72:75], v[24:27], v[208:211]
    v_mfma_f32_16x16x32_bf16 v[212:215], v[72:75], v[28:31], v[212:215]
    v_mfma_f32_16x16x32_bf16 v[104:107], v[76:79], v[32:35], v[104:107]
    v_mfma_f32_16x16x32_bf16 v[108:111], v[76:79], v[36:39], v[108:111]
    v_mfma_f32_16x16x32_bf16 v[112:115], v[76:79], v[40:43], v[112:115]
    v_mfma_f32_16x16x32_bf16 v[116:119], v[76:79], v[44:47], v[116:119]
    v_mfma_f32_16x16x32_bf16 v[120:123], v[80:83], v[32:35], v[120:123]
    v_mfma_f32_16x16x32_bf16 v[124:127], v[80:83], v[36:39], v[124:127]
    v_mfma_f32_16x16x32_bf16 v[128:131], v[80:83], v[40:43], v[128:131]
    v_mfma_f32_16x16x32_bf16 v[132:135], v[80:83], v[44:47], v[132:135]
    v_mfma_f32_16x16x32_bf16 v[136:139], v[84:87], v[32:35], v[136:139]
    v_mfma_f32_16x16x32_bf16 v[140:143], v[84:87], v[36:39], v[140:143]
    v_mfma_f32_16x16x32_bf16 v[144:147], v[84:87], v[40:43], v[144:147]
    v_mfma_f32_16x16x32_bf16 v[148:151], v[84:87], v[44:47], v[148:151]
    v_mfma_f32_16x16x32_bf16 v[152:155], v[88:91], v[32:35], v[152:155]
    v_mfma_f32_16x16x32_bf16 v[156:159], v[88:91], v[36:39], v[156:159]
    v_mfma_f32_16x16x32_bf16 v[160:163], v[88:91], v[40:43], v[160:163]
    v_mfma_f32_16x16x32_bf16 v[164:167], v[88:91], v[44:47], v[164:167]
    v_mfma_f32_16x16x32_bf16 v[168:171], v[92:95], v[32:35], v[168:171]
    v_mfma_f32_16x16x32_bf16 v[172:175], v[92:95], v[36:39], v[172:175]
    v_mfma_f32_16x16x32_bf16 v[176:179], v[92:95], v[40:43], v[176:179]
    v_mfma_f32_16x16x32_bf16 v[180:183], v[92:95], v[44:47], v[180:183]
    v_mfma_f32_16x16x32_bf16 v[184:187], v[96:99], v[32:35], v[184:187]
    v_mfma_f32_16x16x32_bf16 v[188:191], v[96:99], v[36:39], v[188:191]
    v_mfma_f32_16x16x32_bf16 v[192:195], v[96:99], v[40:43], v[192:195]
    v_mfma_f32_16x16x32_bf16 v[196:199], v[96:99], v[44:47], v[196:199]
    v_mfma_f32_16x16x32_bf16 v[200:203], v[100:103], v[32:35], v[200:203]
    v_mfma_f32_16x16x32_bf16 v[204:207], v[100:103], v[36:39], v[204:207]
    v_mfma_f32_16x16x32_bf16 v[208:211], v[100:103], v[40:43], v[208:211]
    v_mfma_f32_16x16x32_bf16 v[212:215], v[100:103], v[44:47], v[212:215]
    s_nop 7
    s_setprio 0
    v_mov_b32 v216, 0xbdd2d3e8
    v_mov_b32 v217, 0xbdd2d3e8
    v_mov_b32 v218, 0xc0135761
    v_mov_b32 v219, 0xc0135761
    v_mov_b32 v220, 1.0
    v_mov_b32 v221, 1.0
    v_pk_mul_f32 v[222:223], v[104:105], v[104:105]
    v_pk_mul_f32 v[224:225], v[106:107], v[106:107]
    v_pk_mul_f32 v[226:227], v[108:109], v[108:109]
    v_pk_mul_f32 v[228:229], v[110:111], v[110:111]
    v_pk_fma_f32 v[222:223], v[222:223], v[216:217], v[218:219]
    v_pk_fma_f32 v[224:225], v[224:225], v[216:217], v[218:219]
    v_pk_fma_f32 v[226:227], v[226:227], v[216:217], v[218:219]
    v_pk_fma_f32 v[228:229], v[228:229], v[216:217], v[218:219]
    v_pk_mul_f32 v[222:223], v[222:223], v[104:105]
    v_pk_mul_f32 v[224:225], v[224:225], v[106:107]
    v_pk_mul_f32 v[226:227], v[226:227], v[108:109]
    v_pk_mul_f32 v[228:229], v[228:229], v[110:111]
    v_exp_f32 v222, v222
    v_exp_f32 v223, v223
    v_exp_f32 v224, v224
    v_exp_f32 v225, v225
    v_exp_f32 v226, v226
    v_exp_f32 v227, v227
    v_exp_f32 v228, v228
    v_exp_f32 v229, v229
    v_pk_add_f32 v[222:223], v[222:223], v[220:221]
    v_pk_add_f32 v[224:225], v[224:225], v[220:221]
    v_pk_add_f32 v[226:227], v[226:227], v[220:221]
    v_pk_add_f32 v[228:229], v[228:229], v[220:221]
    v_rcp_f32 v222, v222
    v_rcp_f32 v223, v223
    v_rcp_f32 v224, v224
    v_rcp_f32 v225, v225
    v_rcp_f32 v226, v226
    v_rcp_f32 v227, v227
    v_rcp_f32 v228, v228
    v_rcp_f32 v229, v229
    v_pk_mul_f32 v[104:105], v[104:105], v[222:223]
    v_pk_mul_f32 v[106:107], v[106:107], v[224:225]
    v_pk_mul_f32 v[108:109], v[108:109], v[226:227]
    v_pk_mul_f32 v[110:111], v[110:111], v[228:229]
    v_pk_mul_f32 v[222:223], v[112:113], v[112:113]
    v_pk_mul_f32 v[224:225], v[114:115], v[114:115]
    v_pk_mul_f32 v[226:227], v[116:117], v[116:117]
    v_pk_mul_f32 v[228:229], v[118:119], v[118:119]
    v_pk_fma_f32 v[222:223], v[222:223], v[216:217], v[218:219]
    v_pk_fma_f32 v[224:225], v[224:225], v[216:217], v[218:219]
    v_pk_fma_f32 v[226:227], v[226:227], v[216:217], v[218:219]
    v_pk_fma_f32 v[228:229], v[228:229], v[216:217], v[218:219]
    v_pk_mul_f32 v[222:223], v[222:223], v[112:113]
    v_pk_mul_f32 v[224:225], v[224:225], v[114:115]
    v_pk_mul_f32 v[226:227], v[226:227], v[116:117]
    v_pk_mul_f32 v[228:229], v[228:229], v[118:119]
    v_exp_f32 v222, v222
    v_exp_f32 v223, v223
    v_exp_f32 v224, v224
    v_exp_f32 v225, v225
    v_exp_f32 v226, v226
    v_exp_f32 v227, v227
    v_exp_f32 v228, v228
    v_exp_f32 v229, v229
    v_pk_add_f32 v[222:223], v[222:223], v[220:221]
    v_pk_add_f32 v[224:225], v[224:225], v[220:221]
    v_pk_add_f32 v[226:227], v[226:227], v[220:221]
    v_pk_add_f32 v[228:229], v[228:229], v[220:221]
    v_rcp_f32 v222, v222
    v_rcp_f32 v223, v223
    v_rcp_f32 v224, v224
    v_rcp_f32 v225, v225
    v_rcp_f32 v226, v226
    v_rcp_f32 v227, v227
    v_rcp_f32 v228, v228
    v_rcp_f32 v229, v229
    v_pk_mul_f32 v[112:113], v[112:113], v[222:223]
    v_pk_mul_f32 v[114:115], v[114:115], v[224:225]
    v_pk_mul_f32 v[116:117], v[116:117], v[226:227]
    v_pk_mul_f32 v[118:119], v[118:119], v[228:229]
    v_pk_mul_f32 v[222:223], v[120:121], v[120:121]
    v_pk_mul_f32 v[224:225], v[122:123], v[122:123]
    v_pk_mul_f32 v[226:227], v[124:125], v[124:125]
    v_pk_mul_f32 v[228:229], v[126:127], v[126:127]
    v_pk_fma_f32 v[222:223], v[222:223], v[216:217], v[218:219]
    v_pk_fma_f32 v[224:225], v[224:225], v[216:217], v[218:219]
    v_pk_fma_f32 v[226:227], v[226:227], v[216:217], v[218:219]
    v_pk_fma_f32 v[228:229], v[228:229], v[216:217], v[218:219]
    v_pk_mul_f32 v[222:223], v[222:223], v[120:121]
    v_pk_mul_f32 v[224:225], v[224:225], v[122:123]
    v_pk_mul_f32 v[226:227], v[226:227], v[124:125]
    v_pk_mul_f32 v[228:229], v[228:229], v[126:127]
    v_exp_f32 v222, v222
    v_exp_f32 v223, v223
    v_exp_f32 v224, v224
    v_exp_f32 v225, v225
    v_exp_f32 v226, v226
    v_exp_f32 v227, v227
    v_exp_f32 v228, v228
    v_exp_f32 v229, v229
    v_pk_add_f32 v[222:223], v[222:223], v[220:221]
    v_pk_add_f32 v[224:225], v[224:225], v[220:221]
    v_pk_add_f32 v[226:227], v[226:227], v[220:221]
    v_pk_add_f32 v[228:229], v[228:229], v[220:221]
    v_rcp_f32 v222, v222
    v_rcp_f32 v223, v223
    v_rcp_f32 v224, v224
    v_rcp_f32 v225, v225
    v_rcp_f32 v226, v226
    v_rcp_f32 v227, v227
    v_rcp_f32 v228, v228
    v_rcp_f32 v229, v229
    v_pk_mul_f32 v[120:121], v[120:121], v[222:223]
    v_pk_mul_f32 v[122:123], v[122:123], v[224:225]
    v_pk_mul_f32 v[124:125], v[124:125], v[226:227]
    v_pk_mul_f32 v[126:127], v[126:127], v[228:229]
    v_pk_mul_f32 v[222:223], v[128:129], v[128:129]
    v_pk_mul_f32 v[224:225], v[130:131], v[130:131]
    v_pk_mul_f32 v[226:227], v[132:133], v[132:133]
    v_pk_mul_f32 v[228:229], v[134:135], v[134:135]
    v_pk_fma_f32 v[222:223], v[222:223], v[216:217], v[218:219]
    v_pk_fma_f32 v[224:225], v[224:225], v[216:217], v[218:219]
    v_pk_fma_f32 v[226:227], v[226:227], v[216:217], v[218:219]
    v_pk_fma_f32 v[228:229], v[228:229], v[216:217], v[218:219]
    v_pk_mul_f32 v[222:223], v[222:223], v[128:129]
    v_pk_mul_f32 v[224:225], v[224:225], v[130:131]
    v_pk_mul_f32 v[226:227], v[226:227], v[132:133]
    v_pk_mul_f32 v[228:229], v[228:229], v[134:135]
    v_exp_f32 v222, v222
    v_exp_f32 v223, v223
    v_exp_f32 v224, v224
    v_exp_f32 v225, v225
    v_exp_f32 v226, v226
    v_exp_f32 v227, v227
    v_exp_f32 v228, v228
    v_exp_f32 v229, v229
    v_pk_add_f32 v[222:223], v[222:223], v[220:221]
    v_pk_add_f32 v[224:225], v[224:225], v[220:221]
    v_pk_add_f32 v[226:227], v[226:227], v[220:221]
    v_pk_add_f32 v[228:229], v[228:229], v[220:221]
    v_rcp_f32 v222, v222
    v_rcp_f32 v223, v223
    v_rcp_f32 v224, v224
    v_rcp_f32 v225, v225
    v_rcp_f32 v226, v226
    v_rcp_f32 v227, v227
    v_rcp_f32 v228, v228
    v_rcp_f32 v229, v229
    v_pk_mul_f32 v[128:129], v[128:129], v[222:223]
    v_pk_mul_f32 v[130:131], v[130:131], v[224:225]
    v_pk_mul_f32 v[132:133], v[132:133], v[226:227]
    v_pk_mul_f32 v[134:135], v[134:135], v[228:229]
    v_pk_mul_f32 v[222:223], v[136:137], v[136:137]
    v_pk_mul_f32 v[224:225], v[138:139], v[138:139]
    v_pk_mul_f32 v[226:227], v[140:141], v[140:141]
    v_pk_mul_f32 v[228:229], v[142:143], v[142:143]
    v_pk_fma_f32 v[222:223], v[222:223], v[216:217], v[218:219]
    v_pk_fma_f32 v[224:225], v[224:225], v[216:217], v[218:219]
    v_pk_fma_f32 v[226:227], v[226:227], v[216:217], v[218:219]
    v_pk_fma_f32 v[228:229], v[228:229], v[216:217], v[218:219]
    v_pk_mul_f32 v[222:223], v[222:223], v[136:137]
    v_pk_mul_f32 v[224:225], v[224:225], v[138:139]
    v_pk_mul_f32 v[226:227], v[226:227], v[140:141]
    v_pk_mul_f32 v[228:229], v[228:229], v[142:143]
    v_exp_f32 v222, v222
    v_exp_f32 v223, v223
    v_exp_f32 v224, v224
    v_exp_f32 v225, v225
    v_exp_f32 v226, v226
    v_exp_f32 v227, v227
    v_exp_f32 v228, v228
    v_exp_f32 v229, v229
    v_pk_add_f32 v[222:223], v[222:223], v[220:221]
    v_pk_add_f32 v[224:225], v[224:225], v[220:221]
    v_pk_add_f32 v[226:227], v[226:227], v[220:221]
    v_pk_add_f32 v[228:229], v[228:229], v[220:221]
    v_rcp_f32 v222, v222
    v_rcp_f32 v223, v223
    v_rcp_f32 v224, v224
    v_rcp_f32 v225, v225
    v_rcp_f32 v226, v226
    v_rcp_f32 v227, v227
    v_rcp_f32 v228, v228
    v_rcp_f32 v229, v229
    v_pk_mul_f32 v[136:137], v[136:137], v[222:223]
    v_pk_mul_f32 v[138:139], v[138:139], v[224:225]
    v_pk_mul_f32 v[140:141], v[140:141], v[226:227]
    v_pk_mul_f32 v[142:143], v[142:143], v[228:229]
    v_pk_mul_f32 v[222:223], v[144:145], v[144:145]
    v_pk_mul_f32 v[224:225], v[146:147], v[146:147]
    v_pk_mul_f32 v[226:227], v[148:149], v[148:149]
    v_pk_mul_f32 v[228:229], v[150:151], v[150:151]
    v_pk_fma_f32 v[222:223], v[222:223], v[216:217], v[218:219]
    v_pk_fma_f32 v[224:225], v[224:225], v[216:217], v[218:219]
    v_pk_fma_f32 v[226:227], v[226:227], v[216:217], v[218:219]
    v_pk_fma_f32 v[228:229], v[228:229], v[216:217], v[218:219]
    v_pk_mul_f32 v[222:223], v[222:223], v[144:145]
    v_pk_mul_f32 v[224:225], v[224:225], v[146:147]
    v_pk_mul_f32 v[226:227], v[226:227], v[148:149]
    v_pk_mul_f32 v[228:229], v[228:229], v[150:151]
    v_exp_f32 v222, v222
    v_exp_f32 v223, v223
    v_exp_f32 v224, v224
    v_exp_f32 v225, v225
    v_exp_f32 v226, v226
    v_exp_f32 v227, v227
    v_exp_f32 v228, v228
    v_exp_f32 v229, v229
    v_pk_add_f32 v[222:223], v[222:223], v[220:221]
    v_pk_add_f32 v[224:225], v[224:225], v[220:221]
    v_pk_add_f32 v[226:227], v[226:227], v[220:221]
    v_pk_add_f32 v[228:229], v[228:229], v[220:221]
    v_rcp_f32 v222, v222
    v_rcp_f32 v223, v223
    v_rcp_f32 v224, v224
    v_rcp_f32 v225, v225
    v_rcp_f32 v226, v226
    v_rcp_f32 v227, v227
    v_rcp_f32 v228, v228
    v_rcp_f32 v229, v229
    v_pk_mul_f32 v[144:145], v[144:145], v[222:223]
    v_pk_mul_f32 v[146:147], v[146:147], v[224:225]
    v_pk_mul_f32 v[148:149], v[148:149], v[226:227]
    v_pk_mul_f32 v[150:151], v[150:151], v[228:229]
    v_pk_mul_f32 v[222:223], v[152:153], v[152:153]
    v_pk_mul_f32 v[224:225], v[154:155], v[154:155]
    v_pk_mul_f32 v[226:227], v[156:157], v[156:157]
    v_pk_mul_f32 v[228:229], v[158:159], v[158:159]
    v_pk_fma_f32 v[222:223], v[222:223], v[216:217], v[218:219]
    v_pk_fma_f32 v[224:225], v[224:225], v[216:217], v[218:219]
    v_pk_fma_f32 v[226:227], v[226:227], v[216:217], v[218:219]
    v_pk_fma_f32 v[228:229], v[228:229], v[216:217], v[218:219]
    v_pk_mul_f32 v[222:223], v[222:223], v[152:153]
    v_pk_mul_f32 v[224:225], v[224:225], v[154:155]
    v_pk_mul_f32 v[226:227], v[226:227], v[156:157]
    v_pk_mul_f32 v[228:229], v[228:229], v[158:159]
    v_exp_f32 v222, v222
    v_exp_f32 v223, v223
    v_exp_f32 v224, v224
    v_exp_f32 v225, v225
    v_exp_f32 v226, v226
    v_exp_f32 v227, v227
    v_exp_f32 v228, v228
    v_exp_f32 v229, v229
    v_pk_add_f32 v[222:223], v[222:223], v[220:221]
    v_pk_add_f32 v[224:225], v[224:225], v[220:221]
    v_pk_add_f32 v[226:227], v[226:227], v[220:221]
    v_pk_add_f32 v[228:229], v[228:229], v[220:221]
    v_rcp_f32 v222, v222
    v_rcp_f32 v223, v223
    v_rcp_f32 v224, v224
    v_rcp_f32 v225, v225
    v_rcp_f32 v226, v226
    v_rcp_f32 v227, v227
    v_rcp_f32 v228, v228
    v_rcp_f32 v229, v229
    v_pk_mul_f32 v[152:153], v[152:153], v[222:223]
    v_pk_mul_f32 v[154:155], v[154:155], v[224:225]
    v_pk_mul_f32 v[156:157], v[156:157], v[226:227]
    v_pk_mul_f32 v[158:159], v[158:159], v[228:229]
    v_pk_mul_f32 v[222:223], v[160:161], v[160:161]
    v_pk_mul_f32 v[224:225], v[162:163], v[162:163]
    v_pk_mul_f32 v[226:227], v[164:165], v[164:165]
    v_pk_mul_f32 v[228:229], v[166:167], v[166:167]
    v_pk_fma_f32 v[222:223], v[222:223], v[216:217], v[218:219]
    v_pk_fma_f32 v[224:225], v[224:225], v[216:217], v[218:219]
    v_pk_fma_f32 v[226:227], v[226:227], v[216:217], v[218:219]
    v_pk_fma_f32 v[228:229], v[228:229], v[216:217], v[218:219]
    v_pk_mul_f32 v[222:223], v[222:223], v[160:161]
    v_pk_mul_f32 v[224:225], v[224:225], v[162:163]
    v_pk_mul_f32 v[226:227], v[226:227], v[164:165]
    v_pk_mul_f32 v[228:229], v[228:229], v[166:167]
    v_exp_f32 v222, v222
    v_exp_f32 v223, v223
    v_exp_f32 v224, v224
    v_exp_f32 v225, v225
    v_exp_f32 v226, v226
    v_exp_f32 v227, v227
    v_exp_f32 v228, v228
    v_exp_f32 v229, v229
    v_pk_add_f32 v[222:223], v[222:223], v[220:221]
    v_pk_add_f32 v[224:225], v[224:225], v[220:221]
    v_pk_add_f32 v[226:227], v[226:227], v[220:221]
    v_pk_add_f32 v[228:229], v[228:229], v[220:221]
    v_rcp_f32 v222, v222
    v_rcp_f32 v223, v223
    v_rcp_f32 v224, v224
    v_rcp_f32 v225, v225
    v_rcp_f32 v226, v226
    v_rcp_f32 v227, v227
    v_rcp_f32 v228, v228
    v_rcp_f32 v229, v229
    v_pk_mul_f32 v[160:161], v[160:161], v[222:223]
    v_pk_mul_f32 v[162:163], v[162:163], v[224:225]
    v_pk_mul_f32 v[164:165], v[164:165], v[226:227]
    v_pk_mul_f32 v[166:167], v[166:167], v[228:229]
    v_pk_mul_f32 v[222:223], v[168:169], v[168:169]
    v_pk_mul_f32 v[224:225], v[170:171], v[170:171]
    v_pk_mul_f32 v[226:227], v[172:173], v[172:173]
    v_pk_mul_f32 v[228:229], v[174:175], v[174:175]
    v_pk_fma_f32 v[222:223], v[222:223], v[216:217], v[218:219]
    v_pk_fma_f32 v[224:225], v[224:225], v[216:217], v[218:219]
    v_pk_fma_f32 v[226:227], v[226:227], v[216:217], v[218:219]
    v_pk_fma_f32 v[228:229], v[228:229], v[216:217], v[218:219]
    v_pk_mul_f32 v[222:223], v[222:223], v[168:169]
    v_pk_mul_f32 v[224:225], v[224:225], v[170:171]
    v_pk_mul_f32 v[226:227], v[226:227], v[172:173]
    v_pk_mul_f32 v[228:229], v[228:229], v[174:175]
    v_exp_f32 v222, v222
    v_exp_f32 v223, v223
    v_exp_f32 v224, v224
    v_exp_f32 v225, v225
    v_exp_f32 v226, v226
    v_exp_f32 v227, v227
    v_exp_f32 v228, v228
    v_exp_f32 v229, v229
    v_pk_add_f32 v[222:223], v[222:223], v[220:221]
    v_pk_add_f32 v[224:225], v[224:225], v[220:221]
    v_pk_add_f32 v[226:227], v[226:227], v[220:221]
    v_pk_add_f32 v[228:229], v[228:229], v[220:221]
    v_rcp_f32 v222, v222
    v_rcp_f32 v223, v223
    v_rcp_f32 v224, v224
    v_rcp_f32 v225, v225
    v_rcp_f32 v226, v226
    v_rcp_f32 v227, v227
    v_rcp_f32 v228, v228
    v_rcp_f32 v229, v229
    v_pk_mul_f32 v[168:169], v[168:169], v[222:223]
    v_pk_mul_f32 v[170:171], v[170:171], v[224:225]
    v_pk_mul_f32 v[172:173], v[172:173], v[226:227]
    v_pk_mul_f32 v[174:175], v[174:175], v[228:229]
    v_pk_mul_f32 v[222:223], v[176:177], v[176:177]
    v_pk_mul_f32 v[224:225], v[178:179], v[178:179]
    v_pk_mul_f32 v[226:227], v[180:181], v[180:181]
    v_pk_mul_f32 v[228:229], v[182:183], v[182:183]
    v_pk_fma_f32 v[222:223], v[222:223], v[216:217], v[218:219]
    v_pk_fma_f32 v[224:225], v[224:225], v[216:217], v[218:219]
    v_pk_fma_f32 v[226:227], v[226:227], v[216:217], v[218:219]
    v_pk_fma_f32 v[228:229], v[228:229], v[216:217], v[218:219]
    v_pk_mul_f32 v[222:223], v[222:223], v[176:177]
    v_pk_mul_f32 v[224:225], v[224:225], v[178:179]
    v_pk_mul_f32 v[226:227], v[226:227], v[180:181]
    v_pk_mul_f32 v[228:229], v[228:229], v[182:183]
    v_exp_f32 v222, v222
    v_exp_f32 v223, v223
    v_exp_f32 v224, v224
    v_exp_f32 v225, v225
    v_exp_f32 v226, v226
    v_exp_f32 v227, v227
    v_exp_f32 v228, v228
    v_exp_f32 v229, v229
    v_pk_add_f32 v[222:223], v[222:223], v[220:221]
    v_pk_add_f32 v[224:225], v[224:225], v[220:221]
    v_pk_add_f32 v[226:227], v[226:227], v[220:221]
    v_pk_add_f32 v[228:229], v[228:229], v[220:221]
    v_rcp_f32 v222, v222
    v_rcp_f32 v223, v223
    v_rcp_f32 v224, v224
    v_rcp_f32 v225, v225
    v_rcp_f32 v226, v226
    v_rcp_f32 v227, v227
    v_rcp_f32 v228, v228
    v_rcp_f32 v229, v229
    v_pk_mul_f32 v[176:177], v[176:177], v[222:223]
    v_pk_mul_f32 v[178:179], v[178:179], v[224:225]
    v_pk_mul_f32 v[180:181], v[180:181], v[226:227]
    v_pk_mul_f32 v[182:183], v[182:183], v[228:229]
    v_pk_mul_f32 v[222:223], v[184:185], v[184:185]
    v_pk_mul_f32 v[224:225], v[186:187], v[186:187]
    v_pk_mul_f32 v[226:227], v[188:189], v[188:189]
    v_pk_mul_f32 v[228:229], v[190:191], v[190:191]
    v_pk_fma_f32 v[222:223], v[222:223], v[216:217], v[218:219]
    v_pk_fma_f32 v[224:225], v[224:225], v[216:217], v[218:219]
    v_pk_fma_f32 v[226:227], v[226:227], v[216:217], v[218:219]
    v_pk_fma_f32 v[228:229], v[228:229], v[216:217], v[218:219]
    v_pk_mul_f32 v[222:223], v[222:223], v[184:185]
    v_pk_mul_f32 v[224:225], v[224:225], v[186:187]
    v_pk_mul_f32 v[226:227], v[226:227], v[188:189]
    v_pk_mul_f32 v[228:229], v[228:229], v[190:191]
    v_exp_f32 v222, v222
    v_exp_f32 v223, v223
    v_exp_f32 v224, v224
    v_exp_f32 v225, v225
    v_exp_f32 v226, v226
    v_exp_f32 v227, v227
    v_exp_f32 v228, v228
    v_exp_f32 v229, v229
    v_pk_add_f32 v[222:223], v[222:223], v[220:221]
    v_pk_add_f32 v[224:225], v[224:225], v[220:221]
    v_pk_add_f32 v[226:227], v[226:227], v[220:221]
    v_pk_add_f32 v[228:229], v[228:229], v[220:221]
    v_rcp_f32 v222, v222
    v_rcp_f32 v223, v223
    v_rcp_f32 v224, v224
    v_rcp_f32 v225, v225
    v_rcp_f32 v226, v226
    v_rcp_f32 v227, v227
    v_rcp_f32 v228, v228
    v_rcp_f32 v229, v229
    v_pk_mul_f32 v[184:185], v[184:185], v[222:223]
    v_pk_mul_f32 v[186:187], v[186:187], v[224:225]
    v_pk_mul_f32 v[188:189], v[188:189], v[226:227]
    v_pk_mul_f32 v[190:191], v[190:191], v[228:229]
    v_pk_mul_f32 v[222:223], v[192:193], v[192:193]
    v_pk_mul_f32 v[224:225], v[194:195], v[194:195]
    v_pk_mul_f32 v[226:227], v[196:197], v[196:197]
    v_pk_mul_f32 v[228:229], v[198:199], v[198:199]
    v_pk_fma_f32 v[222:223], v[222:223], v[216:217], v[218:219]
    v_pk_fma_f32 v[224:225], v[224:225], v[216:217], v[218:219]
    v_pk_fma_f32 v[226:227], v[226:227], v[216:217], v[218:219]
    v_pk_fma_f32 v[228:229], v[228:229], v[216:217], v[218:219]
    v_pk_mul_f32 v[222:223], v[222:223], v[192:193]
    v_pk_mul_f32 v[224:225], v[224:225], v[194:195]
    v_pk_mul_f32 v[226:227], v[226:227], v[196:197]
    v_pk_mul_f32 v[228:229], v[228:229], v[198:199]
    v_exp_f32 v222, v222
    v_exp_f32 v223, v223
    v_exp_f32 v224, v224
    v_exp_f32 v225, v225
    v_exp_f32 v226, v226
    v_exp_f32 v227, v227
    v_exp_f32 v228, v228
    v_exp_f32 v229, v229
    v_pk_add_f32 v[222:223], v[222:223], v[220:221]
    v_pk_add_f32 v[224:225], v[224:225], v[220:221]
    v_pk_add_f32 v[226:227], v[226:227], v[220:221]
    v_pk_add_f32 v[228:229], v[228:229], v[220:221]
    v_rcp_f32 v222, v222
    v_rcp_f32 v223, v223
    v_rcp_f32 v224, v224
    v_rcp_f32 v225, v225
    v_rcp_f32 v226, v226
    v_rcp_f32 v227, v227
    v_rcp_f32 v228, v228
    v_rcp_f32 v229, v229
    v_pk_mul_f32 v[192:193], v[192:193], v[222:223]
    v_pk_mul_f32 v[194:195], v[194:195], v[224:225]
    v_pk_mul_f32 v[196:197], v[196:197], v[226:227]
    v_pk_mul_f32 v[198:199], v[198:199], v[228:229]
    v_pk_mul_f32 v[222:223], v[200:201], v[200:201]
    v_pk_mul_f32 v[224:225], v[202:203], v[202:203]
    v_pk_mul_f32 v[226:227], v[204:205], v[204:205]
    v_pk_mul_f32 v[228:229], v[206:207], v[206:207]
    v_pk_fma_f32 v[222:223], v[222:223], v[216:217], v[218:219]
    v_pk_fma_f32 v[224:225], v[224:225], v[216:217], v[218:219]
    v_pk_fma_f32 v[226:227], v[226:227], v[216:217], v[218:219]
    v_pk_fma_f32 v[228:229], v[228:229], v[216:217], v[218:219]
    v_pk_mul_f32 v[222:223], v[222:223], v[200:201]
    v_pk_mul_f32 v[224:225], v[224:225], v[202:203]
    v_pk_mul_f32 v[226:227], v[226:227], v[204:205]
    v_pk_mul_f32 v[228:229], v[228:229], v[206:207]
    v_exp_f32 v222, v222
    v_exp_f32 v223, v223
    v_exp_f32 v224, v224
    v_exp_f32 v225, v225
    v_exp_f32 v226, v226
    v_exp_f32 v227, v227
    v_exp_f32 v228, v228
    v_exp_f32 v229, v229
    v_pk_add_f32 v[222:223], v[222:223], v[220:221]
    v_pk_add_f32 v[224:225], v[224:225], v[220:221]
    v_pk_add_f32 v[226:227], v[226:227], v[220:221]
    v_pk_add_f32 v[228:229], v[228:229], v[220:221]
    v_rcp_f32 v222, v222
    v_rcp_f32 v223, v223
    v_rcp_f32 v224, v224
    v_rcp_f32 v225, v225
    v_rcp_f32 v226, v226
    v_rcp_f32 v227, v227
    v_rcp_f32 v228, v228
    v_rcp_f32 v229, v229
    v_pk_mul_f32 v[200:201], v[200:201], v[222:223]
    v_pk_mul_f32 v[202:203], v[202:203], v[224:225]
    v_pk_mul_f32 v[204:205], v[204:205], v[226:227]
    v_pk_mul_f32 v[206:207], v[206:207], v[228:229]
    v_pk_mul_f32 v[222:223], v[208:209], v[208:209]
    v_pk_mul_f32 v[224:225], v[210:211], v[210:211]
    v_pk_mul_f32 v[226:227], v[212:213], v[212:213]
    v_pk_mul_f32 v[228:229], v[214:215], v[214:215]
    v_pk_fma_f32 v[222:223], v[222:223], v[216:217], v[218:219]
    v_pk_fma_f32 v[224:225], v[224:225], v[216:217], v[218:219]
    v_pk_fma_f32 v[226:227], v[226:227], v[216:217], v[218:219]
    v_pk_fma_f32 v[228:229], v[228:229], v[216:217], v[218:219]
    v_pk_mul_f32 v[222:223], v[222:223], v[208:209]
    v_pk_mul_f32 v[224:225], v[224:225], v[210:211]
    v_pk_mul_f32 v[226:227], v[226:227], v[212:213]
    v_pk_mul_f32 v[228:229], v[228:229], v[214:215]
    v_exp_f32 v222, v222
    v_exp_f32 v223, v223
    v_exp_f32 v224, v224
    v_exp_f32 v225, v225
    v_exp_f32 v226, v226
    v_exp_f32 v227, v227
    v_exp_f32 v228, v228
    v_exp_f32 v229, v229
    v_pk_add_f32 v[222:223], v[222:223], v[220:221]
    v_pk_add_f32 v[224:225], v[224:225], v[220:221]
    v_pk_add_f32 v[226:227], v[226:227], v[220:221]
    v_pk_add_f32 v[228:229], v[228:229], v[220:221]
    v_rcp_f32 v222, v222
    v_rcp_f32 v223, v223
    v_rcp_f32 v224, v224
    v_rcp_f32 v225, v225
    v_rcp_f32 v226, v226
    v_rcp_f32 v227, v227
    v_rcp_f32 v228, v228
    v_rcp_f32 v229, v229
    v_pk_mul_f32 v[208:209], v[208:209], v[222:223]
    v_pk_mul_f32 v[210:211], v[210:211], v[224:225]
    v_pk_mul_f32 v[212:213], v[212:213], v[226:227]
    v_pk_mul_f32 v[214:215], v[214:215], v[228:229]
    s_lshl_b32 s16, s24, 4
    s_lshl_b32 s17, s7, 2
    s_add_u32 s16, s16, s17
    s_lshl_b32 s16, s16, 4
    s_add_u32 s16, s16, s25
    s_mul_i32 s16, s16, 3584
    s_add_u32 s8, s16, 0x1000000
    s_add_u32 s9, s15, 98304
    s_mov_b32 s11, 0
    v_cvt_pk_bf16_f32 v16, v200, v201
    v_cvt_pk_bf16_f32 v17, v202, v203
    v_cvt_pk_bf16_f32 v18, v204, v205
    v_cvt_pk_bf16_f32 v19, v206, v207
    v_cvt_pk_bf16_f32 v20, v208, v209
    v_cvt_pk_bf16_f32 v21, v210, v211
    v_cvt_pk_bf16_f32 v22, v212, v213
    v_cvt_pk_bf16_f32 v23, v214, v215
    v_cvt_pk_bf16_f32 v210, v184, v185
    v_cvt_pk_bf16_f32 v211, v186, v187
    v_cvt_pk_bf16_f32 v224, v188, v189
    v_cvt_pk_bf16_f32 v225, v190, v191
    v_cvt_pk_bf16_f32 v238, v192, v193
    v_cvt_pk_bf16_f32 v239, v194, v195
    v_cvt_pk_bf16_f32 v252, v196, v197
    v_cvt_pk_bf16_f32 v253, v198, v199
    v_cvt_pk_bf16_f32 v208, v168, v169
    v_cvt_pk_bf16_f32 v209, v170, v171
    v_cvt_pk_bf16_f32 v222, v172, v173
    v_cvt_pk_bf16_f32 v223, v174, v175
    v_cvt_pk_bf16_f32 v236, v176, v177
    v_cvt_pk_bf16_f32 v237, v178, v179
    v_cvt_pk_bf16_f32 v250, v180, v181
    v_cvt_pk_bf16_f32 v251, v182, v183
    v_cvt_pk_bf16_f32 v206, v152, v153
    v_cvt_pk_bf16_f32 v207, v154, v155
    v_cvt_pk_bf16_f32 v220, v156, v157
    v_cvt_pk_bf16_f32 v221, v158, v159
    v_cvt_pk_bf16_f32 v234, v160, v161
    v_cvt_pk_bf16_f32 v235, v162, v163
    v_cvt_pk_bf16_f32 v248, v164, v165
    v_cvt_pk_bf16_f32 v249, v166, v167
    v_cvt_pk_bf16_f32 v204, v136, v137
    v_cvt_pk_bf16_f32 v205, v138, v139
    v_cvt_pk_bf16_f32 v218, v140, v141
    v_cvt_pk_bf16_f32 v219, v142, v143
    v_cvt_pk_bf16_f32 v232, v144, v145
    v_cvt_pk_bf16_f32 v233, v146, v147
    v_cvt_pk_bf16_f32 v246, v148, v149
    v_cvt_pk_bf16_f32 v247, v150, v151
    v_cvt_pk_bf16_f32 v202, v120, v121
    v_cvt_pk_bf16_f32 v203, v122, v123
    v_cvt_pk_bf16_f32 v216, v124, v125
    v_cvt_pk_bf16_f32 v217, v126, v127
    v_cvt_pk_bf16_f32 v230, v128, v129
    v_cvt_pk_bf16_f32 v231, v130, v131
    v_cvt_pk_bf16_f32 v244, v132, v133
    v_cvt_pk_bf16_f32 v245, v134, v135
    v_cvt_pk_bf16_f32 v200, v104, v105
    v_cvt_pk_bf16_f32 v201, v106, v107
    v_cvt_pk_bf16_f32 v214, v108, v109
    v_cvt_pk_bf16_f32 v215, v110, v111
    v_cvt_pk_bf16_f32 v228, v112, v113
    v_cvt_pk_bf16_f32 v229, v114, v115
    v_cvt_pk_bf16_f32 v242, v116, v117
    v_cvt_pk_bf16_f32 v243, v118, v119
    v_mov_b32 v212, v16
    v_mov_b32 v213, v17
    v_mov_b32 v226, v18
    v_mov_b32 v227, v19
    v_mov_b32 v240, v20
    v_mov_b32 v241, v21
    v_mov_b32 v254, v22
    v_mov_b32 v255, v23
    s_setprio 1
    v_lshlrev_b32 v10, 7, v9
    s_lshl_b32 s16, s35, 2
    s_add_u32 s16, s16, s7
    s_lshl_b32 s16, s16, 13
    buffer_load_dword v14, v10, s[52:55], s16 offen
    s_xor_b32 s16, s16, 0x200000
    buffer_load_dword v15, v10, s[48:51], s16 offen
    s_branch m_zjoin
m_z2wave:
    v_mov_b32 v104, 0
    v_mov_b32 v105, 0
    v_mov_b32 v106, 0
    v_mov_b32 v107, 0
    v_mov_b32 v108, 0
    v_mov_b32 v109, 0
    v_mov_b32 v110, 0
    v_mov_b32 v111, 0
    v_mov_b32 v112, 0
    v_mov_b32 v113, 0
    v_mov_b32 v114, 0
    v_mov_b32 v115, 0
    v_mov_b32 v116, 0
    v_mov_b32 v117, 0
    v_mov_b32 v118, 0
    v_mov_b32 v119, 0
    v_mov_b32 v120, 0
    v_mov_b32 v121, 0
    v_mov_b32 v122, 0
    v_mov_b32 v123, 0
    v_mov_b32 v124, 0
    v_mov_b32 v125, 0
    v_mov_b32 v126, 0
    v_mov_b32 v127, 0
    v_mov_b32 v128, 0
    v_mov_b32 v129, 0
    v_mov_b32 v130, 0
    v_mov_b32 v131, 0
    v_mov_b32 v132, 0
    v_mov_b32 v133, 0
    v_mov_b32 v134, 0
    v_mov_b32 v135, 0
    v_mov_b32 v136, 0
    v_mov_b32 v137, 0
    v_mov_b32 v138, 0
    v_mov_b32 v139, 0
    v_mov_b32 v140, 0
    v_mov_b32 v141, 0
    v_mov_b32 v142, 0
    v_mov_b32 v143, 0
    v_mov_b32 v144, 0
    v_mov_b32 v145, 0
    v_mov_b32 v146, 0
    v_mov_b32 v147, 0
    v_mov_b32 v148, 0
    v_mov_b32 v149, 0
    v_mov_b32 v150, 0
    v_mov_b32 v151, 0
    v_mov_b32 v152, 0
    v_mov_b32 v153, 0
    v_mov_b32 v154, 0
    v_mov_b32 v155, 0
    v_mov_b32 v156, 0
    v_mov_b32 v157, 0
    v_mov_b32 v158, 0
    v_mov_b32 v159, 0
    v_mov_b32 v160, 0
    v_mov_b32 v161, 0
    v_mov_b32 v162, 0
    v_mov_b32 v163, 0
    v_mov_b32 v164, 0
    v_mov_b32 v165, 0
    v_mov_b32 v166, 0
    v_mov_b32 v167, 0
    v_mov_b32 v168, 0
    v_mov_b32 v169, 0
    v_mov_b32 v170, 0
    v_mov_b32 v171, 0
    v_mov_b32 v172, 0
    v_mov_b32 v173, 0
    v_mov_b32 v174, 0
    v_mov_b32 v175, 0
    v_mov_b32 v176, 0
    v_mov_b32 v177, 0
    v_mov_b32 v178, 0
    v_mov_b32 v179, 0
    v_mov_b32 v180, 0
    v_mov_b32 v181, 0
    v_mov_b32 v182, 0
    v_mov_b32 v183, 0
    v_mov_b32 v184, 0
    v_mov_b32 v185, 0
    v_mov_b32 v186, 0
    v_mov_b32 v187, 0
    v_mov_b32 v188, 0
    v_mov_b32 v189, 0
    v_mov_b32 v190, 0
    v_mov_b32 v191, 0
    v_mov_b32 v192, 0
    v_mov_b32 v193, 0
    v_mov_b32 v194, 0
    v_mov_b32 v195, 0
    v_mov_b32 v196, 0
    v_mov_b32 v197, 0
    v_mov_b32 v198, 0
    v_mov_b32 v199, 0
    v_mov_b32 v200, 0
    v_mov_b32 v201, 0
    v_mov_b32 v202, 0
    v_mov_b32 v203, 0
    v_mov_b32 v204, 0
    v_mov_b32 v205, 0
    v_mov_b32 v206, 0
    v_mov_b32 v207, 0
    v_mov_b32 v208, 0
    v_mov_b32 v209, 0
    v_mov_b32 v210, 0
    v_mov_b32 v211, 0
    v_mov_b32 v212, 0
    v_mov_b32 v213, 0
    v_mov_b32 v214, 0
    v_mov_b32 v215, 0
    v_mov_b32 v3, v1
    v_mov_b32 v4, v2
    s_mov_b32 s26, 0
    s_mov_b32 s27, 0
    s_add_u32 m0, s27, s31
    s_nop 0
    buffer_load_dwordx4 v6, s[40:43], s29 offen lds
    buffer_load_dwordx4 v7, s[40:43], s29 offen offset:1024 lds
    s_add_u32 s29, s29, 229376
    s_mov_b32 s27, 32768
    s_add_u32 m0, s27, s31
    s_nop 0
    buffer_load_dwordx4 v6, s[40:43], s29 offen lds
    buffer_load_dwordx4 v7, s[40:43], s29 offen offset:1024 lds
    s_add_u32 s29, s29, 229376
    s_mov_b32 s27, 65536
    s_add_u32 m0, s27, s31
    s_nop 0
    buffer_load_dwordx4 v6, s[40:43], s29 offen lds
    buffer_load_dwordx4 v7, s[40:43], s29 offen offset:1024 lds
    s_add_u32 s29, s29, 229376
    s_mov_b32 s27, 98304
    s_add_u32 m0, s27, s31
    s_nop 0
    buffer_load_dwordx4 v6, s[40:43], s29 offen lds
    buffer_load_dwordx4 v7, s[40:43], s29 offen offset:1024 lds
    s_add_u32 s29, s29, 229376
    s_mov_b32 s27, 131072
    s_add_u32 m0, s27, s31
    s_nop 0
    buffer_load_dwordx4 v6, s[40:43], s29 offen lds
    buffer_load_dwordx4 v7, s[40:43], s29 offen offset:1024 lds
    s_add_u32 s29, s29, 229376
    s_barrier
    s_mov_b32 s27, 0
    s_add_u32 m0, s27, s30
    s_nop 0
    buffer_load_dwordx4 v5, s[36:39], s28 offen offset:0 sc1 lds
    buffer_load_dwordx4 v5, s[36:39], s28 offen offset:1024 sc1 lds
    s_add_u32 s28, s28, 16384
    s_barrier
    s_mov_b32 s27, 32768
    s_add_u32 m0, s27, s30
    s_nop 0
    buffer_load_dwordx4 v5, s[36:39], s28 offen offset:0 sc1 lds
    buffer_load_dwordx4 v5, s[36:39], s28 offen offset:1024 sc1 lds
    s_add_u32 s28, s28, 16384
    s_mov_b32 s27, 65536
    s_add_u32 m0, s27, s30
    s_nop 0
    buffer_load_dwordx4 v5, s[36:39], s28 offen offset:0 sc1 lds
    buffer_load_dwordx4 v5, s[36:39], s28 offen offset:1024 sc1 lds
    s_add_u32 s28, s28, 16384
    s_waitcnt vmcnt(4)
    s_barrier
    ds_read_b64_tr_b16 v[48:49], v4 offset:24576
    ds_read_b64_tr_b16 v[50:51], v4 offset:28672
    ds_read_b128 v[16:19], v3 offset:0
    ds_read_b128 v[20:23], v3 offset:1024
    ds_read_b128 v[24:27], v3 offset:2048
    ds_read_b128 v[28:31], v3 offset:3072
    ds_read_b64_tr_b16 v[52:53], v4 offset:24608
    ds_read_b64_tr_b16 v[54:55], v4 offset:28704
    ds_read_b64_tr_b16 v[56:57], v4 offset:24640
    ds_read_b64_tr_b16 v[58:59], v4 offset:28736
    ds_read_b64_tr_b16 v[60:61], v4 offset:24672
    ds_read_b64_tr_b16 v[62:63], v4 offset:28768
    ds_read_b64_tr_b16 v[64:65], v4 offset:24704
    ds_read_b64_tr_b16 v[66:67], v4 offset:28800
    ds_read_b64_tr_b16 v[68:69], v4 offset:24736
    ds_read_b64_tr_b16 v[70:71], v4 offset:28832
    ds_read_b64_tr_b16 v[72:73], v4 offset:24768
    ds_read_b64_tr_b16 v[74:75], v4 offset:28864
    s_mov_b32 s27, s26
    s_add_u32 s26, s26, 32768
    s_cmp_eq_u32 s26, 163840
    s_cselect_b32 s26, 0, s26
    v_add_u32 v3, s26, v1
    v_add_u32 v4, s26, v2
    s_waitcnt vmcnt(2) lgkmcnt(0)
    s_barrier
    v_mfma_f32_16x16x32_bf16 v[104:107], v[16:19], v[48:51], v[104:107]
    ds_read_b64_tr_b16 v[76:77], v4 offset:24576
    s_mov_b32 s27, 98304
    s_add_u32 m0, s27, s30
    v_mfma_f32_16x16x32_bf16 v[108:111], v[20:23], v[48:51], v[108:111]
    ds_read_b64_tr_b16 v[78:79], v4 offset:28672
    buffer_load_dwordx4 v5, s[36:39], s28 offen offset:0 sc1 lds
    v_mfma_f32_16x16x32_bf16 v[112:115], v[24:27], v[48:51], v[112:115]
    ds_read_b128 v[32:35], v3 offset:0
    v_mfma_f32_16x16x32_bf16 v[116:119], v[28:31], v[48:51], v[116:119]
    ds_read_b128 v[36:39], v3 offset:1024
    buffer_load_dwordx4 v5, s[36:39], s28 offen offset:1024 sc1 lds
    v_mfma_f32_16x16x32_bf16 v[120:123], v[16:19], v[52:55], v[120:123]
    ds_read_b128 v[40:43], v3 offset:2048
    s_add_u32 s28, s28, 16384
    s_mov_b32 s27, 131072
    s_add_u32 m0, s27, s30
    v_mfma_f32_16x16x32_bf16 v[124:127], v[20:23], v[52:55], v[124:127]
    ds_read_b128 v[44:47], v3 offset:3072
    buffer_load_dwordx4 v5, s[36:39], s28 offen offset:0 sc1 lds
    v_mfma_f32_16x16x32_bf16 v[128:131], v[24:27], v[52:55], v[128:131]
    ds_read_b64_tr_b16 v[80:81], v4 offset:24608
    v_mfma_f32_16x16x32_bf16 v[132:135], v[28:31], v[52:55], v[132:135]
    ds_read_b64_tr_b16 v[82:83], v4 offset:28704
    v_mfma_f32_16x16x32_bf16 v[136:139], v[16:19], v[56:59], v[136:139]
    ds_read_b64_tr_b16 v[84:85], v4 offset:24640
    buffer_load_dwordx4 v5, s[36:39], s28 offen offset:1024 sc1 lds
    v_mfma_f32_16x16x32_bf16 v[140:143], v[20:23], v[56:59], v[140:143]
    ds_read_b64_tr_b16 v[86:87], v4 offset:28736
    s_add_u32 s28, s28, 16384
    s_mov_b32 s27, 0
    s_add_u32 m0, s27, s30
    v_mfma_f32_16x16x32_bf16 v[144:147], v[24:27], v[56:59], v[144:147]
    ds_read_b64_tr_b16 v[88:89], v4 offset:24672
    buffer_load_dwordx4 v5, s[36:39], s28 offen offset:0 sc1 lds
    v_mfma_f32_16x16x32_bf16 v[148:151], v[28:31], v[56:59], v[148:151]
    ds_read_b64_tr_b16 v[90:91], v4 offset:28768
    v_mfma_f32_16x16x32_bf16 v[152:155], v[16:19], v[60:63], v[152:155]
    ds_read_b64_tr_b16 v[92:93], v4 offset:24704
    buffer_load_dwordx4 v5, s[36:39], s28 offen offset:1024 sc1 lds
    v_mfma_f32_16x16x32_bf16 v[156:159], v[20:23], v[60:63], v[156:159]
    ds_read_b64_tr_b16 v[94:95], v4 offset:28800
    s_add_u32 s28, s28, 16384
    v_mfma_f32_16x16x32_bf16 v[160:163], v[24:27], v[60:63], v[160:163]
    ds_read_b64_tr_b16 v[96:97], v4 offset:24736
    s_add_u32 m0, s27, s31
    v_mfma_f32_16x16x32_bf16 v[164:167], v[28:31], v[60:63], v[164:167]
    ds_read_b64_tr_b16 v[98:99], v4 offset:28832
    buffer_load_dwordx4 v6, s[40:43], s29 offen lds
    v_mfma_f32_16x16x32_bf16 v[168:171], v[16:19], v[64:67], v[168:171]
    ds_read_b64_tr_b16 v[100:101], v4 offset:24768
    v_mfma_f32_16x16x32_bf16 v[172:175], v[20:23], v[64:67], v[172:175]
    ds_read_b64_tr_b16 v[102:103], v4 offset:28864
    buffer_load_dwordx4 v7, s[40:43], s29 offen offset:1024 lds
    v_mfma_f32_16x16x32_bf16 v[176:179], v[24:27], v[64:67], v[176:179]
    s_add_u32 s29, s29, 229376
    v_mfma_f32_16x16x32_bf16 v[180:183], v[28:31], v[64:67], v[180:183]
    v_mfma_f32_16x16x32_bf16 v[184:187], v[16:19], v[68:71], v[184:187]
    s_mov_b32 s27, s26
    s_add_u32 s26, s26, 32768
    v_mfma_f32_16x16x32_bf16 v[188:191], v[20:23], v[68:71], v[188:191]
    s_cmp_eq_u32 s26, 163840
    s_cselect_b32 s26, 0, s26
    v_mfma_f32_16x16x32_bf16 v[192:195], v[24:27], v[68:71], v[192:195]
    v_add_u32 v3, s26, v1
    v_add_u32 v4, s26, v2
    v_mfma_f32_16x16x32_bf16 v[196:199], v[28:31], v[68:71], v[196:199]
    s_waitcnt vmcnt(8) lgkmcnt(0)
    s_barrier
    v_mfma_f32_16x16x32_bf16 v[200:203], v[16:19], v[72:75], v[200:203]
    v_mfma_f32_16x16x32_bf16 v[204:207], v[20:23], v[72:75], v[204:207]
    v_mfma_f32_16x16x32_bf16 v[208:211], v[24:27], v[72:75], v[208:211]
    v_mfma_f32_16x16x32_bf16 v[212:215], v[28:31], v[72:75], v[212:215]
    v_mfma_f32_16x16x32_bf16 v[104:107], v[32:35], v[76:79], v[104:107]
    ds_read_b64_tr_b16 v[48:49], v4 offset:24576
    v_mfma_f32_16x16x32_bf16 v[108:111], v[36:39], v[76:79], v[108:111]
    ds_read_b64_tr_b16 v[50:51], v4 offset:28672
    v_mfma_f32_16x16x32_bf16 v[112:115], v[40:43], v[76:79], v[112:115]
    ds_read_b128 v[16:19], v3 offset:0
    s_mov_b32 s27, 32768
    s_add_u32 m0, s27, s30
    v_mfma_f32_16x16x32_bf16 v[116:119], v[44:47], v[76:79], v[116:119]
    ds_read_b128 v[20:23], v3 offset:1024
    buffer_load_dwordx4 v5, s[36:39], s28 offen offset:0 sc1 lds
    v_mfma_f32_16x16x32_bf16 v[120:123], v[32:35], v[80:83], v[120:123]
    ds_read_b128 v[24:27], v3 offset:2048
    v_mfma_f32_16x16x32_bf16 v[124:127], v[36:39], v[80:83], v[124:127]
    ds_read_b128 v[28:31], v3 offset:3072
    v_mfma_f32_16x16x32_bf16 v[128:131], v[40:43], v[80:83], v[128:131]
    ds_read_b64_tr_b16 v[52:53], v4 offset:24608
    v_mfma_f32_16x16x32_bf16 v[132:135], v[44:47], v[80:83], v[132:135]
    ds_read_b64_tr_b16 v[54:55], v4 offset:28704
    v_mfma_f32_16x16x32_bf16 v[136:139], v[32:35], v[84:87], v[136:139]
    ds_read_b64_tr_b16 v[56:57], v4 offset:24640
    v_mfma_f32_16x16x32_bf16 v[140:143], v[36:39], v[84:87], v[140:143]
    ds_read_b64_tr_b16 v[58:59], v4 offset:28736
    buffer_load_dwordx4 v5, s[36:39], s28 offen offset:1024 sc1 lds
    v_mfma_f32_16x16x32_bf16 v[144:147], v[40:43], v[84:87], v[144:147]
    ds_read_b64_tr_b16 v[60:61], v4 offset:24672
    s_add_u32 s28, s28, 16384
    v_mfma_f32_16x16x32_bf16 v[148:151], v[44:47], v[84:87], v[148:151]
    ds_read_b64_tr_b16 v[62:63], v4 offset:28768
    v_mfma_f32_16x16x32_bf16 v[152:155], v[32:35], v[88:91], v[152:155]
    ds_read_b64_tr_b16 v[64:65], v4 offset:24704
    v_mfma_f32_16x16x32_bf16 v[156:159], v[36:39], v[88:91], v[156:159]
    ds_read_b64_tr_b16 v[66:67], v4 offset:28800
    s_add_u32 m0, s27, s31
    v_mfma_f32_16x16x32_bf16 v[160:163], v[40:43], v[88:91], v[160:163]
    ds_read_b64_tr_b16 v[68:69], v4 offset:24736
    buffer_load_dwordx4 v6, s[40:43], s29 offen lds
    v_mfma_f32_16x16x32_bf16 v[164:167], v[44:47], v[88:91], v[164:167]
    ds_read_b64_tr_b16 v[70:71], v4 offset:28832
    v_mfma_f32_16x16x32_bf16 v[168:171], v[32:35], v[92:95], v[168:171]
    ds_read_b64_tr_b16 v[72:73], v4 offset:24768
    v_mfma_f32_16x16x32_bf16 v[172:175], v[36:39], v[92:95], v[172:175]
    ds_read_b64_tr_b16 v[74:75], v4 offset:28864
    v_mfma_f32_16x16x32_bf16 v[176:179], v[40:43], v[92:95], v[176:179]
    v_mfma_f32_16x16x32_bf16 v[180:183], v[44:47], v[92:95], v[180:183]
    buffer_load_dwordx4 v7, s[40:43], s29 offen offset:1024 lds
    v_mfma_f32_16x16x32_bf16 v[184:187], v[32:35], v[96:99], v[184:187]
    s_add_u32 s29, s29, 229376
    s_mov_b32 s27, s26
    s_add_u32 s26, s26, 32768
    v_mfma_f32_16x16x32_bf16 v[188:191], v[36:39], v[96:99], v[188:191]
    s_cmp_eq_u32 s26, 163840
    s_cselect_b32 s26, 0, s26
    v_mfma_f32_16x16x32_bf16 v[192:195], v[40:43], v[96:99], v[192:195]
    v_add_u32 v3, s26, v1
    v_add_u32 v4, s26, v2
    v_mfma_f32_16x16x32_bf16 v[196:199], v[44:47], v[96:99], v[196:199]
    s_waitcnt vmcnt(10) lgkmcnt(0)
    s_barrier
    v_mfma_f32_16x16x32_bf16 v[200:203], v[32:35], v[100:103], v[200:203]
    v_mfma_f32_16x16x32_bf16 v[204:207], v[36:39], v[100:103], v[204:207]
    v_mfma_f32_16x16x32_bf16 v[208:211], v[40:43], v[100:103], v[208:211]
    v_mfma_f32_16x16x32_bf16 v[212:215], v[44:47], v[100:103], v[212:215]
    v_mfma_f32_16x16x32_bf16 v[104:107], v[16:19], v[48:51], v[104:107]
    ds_read_b64_tr_b16 v[76:77], v4 offset:24576
    v_mfma_f32_16x16x32_bf16 v[108:111], v[20:23], v[48:51], v[108:111]
    ds_read_b64_tr_b16 v[78:79], v4 offset:28672
    v_mfma_f32_16x16x32_bf16 v[112:115], v[24:27], v[48:51], v[112:115]
    ds_read_b128 v[32:35], v3 offset:0
    s_mov_b32 s27, 65536
    s_add_u32 m0, s27, s30
    v_mfma_f32_16x16x32_bf16 v[116:119], v[28:31], v[48:51], v[116:119]
    ds_read_b128 v[36:39], v3 offset:1024
    buffer_load_dwordx4 v5, s[36:39], s28 offen offset:0 sc1 lds
    v_mfma_f32_16x16x32_bf16 v[120:123], v[16:19], v[52:55], v[120:123]
    ds_read_b128 v[40:43], v3 offset:2048
    v_mfma_f32_16x16x32_bf16 v[124:127], v[20:23], v[52:55], v[124:127]
    ds_read_b128 v[44:47], v3 offset:3072
    v_mfma_f32_16x16x32_bf16 v[128:131], v[24:27], v[52:55], v[128:131]
    ds_read_b64_tr_b16 v[80:81], v4 offset:24608
    v_mfma_f32_16x16x32_bf16 v[132:135], v[28:31], v[52:55], v[132:135]
    ds_read_b64_tr_b16 v[82:83], v4 offset:28704
    v_mfma_f32_16x16x32_bf16 v[136:139], v[16:19], v[56:59], v[136:139]
    ds_read_b64_tr_b16 v[84:85], v4 offset:24640
    v_mfma_f32_16x16x32_bf16 v[140:143], v[20:23], v[56:59], v[140:143]
    ds_read_b64_tr_b16 v[86:87], v4 offset:28736
    buffer_load_dwordx4 v5, s[36:39], s28 offen offset:1024 sc1 lds
    v_mfma_f32_16x16x32_bf16 v[144:147], v[24:27], v[56:59], v[144:147]
    ds_read_b64_tr_b16 v[88:89], v4 offset:24672
    s_add_u32 s28, s28, 16384
    v_mfma_f32_16x16x32_bf16 v[148:151], v[28:31], v[56:59], v[148:151]
    ds_read_b64_tr_b16 v[90:91], v4 offset:28768
    v_mfma_f32_16x16x32_bf16 v[152:155], v[16:19], v[60:63], v[152:155]
    ds_read_b64_tr_b16 v[92:93], v4 offset:24704
    v_mfma_f32_16x16x32_bf16 v[156:159], v[20:23], v[60:63], v[156:159]
    ds_read_b64_tr_b16 v[94:95], v4 offset:28800
    s_add_u32 m0, s27, s31
    v_mfma_f32_16x16x32_bf16 v[160:163], v[24:27], v[60:63], v[160:163]
    ds_read_b64_tr_b16 v[96:97], v4 offset:24736
    buffer_load_dwordx4 v6, s[40:43], s29 offen lds
    v_mfma_f32_16x16x32_bf16 v[164:167], v[28:31], v[60:63], v[164:167]
    ds_read_b64_tr_b16 v[98:99], v4 offset:28832
    v_mfma_f32_16x16x32_bf16 v[168:171], v[16:19], v[64:67], v[168:171]
    ds_read_b64_tr_b16 v[100:101], v4 offset:24768
    v_mfma_f32_16x16x32_bf16 v[172:175], v[20:23], v[64:67], v[172:175]
    ds_read_b64_tr_b16 v[102:103], v4 offset:28864
    v_mfma_f32_16x16x32_bf16 v[176:179], v[24:27], v[64:67], v[176:179]
    v_mfma_f32_16x16x32_bf16 v[180:183], v[28:31], v[64:67], v[180:183]
    buffer_load_dwordx4 v7, s[40:43], s29 offen offset:1024 lds
    v_mfma_f32_16x16x32_bf16 v[184:187], v[16:19], v[68:71], v[184:187]
    s_add_u32 s29, s29, 229376
    s_mov_b32 s27, s26
    s_add_u32 s26, s26, 32768
    v_mfma_f32_16x16x32_bf16 v[188:191], v[20:23], v[68:71], v[188:191]
    s_cmp_eq_u32 s26, 163840
    s_cselect_b32 s26, 0, s26
    v_mfma_f32_16x16x32_bf16 v[192:195], v[24:27], v[68:71], v[192:195]
    v_add_u32 v3, s26, v1
    v_add_u32 v4, s26, v2
    v_mfma_f32_16x16x32_bf16 v[196:199], v[28:31], v[68:71], v[196:199]
    s_waitcnt vmcnt(12) lgkmcnt(0)
    s_barrier
    v_mfma_f32_16x16x32_bf16 v[200:203], v[16:19], v[72:75], v[200:203]
    v_mfma_f32_16x16x32_bf16 v[204:207], v[20:23], v[72:75], v[204:207]
    v_mfma_f32_16x16x32_bf16 v[208:211], v[24:27], v[72:75], v[208:211]
    v_mfma_f32_16x16x32_bf16 v[212:215], v[28:31], v[72:75], v[212:215]
    v_mfma_f32_16x16x32_bf16 v[104:107], v[32:35], v[76:79], v[104:107]
    ds_read_b64_tr_b16 v[48:49], v4 offset:24576
    buffer_load_dword v248, v229, s[40:43], s8 offen
    buffer_load_dword v249, v229, s[20:23], s8 offen
    s_add_u32 s8, s8, 0x200000
    v_mfma_f32_16x16x32_bf16 v[108:111], v[36:39], v[76:79], v[108:111]
    ds_read_b64_tr_b16 v[50:51], v4 offset:28672
    v_mfma_f32_16x16x32_bf16 v[112:115], v[40:43], v[76:79], v[112:115]
    ds_read_b128 v[16:19], v3 offset:0
    s_mov_b32 s27, 98304
    s_add_u32 m0, s27, s30
    v_mfma_f32_16x16x32_bf16 v[116:119], v[44:47], v[76:79], v[116:119]
    ds_read_b128 v[20:23], v3 offset:1024
    buffer_load_dwordx4 v5, s[36:39], s28 offen offset:0 sc1 lds
    v_mfma_f32_16x16x32_bf16 v[120:123], v[32:35], v[80:83], v[120:123]
    ds_read_b128 v[24:27], v3 offset:2048
    v_mfma_f32_16x16x32_bf16 v[124:127], v[36:39], v[80:83], v[124:127]
    ds_read_b128 v[28:31], v3 offset:3072
    v_mfma_f32_16x16x32_bf16 v[128:131], v[40:43], v[80:83], v[128:131]
    ds_read_b64_tr_b16 v[52:53], v4 offset:24608
    v_mfma_f32_16x16x32_bf16 v[132:135], v[44:47], v[80:83], v[132:135]
    ds_read_b64_tr_b16 v[54:55], v4 offset:28704
    v_mfma_f32_16x16x32_bf16 v[136:139], v[32:35], v[84:87], v[136:139]
    ds_read_b64_tr_b16 v[56:57], v4 offset:24640
    v_mfma_f32_16x16x32_bf16 v[140:143], v[36:39], v[84:87], v[140:143]
    ds_read_b64_tr_b16 v[58:59], v4 offset:28736
    buffer_load_dwordx4 v5, s[36:39], s28 offen offset:1024 sc1 lds
    v_mfma_f32_16x16x32_bf16 v[144:147], v[40:43], v[84:87], v[144:147]
    ds_read_b64_tr_b16 v[60:61], v4 offset:24672
    s_add_u32 s28, s28, 16384
    v_mfma_f32_16x16x32_bf16 v[148:151], v[44:47], v[84:87], v[148:151]
    ds_read_b64_tr_b16 v[62:63], v4 offset:28768
    v_mfma_f32_16x16x32_bf16 v[152:155], v[32:35], v[88:91], v[152:155]
    ds_read_b64_tr_b16 v[64:65], v4 offset:24704
    v_mfma_f32_16x16x32_bf16 v[156:159], v[36:39], v[88:91], v[156:159]
    ds_read_b64_tr_b16 v[66:67], v4 offset:28800
    s_add_u32 m0, s27, s31
    v_mfma_f32_16x16x32_bf16 v[160:163], v[40:43], v[88:91], v[160:163]
    ds_read_b64_tr_b16 v[68:69], v4 offset:24736
    buffer_load_dwordx4 v6, s[40:43], s29 offen lds
    v_mfma_f32_16x16x32_bf16 v[164:167], v[44:47], v[88:91], v[164:167]
    ds_read_b64_tr_b16 v[70:71], v4 offset:28832
    v_mfma_f32_16x16x32_bf16 v[168:171], v[32:35], v[92:95], v[168:171]
    ds_read_b64_tr_b16 v[72:73], v4 offset:24768
    v_mfma_f32_16x16x32_bf16 v[172:175], v[36:39], v[92:95], v[172:175]
    ds_read_b64_tr_b16 v[74:75], v4 offset:28864
    v_mfma_f32_16x16x32_bf16 v[176:179], v[40:43], v[92:95], v[176:179]
    v_mfma_f32_16x16x32_bf16 v[180:183], v[44:47], v[92:95], v[180:183]
    buffer_load_dwordx4 v7, s[40:43], s29 offen offset:1024 lds
    v_mfma_f32_16x16x32_bf16 v[184:187], v[32:35], v[96:99], v[184:187]
    s_add_u32 s29, s29, 229376
    s_mov_b32 s27, s26
    s_add_u32 s26, s26, 32768
    v_mfma_f32_16x16x32_bf16 v[188:191], v[36:39], v[96:99], v[188:191]
    s_cmp_eq_u32 s26, 163840
    s_cselect_b32 s26, 0, s26
    v_mfma_f32_16x16x32_bf16 v[192:195], v[40:43], v[96:99], v[192:195]
    v_add_u32 v3, s26, v1
    v_add_u32 v4, s26, v2
    v_mfma_f32_16x16x32_bf16 v[196:199], v[44:47], v[96:99], v[196:199]
    s_waitcnt vmcnt(12) lgkmcnt(0)
    s_barrier
    v_mfma_f32_16x16x32_bf16 v[200:203], v[32:35], v[100:103], v[200:203]
    v_mfma_f32_16x16x32_bf16 v[204:207], v[36:39], v[100:103], v[204:207]
    v_mfma_f32_16x16x32_bf16 v[208:211], v[40:43], v[100:103], v[208:211]
    v_mfma_f32_16x16x32_bf16 v[212:215], v[44:47], v[100:103], v[212:215]
    s_mov_b32 s32, 11
.p2align 3
g1_z2_loop:
    v_mfma_f32_16x16x32_bf16 v[104:107], v[16:19], v[48:51], v[104:107]
    ds_read_b64_tr_b16 v[76:77], v4 offset:24576
    s_add_u32 s10, s32, s33
    s_bitcmp1_b32 0x550, s10
    s_cbranch_scc1 g1_z2_cp_r
g1_z2_cp_b:
    v_mfma_f32_16x16x32_bf16 v[108:111], v[20:23], v[48:51], v[108:111]
    ds_read_b64_tr_b16 v[78:79], v4 offset:28672
    v_mfma_f32_16x16x32_bf16 v[112:115], v[24:27], v[48:51], v[112:115]
    ds_read_b128 v[32:35], v3 offset:0
    s_add_u32 m0, s27, s30
    v_mfma_f32_16x16x32_bf16 v[116:119], v[28:31], v[48:51], v[116:119]
    ds_read_b128 v[36:39], v3 offset:1024
    buffer_load_dwordx4 v5, s[36:39], s28 offen offset:0 sc1 lds
    v_mfma_f32_16x16x32_bf16 v[120:123], v[16:19], v[52:55], v[120:123]
    ds_read_b128 v[40:43], v3 offset:2048
    v_mfma_f32_16x16x32_bf16 v[124:127], v[20:23], v[52:55], v[124:127]
    ds_read_b128 v[44:47], v3 offset:3072
    v_mfma_f32_16x16x32_bf16 v[128:131], v[24:27], v[52:55], v[128:131]
    ds_read_b64_tr_b16 v[80:81], v4 offset:24608
    v_mfma_f32_16x16x32_bf16 v[132:135], v[28:31], v[52:55], v[132:135]
    ds_read_b64_tr_b16 v[82:83], v4 offset:28704
    v_mfma_f32_16x16x32_bf16 v[136:139], v[16:19], v[56:59], v[136:139]
    ds_read_b64_tr_b16 v[84:85], v4 offset:24640
    v_mfma_f32_16x16x32_bf16 v[140:143], v[20:23], v[56:59], v[140:143]
    ds_read_b64_tr_b16 v[86:87], v4 offset:28736
    buffer_load_dwordx4 v5, s[36:39], s28 offen offset:1024 sc1 lds
    v_mfma_f32_16x16x32_bf16 v[144:147], v[24:27], v[56:59], v[144:147]
    ds_read_b64_tr_b16 v[88:89], v4 offset:24672
    s_add_u32 s28, s28, 16384
    v_mfma_f32_16x16x32_bf16 v[148:151], v[28:31], v[56:59], v[148:151]
    ds_read_b64_tr_b16 v[90:91], v4 offset:28768
    v_mfma_f32_16x16x32_bf16 v[152:155], v[16:19], v[60:63], v[152:155]
    ds_read_b64_tr_b16 v[92:93], v4 offset:24704
    v_mfma_f32_16x16x32_bf16 v[156:159], v[20:23], v[60:63], v[156:159]
    ds_read_b64_tr_b16 v[94:95], v4 offset:28800
    s_add_u32 m0, s27, s31
    v_mfma_f32_16x16x32_bf16 v[160:163], v[24:27], v[60:63], v[160:163]
    ds_read_b64_tr_b16 v[96:97], v4 offset:24736
    buffer_load_dwordx4 v6, s[40:43], s29 offen lds
    v_mfma_f32_16x16x32_bf16 v[164:167], v[28:31], v[60:63], v[164:167]
    ds_read_b64_tr_b16 v[98:99], v4 offset:28832
    v_mfma_f32_16x16x32_bf16 v[168:171], v[16:19], v[64:67], v[168:171]
    ds_read_b64_tr_b16 v[100:101], v4 offset:24768
    v_mfma_f32_16x16x32_bf16 v[172:175], v[20:23], v[64:67], v[172:175]
    ds_read_b64_tr_b16 v[102:103], v4 offset:28864
    v_mfma_f32_16x16x32_bf16 v[176:179], v[24:27], v[64:67], v[176:179]
    v_mfma_f32_16x16x32_bf16 v[180:183], v[28:31], v[64:67], v[180:183]
    buffer_load_dwordx4 v7, s[40:43], s29 offen offset:1024 lds
    v_mfma_f32_16x16x32_bf16 v[184:187], v[16:19], v[68:71], v[184:187]
    s_add_u32 s29, s29, 229376
    s_mov_b32 s27, s26
    s_add_u32 s26, s26, 32768
    v_mfma_f32_16x16x32_bf16 v[188:191], v[20:23], v[68:71], v[188:191]
    s_cmp_eq_u32 s26, 163840
    s_cselect_b32 s26, 0, s26
    v_mfma_f32_16x16x32_bf16 v[192:195], v[24:27], v[68:71], v[192:195]
    v_add_u32 v3, s26, v1
    v_add_u32 v4, s26, v2
    v_mfma_f32_16x16x32_bf16 v[196:199], v[28:31], v[68:71], v[196:199]
    s_waitcnt vmcnt(12) lgkmcnt(0)
    s_barrier
    v_mfma_f32_16x16x32_bf16 v[200:203], v[16:19], v[72:75], v[200:203]
    v_mfma_f32_16x16x32_bf16 v[204:207], v[20:23], v[72:75], v[204:207]
    v_mfma_f32_16x16x32_bf16 v[208:211], v[24:27], v[72:75], v[208:211]
    v_mfma_f32_16x16x32_bf16 v[212:215], v[28:31], v[72:75], v[212:215]
    v_mfma_f32_16x16x32_bf16 v[104:107], v[32:35], v[76:79], v[104:107]
    ds_read_b64_tr_b16 v[48:49], v4 offset:24576
    v_mfma_f32_16x16x32_bf16 v[108:111], v[36:39], v[76:79], v[108:111]
    ds_read_b64_tr_b16 v[50:51], v4 offset:28672
    v_mfma_f32_16x16x32_bf16 v[112:115], v[40:43], v[76:79], v[112:115]
    ds_read_b128 v[16:19], v3 offset:0
    s_add_u32 m0, s27, s30
    v_mfma_f32_16x16x32_bf16 v[116:119], v[44:47], v[76:79], v[116:119]
    ds_read_b128 v[20:23], v3 offset:1024
    buffer_load_dwordx4 v5, s[36:39], s28 offen offset:0 sc1 lds
    v_mfma_f32_16x16x32_bf16 v[120:123], v[32:35], v[80:83], v[120:123]
    ds_read_b128 v[24:27], v3 offset:2048
    v_mfma_f32_16x16x32_bf16 v[124:127], v[36:39], v[80:83], v[124:127]
    ds_read_b128 v[28:31], v3 offset:3072
    v_mfma_f32_16x16x32_bf16 v[128:131], v[40:43], v[80:83], v[128:131]
    ds_read_b64_tr_b16 v[52:53], v4 offset:24608
    v_mfma_f32_16x16x32_bf16 v[132:135], v[44:47], v[80:83], v[132:135]
    ds_read_b64_tr_b16 v[54:55], v4 offset:28704
    v_mfma_f32_16x16x32_bf16 v[136:139], v[32:35], v[84:87], v[136:139]
    ds_read_b64_tr_b16 v[56:57], v4 offset:24640
    v_mfma_f32_16x16x32_bf16 v[140:143], v[36:39], v[84:87], v[140:143]
    ds_read_b64_tr_b16 v[58:59], v4 offset:28736
    buffer_load_dwordx4 v5, s[36:39], s28 offen offset:1024 sc1 lds
    v_mfma_f32_16x16x32_bf16 v[144:147], v[40:43], v[84:87], v[144:147]
    ds_read_b64_tr_b16 v[60:61], v4 offset:24672
    s_add_u32 s28, s28, 16384
    v_mfma_f32_16x16x32_bf16 v[148:151], v[44:47], v[84:87], v[148:151]
    ds_read_b64_tr_b16 v[62:63], v4 offset:28768
    v_mfma_f32_16x16x32_bf16 v[152:155], v[32:35], v[88:91], v[152:155]
    ds_read_b64_tr_b16 v[64:65], v4 offset:24704
    v_mfma_f32_16x16x32_bf16 v[156:159], v[36:39], v[88:91], v[156:159]
    ds_read_b64_tr_b16 v[66:67], v4 offset:28800
    s_add_u32 m0, s27, s31
    v_mfma_f32_16x16x32_bf16 v[160:163], v[40:43], v[88:91], v[160:163]
    ds_read_b64_tr_b16 v[68:69], v4 offset:24736
    buffer_load_dwordx4 v6, s[40:43], s29 offen lds
    v_mfma_f32_16x16x32_bf16 v[164:167], v[44:47], v[88:91], v[164:167]
    ds_read_b64_tr_b16 v[70:71], v4 offset:28832
    v_mfma_f32_16x16x32_bf16 v[168:171], v[32:35], v[92:95], v[168:171]
    ds_read_b64_tr_b16 v[72:73], v4 offset:24768
    v_mfma_f32_16x16x32_bf16 v[172:175], v[36:39], v[92:95], v[172:175]
    ds_read_b64_tr_b16 v[74:75], v4 offset:28864
    v_mfma_f32_16x16x32_bf16 v[176:179], v[40:43], v[92:95], v[176:179]
    v_mfma_f32_16x16x32_bf16 v[180:183], v[44:47], v[92:95], v[180:183]
    buffer_load_dwordx4 v7, s[40:43], s29 offen offset:1024 lds
    v_mfma_f32_16x16x32_bf16 v[184:187], v[32:35], v[96:99], v[184:187]
    s_add_u32 s29, s29, 229376
    s_mov_b32 s27, s26
    s_add_u32 s26, s26, 32768
    v_mfma_f32_16x16x32_bf16 v[188:191], v[36:39], v[96:99], v[188:191]
    s_cmp_eq_u32 s26, 163840
    s_cselect_b32 s26, 0, s26
    v_mfma_f32_16x16x32_bf16 v[192:195], v[40:43], v[96:99], v[192:195]
    v_add_u32 v3, s26, v1
    v_add_u32 v4, s26, v2
    v_mfma_f32_16x16x32_bf16 v[196:199], v[44:47], v[96:99], v[196:199]
    s_waitcnt vmcnt(12) lgkmcnt(0)
    s_barrier
    v_mfma_f32_16x16x32_bf16 v[200:203], v[32:35], v[100:103], v[200:203]
    v_mfma_f32_16x16x32_bf16 v[204:207], v[36:39], v[100:103], v[204:207]
    v_mfma_f32_16x16x32_bf16 v[208:211], v[40:43], v[100:103], v[208:211]
    v_mfma_f32_16x16x32_bf16 v[212:215], v[44:47], v[100:103], v[212:215]
    s_sub_u32 s32, s32, 1
    s_cmp_lg_u32 s32, 0
    s_cbranch_scc1 g1_z2_loop
    v_mfma_f32_16x16x32_bf16 v[104:107], v[16:19], v[48:51], v[104:107]
    ds_read_b64_tr_b16 v[76:77], v4 offset:24576
    v_mfma_f32_16x16x32_bf16 v[108:111], v[20:23], v[48:51], v[108:111]
    ds_read_b64_tr_b16 v[78:79], v4 offset:28672
    v_mfma_f32_16x16x32_bf16 v[112:115], v[24:27], v[48:51], v[112:115]
    ds_read_b128 v[32:35], v3 offset:0
    s_add_u32 m0, s27, s30
    v_mfma_f32_16x16x32_bf16 v[116:119], v[28:31], v[48:51], v[116:119]
    ds_read_b128 v[36:39], v3 offset:1024
    buffer_load_dwordx4 v5, s[36:39], s28 offen offset:0 sc1 lds
    v_mfma_f32_16x16x32_bf16 v[120:123], v[16:19], v[52:55], v[120:123]
    ds_read_b128 v[40:43], v3 offset:2048
    v_mfma_f32_16x16x32_bf16 v[124:127], v[20:23], v[52:55], v[124:127]
    ds_read_b128 v[44:47], v3 offset:3072
    v_mfma_f32_16x16x32_bf16 v[128:131], v[24:27], v[52:55], v[128:131]
    ds_read_b64_tr_b16 v[80:81], v4 offset:24608
    v_mfma_f32_16x16x32_bf16 v[132:135], v[28:31], v[52:55], v[132:135]
    ds_read_b64_tr_b16 v[82:83], v4 offset:28704
    v_mfma_f32_16x16x32_bf16 v[136:139], v[16:19], v[56:59], v[136:139]
    ds_read_b64_tr_b16 v[84:85], v4 offset:24640
    v_mfma_f32_16x16x32_bf16 v[140:143], v[20:23], v[56:59], v[140:143]
    ds_read_b64_tr_b16 v[86:87], v4 offset:28736
    buffer_load_dwordx4 v5, s[36:39], s28 offen offset:1024 sc1 lds
    v_mfma_f32_16x16x32_bf16 v[144:147], v[24:27], v[56:59], v[144:147]
    ds_read_b64_tr_b16 v[88:89], v4 offset:24672
    s_add_u32 s28, s28, 16384
    v_mfma_f32_16x16x32_bf16 v[148:151], v[28:31], v[56:59], v[148:151]
    ds_read_b64_tr_b16 v[90:91], v4 offset:28768
    v_mfma_f32_16x16x32_bf16 v[152:155], v[16:19], v[60:63], v[152:155]
    ds_read_b64_tr_b16 v[92:93], v4 offset:24704
    v_mfma_f32_16x16x32_bf16 v[156:159], v[20:23], v[60:63], v[156:159]
    ds_read_b64_tr_b16 v[94:95], v4 offset:28800
    s_add_u32 m0, s27, s31
    v_mfma_f32_16x16x32_bf16 v[160:163], v[24:27], v[60:63], v[160:163]
    ds_read_b64_tr_b16 v[96:97], v4 offset:24736
    buffer_load_dwordx4 v6, s[40:43], s29 offen lds
    v_mfma_f32_16x16x32_bf16 v[164:167], v[28:31], v[60:63], v[164:167]
    ds_read_b64_tr_b16 v[98:99], v4 offset:28832
    v_mfma_f32_16x16x32_bf16 v[168:171], v[16:19], v[64:67], v[168:171]
    ds_read_b64_tr_b16 v[100:101], v4 offset:24768
    v_mfma_f32_16x16x32_bf16 v[172:175], v[20:23], v[64:67], v[172:175]
    ds_read_b64_tr_b16 v[102:103], v4 offset:28864
    v_mfma_f32_16x16x32_bf16 v[176:179], v[24:27], v[64:67], v[176:179]
    v_mfma_f32_16x16x32_bf16 v[180:183], v[28:31], v[64:67], v[180:183]
    buffer_load_dwordx4 v7, s[40:43], s29 offen offset:1024 lds
    v_mfma_f32_16x16x32_bf16 v[184:187], v[16:19], v[68:71], v[184:187]
    s_add_u32 s29, s29, 229376
    s_mov_b32 s27, s26
    s_add_u32 s26, s26, 32768
    v_mfma_f32_16x16x32_bf16 v[188:191], v[20:23], v[68:71], v[188:191]
    s_cmp_eq_u32 s26, 163840
    s_cselect_b32 s26, 0, s26
    v_mfma_f32_16x16x32_bf16 v[192:195], v[24:27], v[68:71], v[192:195]
    v_add_u32 v3, s26, v1
    v_add_u32 v4, s26, v2
    v_mfma_f32_16x16x32_bf16 v[196:199], v[28:31], v[68:71], v[196:199]
    s_waitcnt vmcnt(12) lgkmcnt(0)
    s_barrier
    v_mfma_f32_16x16x32_bf16 v[200:203], v[16:19], v[72:75], v[200:203]
    v_mfma_f32_16x16x32_bf16 v[204:207], v[20:23], v[72:75], v[204:207]
    v_mfma_f32_16x16x32_bf16 v[208:211], v[24:27], v[72:75], v[208:211]
    v_mfma_f32_16x16x32_bf16 v[212:215], v[28:31], v[72:75], v[212:215]
    v_mfma_f32_16x16x32_bf16 v[104:107], v[32:35], v[76:79], v[104:107]
    ds_read_b64_tr_b16 v[48:49], v4 offset:24576
    v_mfma_f32_16x16x32_bf16 v[108:111], v[36:39], v[76:79], v[108:111]
    ds_read_b64_tr_b16 v[50:51], v4 offset:28672
    v_mfma_f32_16x16x32_bf16 v[112:115], v[40:43], v[76:79], v[112:115]
    ds_read_b128 v[16:19], v3 offset:0
    v_mfma_f32_16x16x32_bf16 v[116:119], v[44:47], v[76:79], v[116:119]
    ds_read_b128 v[20:23], v3 offset:1024
    v_mfma_f32_16x16x32_bf16 v[120:123], v[32:35], v[80:83], v[120:123]
    ds_read_b128 v[24:27], v3 offset:2048
    v_mfma_f32_16x16x32_bf16 v[124:127], v[36:39], v[80:83], v[124:127]
    ds_read_b128 v[28:31], v3 offset:3072
    v_mfma_f32_16x16x32_bf16 v[128:131], v[40:43], v[80:83], v[128:131]
    ds_read_b64_tr_b16 v[52:53], v4 offset:24608
    v_mfma_f32_16x16x32_bf16 v[132:135], v[44:47], v[80:83], v[132:135]
    ds_read_b64_tr_b16 v[54:55], v4 offset:28704
    v_mfma_f32_16x16x32_bf16 v[136:139], v[32:35], v[84:87], v[136:139]
    ds_read_b64_tr_b16 v[56:57], v4 offset:24640
    v_mfma_f32_16x16x32_bf16 v[140:143], v[36:39], v[84:87], v[140:143]
    ds_read_b64_tr_b16 v[58:59], v4 offset:28736
    v_mfma_f32_16x16x32_bf16 v[144:147], v[40:43], v[84:87], v[144:147]
    ds_read_b64_tr_b16 v[60:61], v4 offset:24672
    v_mfma_f32_16x16x32_bf16 v[148:151], v[44:47], v[84:87], v[148:151]
    ds_read_b64_tr_b16 v[62:63], v4 offset:28768
    v_mfma_f32_16x16x32_bf16 v[152:155], v[32:35], v[88:91], v[152:155]
    ds_read_b64_tr_b16 v[64:65], v4 offset:24704
    v_mfma_f32_16x16x32_bf16 v[156:159], v[36:39], v[88:91], v[156:159]
    ds_read_b64_tr_b16 v[66:67], v4 offset:28800
    v_mfma_f32_16x16x32_bf16 v[160:163], v[40:43], v[88:91], v[160:163]
    ds_read_b64_tr_b16 v[68:69], v4 offset:24736
    v_mfma_f32_16x16x32_bf16 v[164:167], v[44:47], v[88:91], v[164:167]
    ds_read_b64_tr_b16 v[70:71], v4 offset:28832
    v_mfma_f32_16x16x32_bf16 v[168:171], v[32:35], v[92:95], v[168:171]
    ds_read_b64_tr_b16 v[72:73], v4 offset:24768
    v_mfma_f32_16x16x32_bf16 v[172:175], v[36:39], v[92:95], v[172:175]
    ds_read_b64_tr_b16 v[74:75], v4 offset:28864
    v_mfma_f32_16x16x32_bf16 v[176:179], v[40:43], v[92:95], v[176:179]
    v_mfma_f32_16x16x32_bf16 v[180:183], v[44:47], v[92:95], v[180:183]
    v_mfma_f32_16x16x32_bf16 v[184:187], v[32:35], v[96:99], v[184:187]
    s_mov_b32 s27, s26
    s_add_u32 s26, s26, 32768
    v_mfma_f32_16x16x32_bf16 v[188:191], v[36:39], v[96:99], v[188:191]
    s_cmp_eq_u32 s26, 163840
    s_cselect_b32 s26, 0, s26
    v_mfma_f32_16x16x32_bf16 v[192:195], v[40:43], v[96:99], v[192:195]
    v_add_u32 v3, s26, v1
    v_add_u32 v4, s26, v2
    v_mfma_f32_16x16x32_bf16 v[196:199], v[44:47], v[96:99], v[196:199]
    s_waitcnt vmcnt(8) lgkmcnt(0)
    s_barrier
    v_mfma_f32_16x16x32_bf16 v[200:203], v[32:35], v[100:103], v[200:203]
    v_mfma_f32_16x16x32_bf16 v[204:207], v[36:39], v[100:103], v[204:207]
    v_mfma_f32_16x16x32_bf16 v[208:211], v[40:43], v[100:103], v[208:211]
    v_mfma_f32_16x16x32_bf16 v[212:215], v[44:47], v[100:103], v[212:215]
    v_mfma_f32_16x16x32_bf16 v[104:107], v[16:19], v[48:51], v[104:107]
    ds_read_b64_tr_b16 v[76:77], v4 offset:24576
    v_mfma_f32_16x16x32_bf16 v[108:111], v[20:23], v[48:51], v[108:111]
    ds_read_b64_tr_b16 v[78:79], v4 offset:28672
    v_mfma_f32_16x16x32_bf16 v[112:115], v[24:27], v[48:51], v[112:115]
    ds_read_b128 v[32:35], v3 offset:0
    v_mfma_f32_16x16x32_bf16 v[116:119], v[28:31], v[48:51], v[116:119]
    ds_read_b128 v[36:39], v3 offset:1024
    v_mfma_f32_16x16x32_bf16 v[120:123], v[16:19], v[52:55], v[120:123]
    ds_read_b128 v[40:43], v3 offset:2048
    v_mfma_f32_16x16x32_bf16 v[124:127], v[20:23], v[52:55], v[124:127]
    ds_read_b128 v[44:47], v3 offset:3072
    v_mfma_f32_16x16x32_bf16 v[128:131], v[24:27], v[52:55], v[128:131]
    ds_read_b64_tr_b16 v[80:81], v4 offset:24608
    v_mfma_f32_16x16x32_bf16 v[132:135], v[28:31], v[52:55], v[132:135]
    ds_read_b64_tr_b16 v[82:83], v4 offset:28704
    v_mfma_f32_16x16x32_bf16 v[136:139], v[16:19], v[56:59], v[136:139]
    ds_read_b64_tr_b16 v[84:85], v4 offset:24640
    v_mfma_f32_16x16x32_bf16 v[140:143], v[20:23], v[56:59], v[140:143]
    ds_read_b64_tr_b16 v[86:87], v4 offset:28736
    v_mfma_f32_16x16x32_bf16 v[144:147], v[24:27], v[56:59], v[144:147]
    ds_read_b64_tr_b16 v[88:89], v4 offset:24672
    v_mfma_f32_16x16x32_bf16 v[148:151], v[28:31], v[56:59], v[148:151]
    ds_read_b64_tr_b16 v[90:91], v4 offset:28768
    v_mfma_f32_16x16x32_bf16 v[152:155], v[16:19], v[60:63], v[152:155]
    ds_read_b64_tr_b16 v[92:93], v4 offset:24704
    v_mfma_f32_16x16x32_bf16 v[156:159], v[20:23], v[60:63], v[156:159]
    ds_read_b64_tr_b16 v[94:95], v4 offset:28800
    v_mfma_f32_16x16x32_bf16 v[160:163], v[24:27], v[60:63], v[160:163]
    ds_read_b64_tr_b16 v[96:97], v4 offset:24736
    v_mfma_f32_16x16x32_bf16 v[164:167], v[28:31], v[60:63], v[164:167]
    ds_read_b64_tr_b16 v[98:99], v4 offset:28832
    v_mfma_f32_16x16x32_bf16 v[168:171], v[16:19], v[64:67], v[168:171]
    ds_read_b64_tr_b16 v[100:101], v4 offset:24768
    v_mfma_f32_16x16x32_bf16 v[172:175], v[20:23], v[64:67], v[172:175]
    ds_read_b64_tr_b16 v[102:103], v4 offset:28864
    v_mfma_f32_16x16x32_bf16 v[176:179], v[24:27], v[64:67], v[176:179]
    v_mfma_f32_16x16x32_bf16 v[180:183], v[28:31], v[64:67], v[180:183]
    v_mfma_f32_16x16x32_bf16 v[184:187], v[16:19], v[68:71], v[184:187]
    s_mov_b32 s27, s26
    s_add_u32 s26, s26, 32768
    v_mfma_f32_16x16x32_bf16 v[188:191], v[20:23], v[68:71], v[188:191]
    s_cmp_eq_u32 s26, 163840
    s_cselect_b32 s26, 0, s26
    v_mfma_f32_16x16x32_bf16 v[192:195], v[24:27], v[68:71], v[192:195]
    v_add_u32 v3, s26, v1
    v_add_u32 v4, s26, v2
    v_mfma_f32_16x16x32_bf16 v[196:199], v[28:31], v[68:71], v[196:199]
    s_waitcnt vmcnt(4) lgkmcnt(0)
    s_barrier
    v_mfma_f32_16x16x32_bf16 v[200:203], v[16:19], v[72:75], v[200:203]
    v_mfma_f32_16x16x32_bf16 v[204:207], v[20:23], v[72:75], v[204:207]
    v_mfma_f32_16x16x32_bf16 v[208:211], v[24:27], v[72:75], v[208:211]
    v_mfma_f32_16x16x32_bf16 v[212:215], v[28:31], v[72:75], v[212:215]
    v_mfma_f32_16x16x32_bf16 v[104:107], v[32:35], v[76:79], v[104:107]
    ds_read_b64_tr_b16 v[48:49], v4 offset:24576
    v_mfma_f32_16x16x32_bf16 v[108:111], v[36:39], v[76:79], v[108:111]
    ds_read_b64_tr_b16 v[50:51], v4 offset:28672
    v_mfma_f32_16x16x32_bf16 v[112:115], v[40:43], v[76:79], v[112:115]
    ds_read_b128 v[16:19], v3 offset:0
    v_mfma_f32_16x16x32_bf16 v[116:119], v[44:47], v[76:79], v[116:119]
    ds_read_b128 v[20:23], v3 offset:1024
    v_mfma_f32_16x16x32_bf16 v[120:123], v[32:35], v[80:83], v[120:123]
    ds_read_b128 v[24:27], v3 offset:2048
    v_mfma_f32_16x16x32_bf16 v[124:127], v[36:39], v[80:83], v[124:127]
    ds_read_b128 v[28:31], v3 offset:3072
    v_mfma_f32_16x16x32_bf16 v[128:131], v[40:43], v[80:83], v[128:131]
    ds_read_b64_tr_b16 v[52:53], v4 offset:24608
    v_mfma_f32_16x16x32_bf16 v[132:135], v[44:47], v[80:83], v[132:135]
    ds_read_b64_tr_b16 v[54:55], v4 offset:28704
    v_mfma_f32_16x16x32_bf16 v[136:139], v[32:35], v[84:87], v[136:139]
    ds_read_b64_tr_b16 v[56:57], v4 offset:24640
    v_mfma_f32_16x16x32_bf16 v[140:143], v[36:39], v[84:87], v[140:143]
    ds_read_b64_tr_b16 v[58:59], v4 offset:28736
    v_mfma_f32_16x16x32_bf16 v[144:147], v[40:43], v[84:87], v[144:147]
    ds_read_b64_tr_b16 v[60:61], v4 offset:24672
    v_mfma_f32_16x16x32_bf16 v[148:151], v[44:47], v[84:87], v[148:151]
    ds_read_b64_tr_b16 v[62:63], v4 offset:28768
    v_mfma_f32_16x16x32_bf16 v[152:155], v[32:35], v[88:91], v[152:155]
    ds_read_b64_tr_b16 v[64:65], v4 offset:24704
    v_mfma_f32_16x16x32_bf16 v[156:159], v[36:39], v[88:91], v[156:159]
    ds_read_b64_tr_b16 v[66:67], v4 offset:28800
    v_mfma_f32_16x16x32_bf16 v[160:163], v[40:43], v[88:91], v[160:163]
    ds_read_b64_tr_b16 v[68:69], v4 offset:24736
    v_mfma_f32_16x16x32_bf16 v[164:167], v[44:47], v[88:91], v[164:167]
    ds_read_b64_tr_b16 v[70:71], v4 offset:28832
    v_mfma_f32_16x16x32_bf16 v[168:171], v[32:35], v[92:95], v[168:171]
    ds_read_b64_tr_b16 v[72:73], v4 offset:24768
    v_mfma_f32_16x16x32_bf16 v[172:175], v[36:39], v[92:95], v[172:175]
    ds_read_b64_tr_b16 v[74:75], v4 offset:28864
    v_mfma_f32_16x16x32_bf16 v[176:179], v[40:43], v[92:95], v[176:179]
    v_mfma_f32_16x16x32_bf16 v[180:183], v[44:47], v[92:95], v[180:183]
    v_mfma_f32_16x16x32_bf16 v[184:187], v[32:35], v[96:99], v[184:187]
    s_mov_b32 s27, s26
    s_add_u32 s26, s26, 32768
    v_mfma_f32_16x16x32_bf16 v[188:191], v[36:39], v[96:99], v[188:191]
    s_cmp_eq_u32 s26, 163840
    s_cselect_b32 s26, 0, s26
    v_mfma_f32_16x16x32_bf16 v[192:195], v[40:43], v[96:99], v[192:195]
    v_add_u32 v3, s26, v1
    v_add_u32 v4, s26, v2
    v_mfma_f32_16x16x32_bf16 v[196:199], v[44:47], v[96:99], v[196:199]
    s_waitcnt vmcnt(0) lgkmcnt(0)
    s_barrier
    v_mfma_f32_16x16x32_bf16 v[200:203], v[32:35], v[100:103], v[200:203]
    v_mfma_f32_16x16x32_bf16 v[204:207], v[36:39], v[100:103], v[204:207]
    v_mfma_f32_16x16x32_bf16 v[208:211], v[40:43], v[100:103], v[208:211]
    v_mfma_f32_16x16x32_bf16 v[212:215], v[44:47], v[100:103], v[212:215]
    v_mfma_f32_16x16x32_bf16 v[104:107], v[16:19], v[48:51], v[104:107]
    ds_read_b64_tr_b16 v[76:77], v4 offset:24576
    v_mfma_f32_16x16x32_bf16 v[108:111], v[20:23], v[48:51], v[108:111]
    ds_read_b64_tr_b16 v[78:79], v4 offset:28672
    v_mfma_f32_16x16x32_bf16 v[112:115], v[24:27], v[48:51], v[112:115]
    ds_read_b128 v[32:35], v3 offset:0
    v_mfma_f32_16x16x32_bf16 v[116:119], v[28:31], v[48:51], v[116:119]
    ds_read_b128 v[36:39], v3 offset:1024
    v_mfma_f32_16x16x32_bf16 v[120:123], v[16:19], v[52:55], v[120:123]
    ds_read_b128 v[40:43], v3 offset:2048
    v_mfma_f32_16x16x32_bf16 v[124:127], v[20:23], v[52:55], v[124:127]
    ds_read_b128 v[44:47], v3 offset:3072
    v_mfma_f32_16x16x32_bf16 v[128:131], v[24:27], v[52:55], v[128:131]
    ds_read_b64_tr_b16 v[80:81], v4 offset:24608
    v_mfma_f32_16x16x32_bf16 v[132:135], v[28:31], v[52:55], v[132:135]
    ds_read_b64_tr_b16 v[82:83], v4 offset:28704
    v_mfma_f32_16x16x32_bf16 v[136:139], v[16:19], v[56:59], v[136:139]
    ds_read_b64_tr_b16 v[84:85], v4 offset:24640
    v_mfma_f32_16x16x32_bf16 v[140:143], v[20:23], v[56:59], v[140:143]
    ds_read_b64_tr_b16 v[86:87], v4 offset:28736
    v_mfma_f32_16x16x32_bf16 v[144:147], v[24:27], v[56:59], v[144:147]
    ds_read_b64_tr_b16 v[88:89], v4 offset:24672
    v_mfma_f32_16x16x32_bf16 v[148:151], v[28:31], v[56:59], v[148:151]
    ds_read_b64_tr_b16 v[90:91], v4 offset:28768
    v_mfma_f32_16x16x32_bf16 v[152:155], v[16:19], v[60:63], v[152:155]
    ds_read_b64_tr_b16 v[92:93], v4 offset:24704
    v_mfma_f32_16x16x32_bf16 v[156:159], v[20:23], v[60:63], v[156:159]
    ds_read_b64_tr_b16 v[94:95], v4 offset:28800
    v_mfma_f32_16x16x32_bf16 v[160:163], v[24:27], v[60:63], v[160:163]
    ds_read_b64_tr_b16 v[96:97], v4 offset:24736
    v_mfma_f32_16x16x32_bf16 v[164:167], v[28:31], v[60:63], v[164:167]
    ds_read_b64_tr_b16 v[98:99], v4 offset:28832
    v_mfma_f32_16x16x32_bf16 v[168:171], v[16:19], v[64:67], v[168:171]
    ds_read_b64_tr_b16 v[100:101], v4 offset:24768
    v_mfma_f32_16x16x32_bf16 v[172:175], v[20:23], v[64:67], v[172:175]
    ds_read_b64_tr_b16 v[102:103], v4 offset:28864
    v_mfma_f32_16x16x32_bf16 v[176:179], v[24:27], v[64:67], v[176:179]
    v_mfma_f32_16x16x32_bf16 v[180:183], v[28:31], v[64:67], v[180:183]
    v_mfma_f32_16x16x32_bf16 v[184:187], v[16:19], v[68:71], v[184:187]
    s_mov_b32 s27, s26
    s_add_u32 s26, s26, 32768
    v_mfma_f32_16x16x32_bf16 v[188:191], v[20:23], v[68:71], v[188:191]
    s_cmp_eq_u32 s26, 163840
    s_cselect_b32 s26, 0, s26
    v_mfma_f32_16x16x32_bf16 v[192:195], v[24:27], v[68:71], v[192:195]
    v_add_u32 v3, s26, v1
    v_add_u32 v4, s26, v2
    v_mfma_f32_16x16x32_bf16 v[196:199], v[28:31], v[68:71], v[196:199]
    v_lshlrev_b32 v10, 2, v9
    v_add_u32 v10, 157696, v10
    v_mov_b32 v11, 0
    ds_write_b32 v10, v11
    ds_write_b32 v10, v11 offset:256
    ds_write_b32 v10, v11 offset:512
    s_waitcnt lgkmcnt(0)
    s_barrier
    v_mfma_f32_16x16x32_bf16 v[200:203], v[16:19], v[72:75], v[200:203]
    v_mfma_f32_16x16x32_bf16 v[204:207], v[20:23], v[72:75], v[204:207]
    v_mfma_f32_16x16x32_bf16 v[208:211], v[24:27], v[72:75], v[208:211]
    v_mfma_f32_16x16x32_bf16 v[212:215], v[28:31], v[72:75], v[212:215]
    v_mfma_f32_16x16x32_bf16 v[104:107], v[32:35], v[76:79], v[104:107]
    v_mfma_f32_16x16x32_bf16 v[108:111], v[36:39], v[76:79], v[108:111]
    v_mfma_f32_16x16x32_bf16 v[112:115], v[40:43], v[76:79], v[112:115]
    v_mfma_f32_16x16x32_bf16 v[116:119], v[44:47], v[76:79], v[116:119]
    v_mfma_f32_16x16x32_bf16 v[120:123], v[32:35], v[80:83], v[120:123]
    v_mfma_f32_16x16x32_bf16 v[124:127], v[36:39], v[80:83], v[124:127]
    v_mfma_f32_16x16x32_bf16 v[128:131], v[40:43], v[80:83], v[128:131]
    v_mfma_f32_16x16x32_bf16 v[132:135], v[44:47], v[80:83], v[132:135]
    v_mfma_f32_16x16x32_bf16 v[136:139], v[32:35], v[84:87], v[136:139]
    v_mfma_f32_16x16x32_bf16 v[140:143], v[36:39], v[84:87], v[140:143]
    v_mfma_f32_16x16x32_bf16 v[144:147], v[40:43], v[84:87], v[144:147]
    v_mfma_f32_16x16x32_bf16 v[148:151], v[44:47], v[84:87], v[148:151]
    v_mfma_f32_16x16x32_bf16 v[152:155], v[32:35], v[88:91], v[152:155]
    v_mfma_f32_16x16x32_bf16 v[156:159], v[36:39], v[88:91], v[156:159]
    v_mfma_f32_16x16x32_bf16 v[160:163], v[40:43], v[88:91], v[160:163]
    v_mfma_f32_16x16x32_bf16 v[164:167], v[44:47], v[88:91], v[164:167]
    v_mfma_f32_16x16x32_bf16 v[168:171], v[32:35], v[92:95], v[168:171]
    v_mfma_f32_16x16x32_bf16 v[172:175], v[36:39], v[92:95], v[172:175]
    v_mfma_f32_16x16x32_bf16 v[176:179], v[40:43], v[92:95], v[176:179]
    v_mfma_f32_16x16x32_bf16 v[180:183], v[44:47], v[92:95], v[180:183]
    v_mfma_f32_16x16x32_bf16 v[184:187], v[32:35], v[96:99], v[184:187]
    v_mfma_f32_16x16x32_bf16 v[188:191], v[36:39], v[96:99], v[188:191]
    v_mfma_f32_16x16x32_bf16 v[192:195], v[40:43], v[96:99], v[192:195]
    v_mfma_f32_16x16x32_bf16 v[196:199], v[44:47], v[96:99], v[196:199]
    v_mfma_f32_16x16x32_bf16 v[200:203], v[32:35], v[100:103], v[200:203]
    v_mfma_f32_16x16x32_bf16 v[204:207], v[36:39], v[100:103], v[204:207]
    v_mfma_f32_16x16x32_bf16 v[208:211], v[40:43], v[100:103], v[208:211]
    v_mfma_f32_16x16x32_bf16 v[212:215], v[44:47], v[100:103], v[212:215]
    s_nop 7
    s_setprio 1
    s_mov_b32 s11, 16
    v_mov_b32 v216, 0xbdd2d3e8
    v_mov_b32 v217, 0xbdd2d3e8
    v_mov_b32 v218, 0xc0135761
    v_mov_b32 v219, 0xc0135761
    v_mov_b32 v220, 1.0
    v_mov_b32 v221, 1.0
    v_pk_mul_f32 v[222:223], v[104:105], v[104:105]
    v_pk_mul_f32 v[224:225], v[106:107], v[106:107]
    v_pk_mul_f32 v[226:227], v[108:109], v[108:109]
    v_pk_mul_f32 v[228:229], v[110:111], v[110:111]
    v_pk_fma_f32 v[222:223], v[222:223], v[216:217], v[218:219]
    v_pk_fma_f32 v[224:225], v[224:225], v[216:217], v[218:219]
    v_pk_fma_f32 v[226:227], v[226:227], v[216:217], v[218:219]
    v_pk_fma_f32 v[228:229], v[228:229], v[216:217], v[218:219]
    v_pk_mul_f32 v[222:223], v[222:223], v[104:105]
    v_pk_mul_f32 v[224:225], v[224:225], v[106:107]
    v_pk_mul_f32 v[226:227], v[226:227], v[108:109]
    v_pk_mul_f32 v[228:229], v[228:229], v[110:111]
    v_exp_f32 v222, v222
    v_exp_f32 v223, v223
    v_exp_f32 v224, v224
    v_exp_f32 v225, v225
    v_exp_f32 v226, v226
    v_exp_f32 v227, v227
    v_exp_f32 v228, v228
    v_exp_f32 v229, v229
    v_pk_add_f32 v[222:223], v[222:223], v[220:221]
    v_pk_add_f32 v[224:225], v[224:225], v[220:221]
    v_pk_add_f32 v[226:227], v[226:227], v[220:221]
    v_pk_add_f32 v[228:229], v[228:229], v[220:221]
    v_rcp_f32 v222, v222
    v_rcp_f32 v223, v223
    v_rcp_f32 v224, v224
    v_rcp_f32 v225, v225
    v_rcp_f32 v226, v226
    v_rcp_f32 v227, v227
    v_rcp_f32 v228, v228
    v_rcp_f32 v229, v229
    v_pk_mul_f32 v[104:105], v[104:105], v[222:223]
    v_pk_mul_f32 v[106:107], v[106:107], v[224:225]
    v_pk_mul_f32 v[108:109], v[108:109], v[226:227]
    v_pk_mul_f32 v[110:111], v[110:111], v[228:229]
    v_pk_mul_f32 v[222:223], v[112:113], v[112:113]
    v_pk_mul_f32 v[224:225], v[114:115], v[114:115]
    v_pk_mul_f32 v[226:227], v[116:117], v[116:117]
    v_pk_mul_f32 v[228:229], v[118:119], v[118:119]
    v_pk_fma_f32 v[222:223], v[222:223], v[216:217], v[218:219]
    v_pk_fma_f32 v[224:225], v[224:225], v[216:217], v[218:219]
    v_pk_fma_f32 v[226:227], v[226:227], v[216:217], v[218:219]
    v_pk_fma_f32 v[228:229], v[228:229], v[216:217], v[218:219]
    v_pk_mul_f32 v[222:223], v[222:223], v[112:113]
    v_pk_mul_f32 v[224:225], v[224:225], v[114:115]
    v_pk_mul_f32 v[226:227], v[226:227], v[116:117]
    v_pk_mul_f32 v[228:229], v[228:229], v[118:119]
    v_exp_f32 v222, v222
    v_exp_f32 v223, v223
    v_exp_f32 v224, v224
    v_exp_f32 v225, v225
    v_exp_f32 v226, v226
    v_exp_f32 v227, v227
    v_exp_f32 v228, v228
    v_exp_f32 v229, v229
    v_pk_add_f32 v[222:223], v[222:223], v[220:221]
    v_pk_add_f32 v[224:225], v[224:225], v[220:221]
    v_pk_add_f32 v[226:227], v[226:227], v[220:221]
    v_pk_add_f32 v[228:229], v[228:229], v[220:221]
    v_rcp_f32 v222, v222
    v_rcp_f32 v223, v223
    v_rcp_f32 v224, v224
    v_rcp_f32 v225, v225
    v_rcp_f32 v226, v226
    v_rcp_f32 v227, v227
    v_rcp_f32 v228, v228
    v_rcp_f32 v229, v229
    v_pk_mul_f32 v[112:113], v[112:113], v[222:223]
    v_pk_mul_f32 v[114:115], v[114:115], v[224:225]
    v_pk_mul_f32 v[116:117], v[116:117], v[226:227]
    v_pk_mul_f32 v[118:119], v[118:119], v[228:229]
    v_pk_mul_f32 v[222:223], v[120:121], v[120:121]
    v_pk_mul_f32 v[224:225], v[122:123], v[122:123]
    v_pk_mul_f32 v[226:227], v[124:125], v[124:125]
    v_pk_mul_f32 v[228:229], v[126:127], v[126:127]
    v_pk_fma_f32 v[222:223], v[222:223], v[216:217], v[218:219]
    v_pk_fma_f32 v[224:225], v[224:225], v[216:217], v[218:219]
    v_pk_fma_f32 v[226:227], v[226:227], v[216:217], v[218:219]
    v_pk_fma_f32 v[228:229], v[228:229], v[216:217], v[218:219]
    v_pk_mul_f32 v[222:223], v[222:223], v[120:121]
    v_pk_mul_f32 v[224:225], v[224:225], v[122:123]
    v_pk_mul_f32 v[226:227], v[226:227], v[124:125]
    v_pk_mul_f32 v[228:229], v[228:229], v[126:127]
    v_exp_f32 v222, v222
    v_exp_f32 v223, v223
    v_exp_f32 v224, v224
    v_exp_f32 v225, v225
    v_exp_f32 v226, v226
    v_exp_f32 v227, v227
    v_exp_f32 v228, v228
    v_exp_f32 v229, v229
    v_pk_add_f32 v[222:223], v[222:223], v[220:221]
    v_pk_add_f32 v[224:225], v[224:225], v[220:221]
    v_pk_add_f32 v[226:227], v[226:227], v[220:221]
    v_pk_add_f32 v[228:229], v[228:229], v[220:221]
    v_rcp_f32 v222, v222
    v_rcp_f32 v223, v223
    v_rcp_f32 v224, v224
    v_rcp_f32 v225, v225
    v_rcp_f32 v226, v226
    v_rcp_f32 v227, v227
    v_rcp_f32 v228, v228
    v_rcp_f32 v229, v229
    v_pk_mul_f32 v[120:121], v[120:121], v[222:223]
    v_pk_mul_f32 v[122:123], v[122:123], v[224:225]
    v_pk_mul_f32 v[124:125], v[124:125], v[226:227]
    v_pk_mul_f32 v[126:127], v[126:127], v[228:229]
    v_pk_mul_f32 v[222:223], v[128:129], v[128:129]
    v_pk_mul_f32 v[224:225], v[130:131], v[130:131]
    v_pk_mul_f32 v[226:227], v[132:133], v[132:133]
    v_pk_mul_f32 v[228:229], v[134:135], v[134:135]
    v_pk_fma_f32 v[222:223], v[222:223], v[216:217], v[218:219]
    v_pk_fma_f32 v[224:225], v[224:225], v[216:217], v[218:219]
    v_pk_fma_f32 v[226:227], v[226:227], v[216:217], v[218:219]
    v_pk_fma_f32 v[228:229], v[228:229], v[216:217], v[218:219]
    v_pk_mul_f32 v[222:223], v[222:223], v[128:129]
    v_pk_mul_f32 v[224:225], v[224:225], v[130:131]
    v_pk_mul_f32 v[226:227], v[226:227], v[132:133]
    v_pk_mul_f32 v[228:229], v[228:229], v[134:135]
    v_exp_f32 v222, v222
    v_exp_f32 v223, v223
    v_exp_f32 v224, v224
    v_exp_f32 v225, v225
    v_exp_f32 v226, v226
    v_exp_f32 v227, v227
    v_exp_f32 v228, v228
    v_exp_f32 v229, v229
    v_pk_add_f32 v[222:223], v[222:223], v[220:221]
    v_pk_add_f32 v[224:225], v[224:225], v[220:221]
    v_pk_add_f32 v[226:227], v[226:227], v[220:221]
    v_pk_add_f32 v[228:229], v[228:229], v[220:221]
    v_rcp_f32 v222, v222
    v_rcp_f32 v223, v223
    v_rcp_f32 v224, v224
    v_rcp_f32 v225, v225
    v_rcp_f32 v226, v226
    v_rcp_f32 v227, v227
    v_rcp_f32 v228, v228
    v_rcp_f32 v229, v229
    v_pk_mul_f32 v[128:129], v[128:129], v[222:223]
    v_pk_mul_f32 v[130:131], v[130:131], v[224:225]
    v_pk_mul_f32 v[132:133], v[132:133], v[226:227]
    v_pk_mul_f32 v[134:135], v[134:135], v[228:229]
    v_pk_mul_f32 v[222:223], v[136:137], v[136:137]
    v_pk_mul_f32 v[224:225], v[138:139], v[138:139]
    v_pk_mul_f32 v[226:227], v[140:141], v[140:141]
    v_pk_mul_f32 v[228:229], v[142:143], v[142:143]
    v_pk_fma_f32 v[222:223], v[222:223], v[216:217], v[218:219]
    v_pk_fma_f32 v[224:225], v[224:225], v[216:217], v[218:219]
    v_pk_fma_f32 v[226:227], v[226:227], v[216:217], v[218:219]
    v_pk_fma_f32 v[228:229], v[228:229], v[216:217], v[218:219]
    v_pk_mul_f32 v[222:223], v[222:223], v[136:137]
    v_pk_mul_f32 v[224:225], v[224:225], v[138:139]
    v_pk_mul_f32 v[226:227], v[226:227], v[140:141]
    v_pk_mul_f32 v[228:229], v[228:229], v[142:143]
    v_exp_f32 v222, v222
    v_exp_f32 v223, v223
    v_exp_f32 v224, v224
    v_exp_f32 v225, v225
    v_exp_f32 v226, v226
    v_exp_f32 v227, v227
    v_exp_f32 v228, v228
    v_exp_f32 v229, v229
    v_pk_add_f32 v[222:223], v[222:223], v[220:221]
    v_pk_add_f32 v[224:225], v[224:225], v[220:221]
    v_pk_add_f32 v[226:227], v[226:227], v[220:221]
    v_pk_add_f32 v[228:229], v[228:229], v[220:221]
    v_rcp_f32 v222, v222
    v_rcp_f32 v223, v223
    v_rcp_f32 v224, v224
    v_rcp_f32 v225, v225
    v_rcp_f32 v226, v226
    v_rcp_f32 v227, v227
    v_rcp_f32 v228, v228
    v_rcp_f32 v229, v229
    v_pk_mul_f32 v[136:137], v[136:137], v[222:223]
    v_pk_mul_f32 v[138:139], v[138:139], v[224:225]
    v_pk_mul_f32 v[140:141], v[140:141], v[226:227]
    v_pk_mul_f32 v[142:143], v[142:143], v[228:229]
    v_pk_mul_f32 v[222:223], v[144:145], v[144:145]
    v_pk_mul_f32 v[224:225], v[146:147], v[146:147]
    v_pk_mul_f32 v[226:227], v[148:149], v[148:149]
    v_pk_mul_f32 v[228:229], v[150:151], v[150:151]
    v_pk_fma_f32 v[222:223], v[222:223], v[216:217], v[218:219]
    v_pk_fma_f32 v[224:225], v[224:225], v[216:217], v[218:219]
    v_pk_fma_f32 v[226:227], v[226:227], v[216:217], v[218:219]
    v_pk_fma_f32 v[228:229], v[228:229], v[216:217], v[218:219]
    v_pk_mul_f32 v[222:223], v[222:223], v[144:145]
    v_pk_mul_f32 v[224:225], v[224:225], v[146:147]
    v_pk_mul_f32 v[226:227], v[226:227], v[148:149]
    v_pk_mul_f32 v[228:229], v[228:229], v[150:151]
    v_exp_f32 v222, v222
    v_exp_f32 v223, v223
    v_exp_f32 v224, v224
    v_exp_f32 v225, v225
    v_exp_f32 v226, v226
    v_exp_f32 v227, v227
    v_exp_f32 v228, v228
    v_exp_f32 v229, v229
    v_pk_add_f32 v[222:223], v[222:223], v[220:221]
    v_pk_add_f32 v[224:225], v[224:225], v[220:221]
    v_pk_add_f32 v[226:227], v[226:227], v[220:221]
    v_pk_add_f32 v[228:229], v[228:229], v[220:221]
    v_rcp_f32 v222, v222
    v_rcp_f32 v223, v223
    v_rcp_f32 v224, v224
    v_rcp_f32 v225, v225
    v_rcp_f32 v226, v226
    v_rcp_f32 v227, v227
    v_rcp_f32 v228, v228
    v_rcp_f32 v229, v229
    v_pk_mul_f32 v[144:145], v[144:145], v[222:223]
    v_pk_mul_f32 v[146:147], v[146:147], v[224:225]
    v_pk_mul_f32 v[148:149], v[148:149], v[226:227]
    v_pk_mul_f32 v[150:151], v[150:151], v[228:229]
    v_pk_mul_f32 v[222:223], v[152:153], v[152:153]
    v_pk_mul_f32 v[224:225], v[154:155], v[154:155]
    v_pk_mul_f32 v[226:227], v[156:157], v[156:157]
    v_pk_mul_f32 v[228:229], v[158:159], v[158:159]
    v_pk_fma_f32 v[222:223], v[222:223], v[216:217], v[218:219]
    v_pk_fma_f32 v[224:225], v[224:225], v[216:217], v[218:219]
    v_pk_fma_f32 v[226:227], v[226:227], v[216:217], v[218:219]
    v_pk_fma_f32 v[228:229], v[228:229], v[216:217], v[218:219]
    v_pk_mul_f32 v[222:223], v[222:223], v[152:153]
    v_pk_mul_f32 v[224:225], v[224:225], v[154:155]
    v_pk_mul_f32 v[226:227], v[226:227], v[156:157]
    v_pk_mul_f32 v[228:229], v[228:229], v[158:159]
    v_exp_f32 v222, v222
    v_exp_f32 v223, v223
    v_exp_f32 v224, v224
    v_exp_f32 v225, v225
    v_exp_f32 v226, v226
    v_exp_f32 v227, v227
    v_exp_f32 v228, v228
    v_exp_f32 v229, v229
    v_pk_add_f32 v[222:223], v[222:223], v[220:221]
    v_pk_add_f32 v[224:225], v[224:225], v[220:221]
    v_pk_add_f32 v[226:227], v[226:227], v[220:221]
    v_pk_add_f32 v[228:229], v[228:229], v[220:221]
    v_rcp_f32 v222, v222
    v_rcp_f32 v223, v223
    v_rcp_f32 v224, v224
    v_rcp_f32 v225, v225
    v_rcp_f32 v226, v226
    v_rcp_f32 v227, v227
    v_rcp_f32 v228, v228
    v_rcp_f32 v229, v229
    v_pk_mul_f32 v[152:153], v[152:153], v[222:223]
    v_pk_mul_f32 v[154:155], v[154:155], v[224:225]
    v_pk_mul_f32 v[156:157], v[156:157], v[226:227]
    v_pk_mul_f32 v[158:159], v[158:159], v[228:229]
    v_pk_mul_f32 v[222:223], v[160:161], v[160:161]
    v_pk_mul_f32 v[224:225], v[162:163], v[162:163]
    v_pk_mul_f32 v[226:227], v[164:165], v[164:165]
    v_pk_mul_f32 v[228:229], v[166:167], v[166:167]
    v_pk_fma_f32 v[222:223], v[222:223], v[216:217], v[218:219]
    v_pk_fma_f32 v[224:225], v[224:225], v[216:217], v[218:219]
    v_pk_fma_f32 v[226:227], v[226:227], v[216:217], v[218:219]
    v_pk_fma_f32 v[228:229], v[228:229], v[216:217], v[218:219]
    v_pk_mul_f32 v[222:223], v[222:223], v[160:161]
    v_pk_mul_f32 v[224:225], v[224:225], v[162:163]
    v_pk_mul_f32 v[226:227], v[226:227], v[164:165]
    v_pk_mul_f32 v[228:229], v[228:229], v[166:167]
    v_exp_f32 v222, v222
    v_exp_f32 v223, v223
    v_exp_f32 v224, v224
    v_exp_f32 v225, v225
    v_exp_f32 v226, v226
    v_exp_f32 v227, v227
    v_exp_f32 v228, v228
    v_exp_f32 v229, v229
    v_pk_add_f32 v[222:223], v[222:223], v[220:221]
    v_pk_add_f32 v[224:225], v[224:225], v[220:221]
    v_pk_add_f32 v[226:227], v[226:227], v[220:221]
    v_pk_add_f32 v[228:229], v[228:229], v[220:221]
    v_rcp_f32 v222, v222
    v_rcp_f32 v223, v223
    v_rcp_f32 v224, v224
    v_rcp_f32 v225, v225
    v_rcp_f32 v226, v226
    v_rcp_f32 v227, v227
    v_rcp_f32 v228, v228
    v_rcp_f32 v229, v229
    v_pk_mul_f32 v[160:161], v[160:161], v[222:223]
    v_pk_mul_f32 v[162:163], v[162:163], v[224:225]
    v_pk_mul_f32 v[164:165], v[164:165], v[226:227]
    v_pk_mul_f32 v[166:167], v[166:167], v[228:229]
    v_pk_mul_f32 v[222:223], v[168:169], v[168:169]
    v_pk_mul_f32 v[224:225], v[170:171], v[170:171]
    v_pk_mul_f32 v[226:227], v[172:173], v[172:173]
    v_pk_mul_f32 v[228:229], v[174:175], v[174:175]
    v_pk_fma_f32 v[222:223], v[222:223], v[216:217], v[218:219]
    v_pk_fma_f32 v[224:225], v[224:225], v[216:217], v[218:219]
    v_pk_fma_f32 v[226:227], v[226:227], v[216:217], v[218:219]
    v_pk_fma_f32 v[228:229], v[228:229], v[216:217], v[218:219]
    v_pk_mul_f32 v[222:223], v[222:223], v[168:169]
    v_pk_mul_f32 v[224:225], v[224:225], v[170:171]
    v_pk_mul_f32 v[226:227], v[226:227], v[172:173]
    v_pk_mul_f32 v[228:229], v[228:229], v[174:175]
    v_exp_f32 v222, v222
    v_exp_f32 v223, v223
    v_exp_f32 v224, v224
    v_exp_f32 v225, v225
    v_exp_f32 v226, v226
    v_exp_f32 v227, v227
    v_exp_f32 v228, v228
    v_exp_f32 v229, v229
    v_pk_add_f32 v[222:223], v[222:223], v[220:221]
    v_pk_add_f32 v[224:225], v[224:225], v[220:221]
    v_pk_add_f32 v[226:227], v[226:227], v[220:221]
    v_pk_add_f32 v[228:229], v[228:229], v[220:221]
    v_rcp_f32 v222, v222
    v_rcp_f32 v223, v223
    v_rcp_f32 v224, v224
    v_rcp_f32 v225, v225
    v_rcp_f32 v226, v226
    v_rcp_f32 v227, v227
    v_rcp_f32 v228, v228
    v_rcp_f32 v229, v229
    v_pk_mul_f32 v[168:169], v[168:169], v[222:223]
    v_pk_mul_f32 v[170:171], v[170:171], v[224:225]
    v_pk_mul_f32 v[172:173], v[172:173], v[226:227]
    v_pk_mul_f32 v[174:175], v[174:175], v[228:229]
    v_pk_mul_f32 v[222:223], v[176:177], v[176:177]
    v_pk_mul_f32 v[224:225], v[178:179], v[178:179]
    v_pk_mul_f32 v[226:227], v[180:181], v[180:181]
    v_pk_mul_f32 v[228:229], v[182:183], v[182:183]
    v_pk_fma_f32 v[222:223], v[222:223], v[216:217], v[218:219]
    v_pk_fma_f32 v[224:225], v[224:225], v[216:217], v[218:219]
    v_pk_fma_f32 v[226:227], v[226:227], v[216:217], v[218:219]
    v_pk_fma_f32 v[228:229], v[228:229], v[216:217], v[218:219]
    v_pk_mul_f32 v[222:223], v[222:223], v[176:177]
    v_pk_mul_f32 v[224:225], v[224:225], v[178:179]
    v_pk_mul_f32 v[226:227], v[226:227], v[180:181]
    v_pk_mul_f32 v[228:229], v[228:229], v[182:183]
    v_exp_f32 v222, v222
    v_exp_f32 v223, v223
    v_exp_f32 v224, v224
    v_exp_f32 v225, v225
    v_exp_f32 v226, v226
    v_exp_f32 v227, v227
    v_exp_f32 v228, v228
    v_exp_f32 v229, v229
    v_pk_add_f32 v[222:223], v[222:223], v[220:221]
    v_pk_add_f32 v[224:225], v[224:225], v[220:221]
    v_pk_add_f32 v[226:227], v[226:227], v[220:221]
    v_pk_add_f32 v[228:229], v[228:229], v[220:221]
    v_rcp_f32 v222, v222
    v_rcp_f32 v223, v223
    v_rcp_f32 v224, v224
    v_rcp_f32 v225, v225
    v_rcp_f32 v226, v226
    v_rcp_f32 v227, v227
    v_rcp_f32 v228, v228
    v_rcp_f32 v229, v229
    v_pk_mul_f32 v[176:177], v[176:177], v[222:223]
    v_pk_mul_f32 v[178:179], v[178:179], v[224:225]
    v_pk_mul_f32 v[180:181], v[180:181], v[226:227]
    v_pk_mul_f32 v[182:183], v[182:183], v[228:229]
    v_pk_mul_f32 v[222:223], v[184:185], v[184:185]
    v_pk_mul_f32 v[224:225], v[186:187], v[186:187]
    v_pk_mul_f32 v[226:227], v[188:189], v[188:189]
    v_pk_mul_f32 v[228:229], v[190:191], v[190:191]
    v_pk_fma_f32 v[222:223], v[222:223], v[216:217], v[218:219]
    v_pk_fma_f32 v[224:225], v[224:225], v[216:217], v[218:219]
    v_pk_fma_f32 v[226:227], v[226:227], v[216:217], v[218:219]
    v_pk_fma_f32 v[228:229], v[228:229], v[216:217], v[218:219]
    v_pk_mul_f32 v[222:223], v[222:223], v[184:185]
    v_pk_mul_f32 v[224:225], v[224:225], v[186:187]
    v_pk_mul_f32 v[226:227], v[226:227], v[188:189]
    v_pk_mul_f32 v[228:229], v[228:229], v[190:191]
    v_exp_f32 v222, v222
    v_exp_f32 v223, v223
    v_exp_f32 v224, v224
    v_exp_f32 v225, v225
    v_exp_f32 v226, v226
    v_exp_f32 v227, v227
    v_exp_f32 v228, v228
    v_exp_f32 v229, v229
    v_pk_add_f32 v[222:223], v[222:223], v[220:221]
    v_pk_add_f32 v[224:225], v[224:225], v[220:221]
    v_pk_add_f32 v[226:227], v[226:227], v[220:221]
    v_pk_add_f32 v[228:229], v[228:229], v[220:221]
    v_rcp_f32 v222, v222
    v_rcp_f32 v223, v223
    v_rcp_f32 v224, v224
    v_rcp_f32 v225, v225
    v_rcp_f32 v226, v226
    v_rcp_f32 v227, v227
    v_rcp_f32 v228, v228
    v_rcp_f32 v229, v229
    v_pk_mul_f32 v[184:185], v[184:185], v[222:223]
    v_pk_mul_f32 v[186:187], v[186:187], v[224:225]
    v_pk_mul_f32 v[188:189], v[188:189], v[226:227]
    v_pk_mul_f32 v[190:191], v[190:191], v[228:229]
    v_pk_mul_f32 v[222:223], v[192:193], v[192:193]
    v_pk_mul_f32 v[224:225], v[194:195], v[194:195]
    v_pk_mul_f32 v[226:227], v[196:197], v[196:197]
    v_pk_mul_f32 v[228:229], v[198:199], v[198:199]
    v_pk_fma_f32 v[222:223], v[222:223], v[216:217], v[218:219]
    v_pk_fma_f32 v[224:225], v[224:225], v[216:217], v[218:219]
    v_pk_fma_f32 v[226:227], v[226:227], v[216:217], v[218:219]
    v_pk_fma_f32 v[228:229], v[228:229], v[216:217], v[218:219]
    v_pk_mul_f32 v[222:223], v[222:223], v[192:193]
    v_pk_mul_f32 v[224:225], v[224:225], v[194:195]
    v_pk_mul_f32 v[226:227], v[226:227], v[196:197]
    v_pk_mul_f32 v[228:229], v[228:229], v[198:199]
    v_exp_f32 v222, v222
    v_exp_f32 v223, v223
    v_exp_f32 v224, v224
    v_exp_f32 v225, v225
    v_exp_f32 v226, v226
    v_exp_f32 v227, v227
    v_exp_f32 v228, v228
    v_exp_f32 v229, v229
    v_pk_add_f32 v[222:223], v[222:223], v[220:221]
    v_pk_add_f32 v[224:225], v[224:225], v[220:221]
    v_pk_add_f32 v[226:227], v[226:227], v[220:221]
    v_pk_add_f32 v[228:229], v[228:229], v[220:221]
    v_rcp_f32 v222, v222
    v_rcp_f32 v223, v223
    v_rcp_f32 v224, v224
    v_rcp_f32 v225, v225
    v_rcp_f32 v226, v226
    v_rcp_f32 v227, v227
    v_rcp_f32 v228, v228
    v_rcp_f32 v229, v229
    v_pk_mul_f32 v[192:193], v[192:193], v[222:223]
    v_pk_mul_f32 v[194:195], v[194:195], v[224:225]
    v_pk_mul_f32 v[196:197], v[196:197], v[226:227]
    v_pk_mul_f32 v[198:199], v[198:199], v[228:229]
    v_pk_mul_f32 v[222:223], v[200:201], v[200:201]
    v_pk_mul_f32 v[224:225], v[202:203], v[202:203]
    v_pk_mul_f32 v[226:227], v[204:205], v[204:205]
    v_pk_mul_f32 v[228:229], v[206:207], v[206:207]
    v_pk_fma_f32 v[222:223], v[222:223], v[216:217], v[218:219]
    v_pk_fma_f32 v[224:225], v[224:225], v[216:217], v[218:219]
    v_pk_fma_f32 v[226:227], v[226:227], v[216:217], v[218:219]
    v_pk_fma_f32 v[228:229], v[228:229], v[216:217], v[218:219]
    v_pk_mul_f32 v[222:223], v[222:223], v[200:201]
    v_pk_mul_f32 v[224:225], v[224:225], v[202:203]
    v_pk_mul_f32 v[226:227], v[226:227], v[204:205]
    v_pk_mul_f32 v[228:229], v[228:229], v[206:207]
    v_exp_f32 v222, v222
    v_exp_f32 v223, v223
    v_exp_f32 v224, v224
    v_exp_f32 v225, v225
    v_exp_f32 v226, v226
    v_exp_f32 v227, v227
    v_exp_f32 v228, v228
    v_exp_f32 v229, v229
    v_pk_add_f32 v[222:223], v[222:223], v[220:221]
    v_pk_add_f32 v[224:225], v[224:225], v[220:221]
    v_pk_add_f32 v[226:227], v[226:227], v[220:221]
    v_pk_add_f32 v[228:229], v[228:229], v[220:221]
    v_rcp_f32 v222, v222
    v_rcp_f32 v223, v223
    v_rcp_f32 v224, v224
    v_rcp_f32 v225, v225
    v_rcp_f32 v226, v226
    v_rcp_f32 v227, v227
    v_rcp_f32 v228, v228
    v_rcp_f32 v229, v229
    v_pk_mul_f32 v[200:201], v[200:201], v[222:223]
    v_pk_mul_f32 v[202:203], v[202:203], v[224:225]
    v_pk_mul_f32 v[204:205], v[204:205], v[226:227]
    v_pk_mul_f32 v[206:207], v[206:207], v[228:229]
    v_pk_mul_f32 v[222:223], v[208:209], v[208:209]
    v_pk_mul_f32 v[224:225], v[210:211], v[210:211]
    v_pk_mul_f32 v[226:227], v[212:213], v[212:213]
    v_pk_mul_f32 v[228:229], v[214:215], v[214:215]
    v_pk_fma_f32 v[222:223], v[222:223], v[216:217], v[218:219]
    v_pk_fma_f32 v[224:225], v[224:225], v[216:217], v[218:219]
    v_pk_fma_f32 v[226:227], v[226:227], v[216:217], v[218:219]
    v_pk_fma_f32 v[228:229], v[228:229], v[216:217], v[218:219]
    v_pk_mul_f32 v[222:223], v[222:223], v[208:209]
    v_pk_mul_f32 v[224:225], v[224:225], v[210:211]
    v_pk_mul_f32 v[226:227], v[226:227], v[212:213]
    v_pk_mul_f32 v[228:229], v[228:229], v[214:215]
    v_exp_f32 v222, v222
    v_exp_f32 v223, v223
    v_exp_f32 v224, v224
    v_exp_f32 v225, v225
    v_exp_f32 v226, v226
    v_exp_f32 v227, v227
    v_exp_f32 v228, v228
    v_exp_f32 v229, v229
    v_pk_add_f32 v[222:223], v[222:223], v[220:221]
    v_pk_add_f32 v[224:225], v[224:225], v[220:221]
    v_pk_add_f32 v[226:227], v[226:227], v[220:221]
    v_pk_add_f32 v[228:229], v[228:229], v[220:221]
    v_rcp_f32 v222, v222
    v_rcp_f32 v223, v223
    v_rcp_f32 v224, v224
    v_rcp_f32 v225, v225
    v_rcp_f32 v226, v226
    v_rcp_f32 v227, v227
    v_rcp_f32 v228, v228
    v_rcp_f32 v229, v229
    v_pk_mul_f32 v[208:209], v[208:209], v[222:223]
    v_pk_mul_f32 v[210:211], v[210:211], v[224:225]
    v_pk_mul_f32 v[212:213], v[212:213], v[226:227]
    v_pk_mul_f32 v[214:215], v[214:215], v[228:229]
    v_pk_add_f32 v[16:17], v[104:105], v[120:121]
    v_pk_mul_f32 v[32:33], v[104:105], v[104:105]
    v_pk_add_f32 v[18:19], v[106:107], v[122:123]
    v_pk_mul_f32 v[34:35], v[106:107], v[106:107]
    v_pk_add_f32 v[20:21], v[108:109], v[124:125]
    v_pk_mul_f32 v[36:37], v[108:109], v[108:109]
    v_pk_add_f32 v[22:23], v[110:111], v[126:127]
    v_pk_mul_f32 v[38:39], v[110:111], v[110:111]
    v_pk_add_f32 v[24:25], v[112:113], v[128:129]
    v_pk_mul_f32 v[40:41], v[112:113], v[112:113]
    v_pk_add_f32 v[26:27], v[114:115], v[130:131]
    v_pk_mul_f32 v[42:43], v[114:115], v[114:115]
    v_pk_add_f32 v[28:29], v[116:117], v[132:133]
    v_pk_mul_f32 v[44:45], v[116:117], v[116:117]
    v_pk_add_f32 v[30:31], v[118:119], v[134:135]
    v_pk_mul_f32 v[46:47], v[118:119], v[118:119]
    v_pk_fma_f32 v[32:33], v[120:121], v[120:121], v[32:33]
    v_pk_fma_f32 v[34:35], v[122:123], v[122:123], v[34:35]
    v_pk_fma_f32 v[36:37], v[124:125], v[124:125], v[36:37]
    v_pk_fma_f32 v[38:39], v[126:127], v[126:127], v[38:39]
    v_pk_fma_f32 v[40:41], v[128:129], v[128:129], v[40:41]
    v_pk_fma_f32 v[42:43], v[130:131], v[130:131], v[42:43]
    v_pk_fma_f32 v[44:45], v[132:133], v[132:133], v[44:45]
    v_pk_fma_f32 v[46:47], v[134:135], v[134:135], v[46:47]
    v_pk_add_f32 v[16:17], v[16:17], v[136:137]
    v_pk_fma_f32 v[32:33], v[136:137], v[136:137], v[32:33]
    v_pk_add_f32 v[18:19], v[18:19], v[138:139]
    v_pk_fma_f32 v[34:35], v[138:139], v[138:139], v[34:35]
    v_pk_add_f32 v[20:21], v[20:21], v[140:141]
    v_pk_fma_f32 v[36:37], v[140:141], v[140:141], v[36:37]
    v_pk_add_f32 v[22:23], v[22:23], v[142:143]
    v_pk_fma_f32 v[38:39], v[142:143], v[142:143], v[38:39]
    v_pk_add_f32 v[24:25], v[24:25], v[144:145]
    v_pk_fma_f32 v[40:41], v[144:145], v[144:145], v[40:41]
    v_pk_add_f32 v[26:27], v[26:27], v[146:147]
    v_pk_fma_f32 v[42:43], v[146:147], v[146:147], v[42:43]
    v_pk_add_f32 v[28:29], v[28:29], v[148:149]
    v_pk_fma_f32 v[44:45], v[148:149], v[148:149], v[44:45]
    v_pk_add_f32 v[30:31], v[30:31], v[150:151]
    v_pk_fma_f32 v[46:47], v[150:151], v[150:151], v[46:47]
    v_pk_add_f32 v[16:17], v[16:17], v[152:153]
    v_pk_fma_f32 v[32:33], v[152:153], v[152:153], v[32:33]
    v_pk_add_f32 v[18:19], v[18:19], v[154:155]
    v_pk_fma_f32 v[34:35], v[154:155], v[154:155], v[34:35]
    v_pk_add_f32 v[20:21], v[20:21], v[156:157]
    v_pk_fma_f32 v[36:37], v[156:157], v[156:157], v[36:37]
    v_pk_add_f32 v[22:23], v[22:23], v[158:159]
    v_pk_fma_f32 v[38:39], v[158:159], v[158:159], v[38:39]
    v_pk_add_f32 v[24:25], v[24:25], v[160:161]
    v_pk_fma_f32 v[40:41], v[160:161], v[160:161], v[40:41]
    v_pk_add_f32 v[26:27], v[26:27], v[162:163]
    v_pk_fma_f32 v[42:43], v[162:163], v[162:163], v[42:43]
    v_pk_add_f32 v[28:29], v[28:29], v[164:165]
    v_pk_fma_f32 v[44:45], v[164:165], v[164:165], v[44:45]
    v_pk_add_f32 v[30:31], v[30:31], v[166:167]
    v_pk_fma_f32 v[46:47], v[166:167], v[166:167], v[46:47]
    v_pk_add_f32 v[16:17], v[16:17], v[168:169]
    v_pk_fma_f32 v[32:33], v[168:169], v[168:169], v[32:33]
    v_pk_add_f32 v[18:19], v[18:19], v[170:171]
    v_pk_fma_f32 v[34:35], v[170:171], v[170:171], v[34:35]
    v_pk_add_f32 v[20:21], v[20:21], v[172:173]
    v_pk_fma_f32 v[36:37], v[172:173], v[172:173], v[36:37]
    v_pk_add_f32 v[22:23], v[22:23], v[174:175]
    v_pk_fma_f32 v[38:39], v[174:175], v[174:175], v[38:39]
    v_pk_add_f32 v[24:25], v[24:25], v[176:177]
    v_pk_fma_f32 v[40:41], v[176:177], v[176:177], v[40:41]
    v_pk_add_f32 v[26:27], v[26:27], v[178:179]
    v_pk_fma_f32 v[42:43], v[178:179], v[178:179], v[42:43]
    v_pk_add_f32 v[28:29], v[28:29], v[180:181]
    v_pk_fma_f32 v[44:45], v[180:181], v[180:181], v[44:45]
    v_pk_add_f32 v[30:31], v[30:31], v[182:183]
    v_pk_fma_f32 v[46:47], v[182:183], v[182:183], v[46:47]
    v_pk_add_f32 v[16:17], v[16:17], v[184:185]
    v_pk_fma_f32 v[32:33], v[184:185], v[184:185], v[32:33]
    v_pk_add_f32 v[18:19], v[18:19], v[186:187]
    v_pk_fma_f32 v[34:35], v[186:187], v[186:187], v[34:35]
    v_pk_add_f32 v[20:21], v[20:21], v[188:189]
    v_pk_fma_f32 v[36:37], v[188:189], v[188:189], v[36:37]
    v_pk_add_f32 v[22:23], v[22:23], v[190:191]
    v_pk_fma_f32 v[38:39], v[190:191], v[190:191], v[38:39]
    v_pk_add_f32 v[24:25], v[24:25], v[192:193]
    v_pk_fma_f32 v[40:41], v[192:193], v[192:193], v[40:41]
    v_pk_add_f32 v[26:27], v[26:27], v[194:195]
    v_pk_fma_f32 v[42:43], v[194:195], v[194:195], v[42:43]
    v_pk_add_f32 v[28:29], v[28:29], v[196:197]
    v_pk_fma_f32 v[44:45], v[196:197], v[196:197], v[44:45]
    v_pk_add_f32 v[30:31], v[30:31], v[198:199]
    v_pk_fma_f32 v[46:47], v[198:199], v[198:199], v[46:47]
    v_pk_add_f32 v[16:17], v[16:17], v[200:201]
    v_pk_fma_f32 v[32:33], v[200:201], v[200:201], v[32:33]
    v_pk_add_f32 v[18:19], v[18:19], v[202:203]
    v_pk_fma_f32 v[34:35], v[202:203], v[202:203], v[34:35]
    v_pk_add_f32 v[20:21], v[20:21], v[204:205]
    v_pk_fma_f32 v[36:37], v[204:205], v[204:205], v[36:37]
    v_pk_add_f32 v[22:23], v[22:23], v[206:207]
    v_pk_fma_f32 v[38:39], v[206:207], v[206:207], v[38:39]
    v_pk_add_f32 v[24:25], v[24:25], v[208:209]
    v_pk_fma_f32 v[40:41], v[208:209], v[208:209], v[40:41]
    v_pk_add_f32 v[26:27], v[26:27], v[210:211]
    v_pk_fma_f32 v[42:43], v[210:211], v[210:211], v[42:43]
    v_pk_add_f32 v[28:29], v[28:29], v[212:213]
    v_pk_fma_f32 v[44:45], v[212:213], v[212:213], v[44:45]
    v_pk_add_f32 v[30:31], v[30:31], v[214:215]
    v_pk_fma_f32 v[46:47], v[214:215], v[214:215], v[46:47]
    s_nop 1
    v_add_f32_dpp v48, v16, v16 row_ror:8 row_mask:0xf bank_mask:0x3
    v_add_f32_dpp v49, v17, v17 row_ror:8 row_mask:0xf bank_mask:0x3
    v_add_f32_dpp v50, v18, v18 row_ror:8 row_mask:0xf bank_mask:0x3
    v_add_f32_dpp v51, v19, v19 row_ror:8 row_mask:0xf bank_mask:0x3
    v_add_f32_dpp v52, v32, v32 row_ror:8 row_mask:0xf bank_mask:0x3
    v_add_f32_dpp v53, v33, v33 row_ror:8 row_mask:0xf bank_mask:0x3
    v_add_f32_dpp v54, v34, v34 row_ror:8 row_mask:0xf bank_mask:0x3
    v_add_f32_dpp v55, v35, v35 row_ror:8 row_mask:0xf bank_mask:0x3
    v_add_f32_dpp v56, v20, v20 row_ror:8 row_mask:0xf bank_mask:0x3
    v_add_f32_dpp v57, v21, v21 row_ror:8 row_mask:0xf bank_mask:0x3
    v_add_f32_dpp v58, v22, v22 row_ror:8 row_mask:0xf bank_mask:0x3
    v_add_f32_dpp v59, v23, v23 row_ror:8 row_mask:0xf bank_mask:0x3
    v_add_f32_dpp v60, v36, v36 row_ror:8 row_mask:0xf bank_mask:0x3
    v_add_f32_dpp v61, v37, v37 row_ror:8 row_mask:0xf bank_mask:0x3
    v_add_f32_dpp v62, v38, v38 row_ror:8 row_mask:0xf bank_mask:0x3
    v_add_f32_dpp v63, v39, v39 row_ror:8 row_mask:0xf bank_mask:0x3
    v_add_f32_dpp v48, v24, v24 row_ror:8 row_mask:0xf bank_mask:0xc
    v_add_f32_dpp v49, v25, v25 row_ror:8 row_mask:0xf bank_mask:0xc
    v_add_f32_dpp v50, v26, v26 row_ror:8 row_mask:0xf bank_mask:0xc
    v_add_f32_dpp v51, v27, v27 row_ror:8 row_mask:0xf bank_mask:0xc
    v_add_f32_dpp v52, v40, v40 row_ror:8 row_mask:0xf bank_mask:0xc
    v_add_f32_dpp v53, v41, v41 row_ror:8 row_mask:0xf bank_mask:0xc
    v_add_f32_dpp v54, v42, v42 row_ror:8 row_mask:0xf bank_mask:0xc
    v_add_f32_dpp v55, v43, v43 row_ror:8 row_mask:0xf bank_mask:0xc
    v_add_f32_dpp v56, v28, v28 row_ror:8 row_mask:0xf bank_mask:0xc
    v_add_f32_dpp v57, v29, v29 row_ror:8 row_mask:0xf bank_mask:0xc
    v_add_f32_dpp v58, v30, v30 row_ror:8 row_mask:0xf bank_mask:0xc
    v_add_f32_dpp v59, v31, v31 row_ror:8 row_mask:0xf bank_mask:0xc
    v_add_f32_dpp v60, v44, v44 row_ror:8 row_mask:0xf bank_mask:0xc
    v_add_f32_dpp v61, v45, v45 row_ror:8 row_mask:0xf bank_mask:0xc
    v_add_f32_dpp v62, v46, v46 row_ror:8 row_mask:0xf bank_mask:0xc
    v_add_f32_dpp v63, v47, v47 row_ror:8 row_mask:0xf bank_mask:0xc
    s_nop 1
    v_add_f32_dpp v64, v48, v48 row_ror:12 row_mask:0xf bank_mask:0x5
    v_add_f32_dpp v66, v49, v49 row_ror:12 row_mask:0xf bank_mask:0x5
    v_add_f32_dpp v68, v50, v50 row_ror:12 row_mask:0xf bank_mask:0x5
    v_add_f32_dpp v70, v51, v51 row_ror:12 row_mask:0xf bank_mask:0x5
    v_add_f32_dpp v65, v52, v52 row_ror:12 row_mask:0xf bank_mask:0x5
    v_add_f32_dpp v67, v53, v53 row_ror:12 row_mask:0xf bank_mask:0x5
    v_add_f32_dpp v69, v54, v54 row_ror:12 row_mask:0xf bank_mask:0x5
    v_add_f32_dpp v71, v55, v55 row_ror:12 row_mask:0xf bank_mask:0x5
    v_add_f32_dpp v64, v56, v56 row_ror:4 row_mask:0xf bank_mask:0xa
    v_add_f32_dpp v66, v57, v57 row_ror:4 row_mask:0xf bank_mask:0xa
    v_add_f32_dpp v68, v58, v58 row_ror:4 row_mask:0xf bank_mask:0xa
    v_add_f32_dpp v70, v59, v59 row_ror:4 row_mask:0xf bank_mask:0xa
    v_add_f32_dpp v65, v60, v60 row_ror:4 row_mask:0xf bank_mask:0xa
    v_add_f32_dpp v67, v61, v61 row_ror:4 row_mask:0xf bank_mask:0xa
    v_add_f32_dpp v69, v62, v62 row_ror:4 row_mask:0xf bank_mask:0xa
    v_add_f32_dpp v71, v63, v63 row_ror:4 row_mask:0xf bank_mask:0xa
    s_nop 1
    v_add_f32_dpp v72, v64, v64 quad_perm:[1,0,3,2] row_mask:0xf bank_mask:0xf
    v_add_f32_dpp v73, v65, v65 quad_perm:[1,0,3,2] row_mask:0xf bank_mask:0xf
    v_add_f32_dpp v74, v66, v66 quad_perm:[1,0,3,2] row_mask:0xf bank_mask:0xf
    v_add_f32_dpp v75, v67, v67 quad_perm:[1,0,3,2] row_mask:0xf bank_mask:0xf
    v_add_f32_dpp v76, v68, v68 quad_perm:[1,0,3,2] row_mask:0xf bank_mask:0xf
    v_add_f32_dpp v77, v69, v69 quad_perm:[1,0,3,2] row_mask:0xf bank_mask:0xf
    v_add_f32_dpp v78, v70, v70 quad_perm:[1,0,3,2] row_mask:0xf bank_mask:0xf
    v_add_f32_dpp v79, v71, v71 quad_perm:[1,0,3,2] row_mask:0xf bank_mask:0xf
    v_mov_b32 v82, s4
    v_mov_b32 v83, s4
    v_mov_b32 v86, s4
    v_mov_b32 v87, s4
    v_mov_b32 v90, s4
    v_mov_b32 v91, s4
    v_mov_b32 v94, s4
    v_mov_b32 v95, s4
    v_add_f32_dpp v80, v72, v72 quad_perm:[2,3,0,1] row_mask:0xf bank_mask:0xf
    v_add_f32_dpp v81, v73, v73 quad_perm:[2,3,0,1] row_mask:0xf bank_mask:0xf
    v_add_f32_dpp v84, v74, v74 quad_perm:[2,3,0,1] row_mask:0xf bank_mask:0xf
    v_add_f32_dpp v85, v75, v75 quad_perm:[2,3,0,1] row_mask:0xf bank_mask:0xf
    v_add_f32_dpp v88, v76, v76 quad_perm:[2,3,0,1] row_mask:0xf bank_mask:0xf
    v_add_f32_dpp v89, v77, v77 quad_perm:[2,3,0,1] row_mask:0xf bank_mask:0xf
    v_add_f32_dpp v92, v78, v78 quad_perm:[2,3,0,1] row_mask:0xf bank_mask:0xf
    v_add_f32_dpp v93, v79, v79 quad_perm:[2,3,0,1] row_mask:0xf bank_mask:0xf
    s_lshl_b32 s16, s24, 2
    s_add_u32 s16, s16, s7
    s_lshl_b32 s16, s16, 14
    s_add_u32 s16, s16, 0x2f80000
    s_and_b32 s17, s25, 15
    s_lshl_b32 s18, s17, 10
    s_add_u32 s18, s18, s16
    v_bfe_u32 v10, v9, 2, 2
    v_lshrrev_b32 v11, 4, v9
    v_lshlrev_b32 v10, 6, v10
    v_lshl_add_u32 v10, v11, 4, v10
    s_mov_b32 s22, 0x11111111
    s_mov_b32 exec_lo, s22
    s_mov_b32 exec_hi, s22
    buffer_store_dwordx4 v[80:83], v10, s[36:39], s18 offen offset:0 sc1
    buffer_store_dwordx4 v[84:87], v10, s[36:39], s18 offen offset:256 sc1
    buffer_store_dwordx4 v[88:91], v10, s[36:39], s18 offen offset:512 sc1
    buffer_store_dwordx4 v[92:95], v10, s[36:39], s18 offen offset:768 sc1
    s_mov_b64 exec, -1
    v_and_b32 v10, 3, v9
    v_lshlrev_b32 v10, 8, v10
    v_lshrrev_b32 v11, 2, v9
    v_lshl_add_u32 v10, v11, 4, v10
    s_add_u32 s19, s16, 4096
    s_add_u32 s20, s16, 8192
    s_add_u32 s21, s16, 12288
    s_sub_u32 s23, s16, 0x2effc08
    s_mov_b32 s13, 0x80000
g1_sp0_l:
    s_load_dword s26, s[100:101], s23 glc
    s_add_u32 s27, s23, 1024
    s_load_dword s27, s[100:101], s27 glc
    s_add_u32 s28, s23, 2048
    s_load_dword s28, s[100:101], s28 glc
    s_add_u32 s29, s23, 3072
    s_load_dword s29, s[100:101], s29 glc
    s_add_u32 s30, s23, 4096
    s_load_dword s30, s[100:101], s30 glc
    s_add_u32 s31, s23, 5120
    s_load_dword s31, s[100:101], s31 glc
    s_add_u32 s32, s23, 6144
    s_load_dword s32, s[100:101], s32 glc
    s_add_u32 s33, s23, 7168
    s_load_dword s33, s[100:101], s33 glc
    s_sub_u32 s13, s13, 1
    s_cbranch_scc1 g1_sp0_d
    s_waitcnt lgkmcnt(0)
    s_cmp_eq_u32 s26, s4
    s_cbranch_scc0 g1_sp0_w
    s_cmp_eq_u32 s27, s4
    s_cbranch_scc0 g1_sp0_w
    s_cmp_eq_u32 s28, s4
    s_cbranch_scc0 g1_sp0_w
    s_cmp_eq_u32 s29, s4
    s_cbranch_scc0 g1_sp0_w
    s_cmp_eq_u32 s30, s4
    s_cbranch_scc0 g1_sp0_w
    s_cmp_eq_u32 s31, s4
    s_cbranch_scc0 g1_sp0_w
    s_cmp_eq_u32 s32, s4
    s_cbranch_scc0 g1_sp0_w
    s_cmp_eq_u32 s33, s4
    s_cbranch_scc0 g1_sp0_w
    s_branch g1_sp0_d
g1_sp0_w:
    s_sleep 2
    s_branch g1_sp0_l
g1_sp0_d:
    s_waitcnt lgkmcnt(0)
    s_mov_b32 s13, 0x80000
g1_sp1_l:
    s_add_u32 s26, s23, 8192
    s_load_dword s26, s[100:101], s26 glc
    s_add_u32 s27, s23, 9216
    s_load_dword s27, s[100:101], s27 glc
    s_add_u32 s28, s23, 10240
    s_load_dword s28, s[100:101], s28 glc
    s_add_u32 s29, s23, 11264
    s_load_dword s29, s[100:101], s29 glc
    s_add_u32 s30, s23, 12288
    s_load_dword s30, s[100:101], s30 glc
    s_add_u32 s31, s23, 13312
    s_load_dword s31, s[100:101], s31 glc
    s_add_u32 s32, s23, 14336
    s_load_dword s32, s[100:101], s32 glc
    s_add_u32 s33, s23, 15360
    s_load_dword s33, s[100:101], s33 glc
    s_sub_u32 s13, s13, 1
    s_cbranch_scc1 g1_sp1_d
    s_waitcnt lgkmcnt(0)
    s_cmp_eq_u32 s26, s4
    s_cbranch_scc0 g1_sp1_w
    s_cmp_eq_u32 s27, s4
    s_cbranch_scc0 g1_sp1_w
    s_cmp_eq_u32 s28, s4
    s_cbranch_scc0 g1_sp1_w
    s_cmp_eq_u32 s29, s4
    s_cbranch_scc0 g1_sp1_w
    s_cmp_eq_u32 s30, s4
    s_cbranch_scc0 g1_sp1_w
    s_cmp_eq_u32 s31, s4
    s_cbranch_scc0 g1_sp1_w
    s_cmp_eq_u32 s32, s4
    s_cbranch_scc0 g1_sp1_w
    s_cmp_eq_u32 s33, s4
    s_cbranch_scc0 g1_sp1_w
    s_branch g1_sp1_d
g1_sp1_w:
    s_sleep 2
    s_branch g1_sp1_l
g1_sp1_d:
    s_waitcnt lgkmcnt(0)
    s_mov_b32 s22, 0x40000
g1_poll:
    buffer_load_dwordx3 v[16:18], v10, s[36:39], s16 offen offset:0 sc0 sc1
    buffer_load_dwordx3 v[20:22], v10, s[36:39], s16 offen offset:1024 sc0 sc1
    buffer_load_dwordx3 v[24:26], v10, s[36:39], s16 offen offset:2048 sc0 sc1
    buffer_load_dwordx3 v[28:30], v10, s[36:39], s16 offen offset:3072 sc0 sc1
    buffer_load_dwordx3 v[32:34], v10, s[36:39], s19 offen offset:0 sc0 sc1
    buffer_load_dwordx3 v[36:38], v10, s[36:39], s19 offen offset:1024 sc0 sc1
    buffer_load_dwordx3 v[40:42], v10, s[36:39], s19 offen offset:2048 sc0 sc1
    buffer_load_dwordx3 v[44:46], v10, s[36:39], s19 offen offset:3072 sc0 sc1
    buffer_load_dwordx3 v[48:50], v10, s[36:39], s20 offen offset:0 sc0 sc1
    buffer_load_dwordx3 v[52:54], v10, s[36:39], s20 offen offset:1024 sc0 sc1
    buffer_load_dwordx3 v[56:58], v10, s[36:39], s20 offen offset:2048 sc0 sc1
    buffer_load_dwordx3 v[60:62], v10, s[36:39], s20 offen offset:3072 sc0 sc1
    buffer_load_dwordx3 v[64:66], v10, s[36:39], s21 offen offset:0 sc0 sc1
    buffer_load_dwordx3 v[68:70], v10, s[36:39], s21 offen offset:1024 sc0 sc1
    buffer_load_dwordx3 v[72:74], v10, s[36:39], s21 offen offset:2048 sc0 sc1
    buffer_load_dwordx3 v[76:78], v10, s[36:39], s21 offen offset:3072 sc0 sc1
    s_waitcnt vmcnt(0)
    v_min3_u32 v12, v18, v22, v26
    v_max3_u32 v13, v18, v22, v26
    v_min3_u32 v12, v12, v30, v34
    v_max3_u32 v13, v13, v30, v34
    v_min3_u32 v12, v12, v38, v42
    v_max3_u32 v13, v13, v38, v42
    v_min3_u32 v12, v12, v46, v50
    v_max3_u32 v13, v13, v46, v50
    v_min3_u32 v12, v12, v54, v58
    v_max3_u32 v13, v13, v54, v58
    v_min3_u32 v12, v12, v62, v66
    v_max3_u32 v13, v13, v62, v66
    v_min3_u32 v12, v12, v70, v74
    v_max3_u32 v13, v13, v70, v74
    v_min_u32 v12, v12, v78
    v_max_u32 v13, v13, v78
    v_xor_b32 v12, s4, v12
    v_xor_b32 v13, s4, v13
    v_or_b32 v12, v12, v13
    v_cmp_ne_u32 vcc, 0, v12
    s_sub_u32 s22, s22, 1
    s_cselect_b64 vcc, 0, vcc
    s_nop 3
    s_cbranch_vccz g1_polled
    s_sleep 2
    s_branch g1_poll
g1_polled:
    v_add_f32 v16, v16, v20
    v_add_f32 v17, v17, v21
    v_add_f32 v16, v16, v24
    v_add_f32 v17, v17, v25
    v_add_f32 v16, v16, v28
    v_add_f32 v17, v17, v29
    v_add_f32 v16, v16, v32
    v_add_f32 v17, v17, v33
    v_add_f32 v16, v16, v36
    v_add_f32 v17, v17, v37
    v_add_f32 v16, v16, v40
    v_add_f32 v17, v17, v41
    v_add_f32 v16, v16, v44
    v_add_f32 v17, v17, v45
    v_add_f32 v16, v16, v48
    v_add_f32 v17, v17, v49
    v_add_f32 v16, v16, v52
    v_add_f32 v17, v17, v53
    v_add_f32 v16, v16, v56
    v_add_f32 v17, v17, v57
    v_add_f32 v16, v16, v60
    v_add_f32 v17, v17, v61
    v_add_f32 v16, v16, v64
    v_add_f32 v17, v17, v65
    v_add_f32 v16, v16, v68
    v_add_f32 v17, v17, v69
    v_add_f32 v16, v16, v72
    v_add_f32 v17, v17, v73
    v_add_f32 v16, v16, v76
    v_add_f32 v17, v17, v77
    v_mul_f32 v16, 0x3a124925, v16
    v_mul_f32 v17, 0x3a124925, v17
    v_fma_f32 v17, -v16, v16, v17
    v_max_f32 v17, 0, v17
    v_cvt_pk_bf16_f32 v18, v16, v17
    v_lshlrev_b32 v16, 16, v18
    v_and_b32 v17, 0xffff0000, v18
    v_add_f32 v17, 0x3727c5ac, v17
    v_cvt_pk_bf16_f32 v17, v17, v17
    v_and_b32 v17, 0xffff0000, v17
    v_sqrt_f32 v17, v17
    s_nop 0
    v_cvt_pk_bf16_f32 v17, v17, v17
    v_and_b32 v17, 0xffff0000, v17
    v_rcp_f32 v17, v17
    s_nop 0
    v_mul_f32 v16, v16, v17
    v_sub_f32 v16, 0, v16
    s_lshl_b32 s22, s7, 9
    s_add_u32 s22, s22, 158720
    v_lshlrev_b32 v11, 2, v9
    v_add_u32 v11, s22, v11
    ds_write_b32 v11, v17
    ds_write_b32 v11, v16 offset:256
    v_lshrrev_b32 v12, 4, v9
    v_lshlrev_b32 v12, 4, v12
    v_add_u32 v12, s22, v12
    s_waitcnt lgkmcnt(0)
    ds_read_b128 v[16:19], v12 offset:0
    ds_read_b128 v[32:35], v12 offset:256
    ds_read_b128 v[20:23], v12 offset:64
    ds_read_b128 v[36:39], v12 offset:320
    ds_read_b128 v[24:27], v12 offset:128
    ds_read_b128 v[40:43], v12 offset:384
    ds_read_b128 v[28:31], v12 offset:192
    ds_read_b128 v[44:47], v12 offset:448
    s_lshl_b32 s18, s24, 3
    s_lshl_b32 s19, s7, 1
    s_add_u32 s18, s18, s19
    s_lshl_b32 s19, s17, 6
    s_add_u32 s18, s18, s19
    s_mul_i32 s18, s18, 7168
    s_add_u32 s18, s18, 0x1800000
    s_add_u32 s19, s18, 4096
    v_lshlrev_b32 v10, 4, v9
    s_waitcnt lgkmcnt(0)
    v_fma_f32 v104, v104, v16, v32
    v_fma_f32 v105, v105, v17, v33
    v_fma_f32 v106, v106, v18, v34
    v_fma_f32 v107, v107, v19, v35
    v_cvt_pk_bf16_f32 v48, v104, v105
    v_cvt_pk_bf16_f32 v49, v106, v107
    v_fma_f32 v108, v108, v20, v36
    v_fma_f32 v109, v109, v21, v37
    v_fma_f32 v110, v110, v22, v38
    v_fma_f32 v111, v111, v23, v39
    v_cvt_pk_bf16_f32 v50, v108, v109
    v_cvt_pk_bf16_f32 v51, v110, v111
    buffer_store_dwordx4 v[48:51], v10, s[36:39], s18 offen offset:0 sc1
    v_fma_f32 v120, v120, v16, v32
    v_fma_f32 v121, v121, v17, v33
    v_fma_f32 v122, v122, v18, v34
    v_fma_f32 v123, v123, v19, v35
    v_cvt_pk_bf16_f32 v52, v120, v121
    v_cvt_pk_bf16_f32 v53, v122, v123
    v_fma_f32 v124, v124, v20, v36
    v_fma_f32 v125, v125, v21, v37
    v_fma_f32 v126, v126, v22, v38
    v_fma_f32 v127, v127, v23, v39
    v_cvt_pk_bf16_f32 v54, v124, v125
    v_cvt_pk_bf16_f32 v55, v126, v127
    buffer_store_dwordx4 v[52:55], v10, s[36:39], s18 offen offset:1024 sc1
    v_fma_f32 v136, v136, v16, v32
    v_fma_f32 v137, v137, v17, v33
    v_fma_f32 v138, v138, v18, v34
    v_fma_f32 v139, v139, v19, v35
    v_cvt_pk_bf16_f32 v56, v136, v137
    v_cvt_pk_bf16_f32 v57, v138, v139
    v_fma_f32 v140, v140, v20, v36
    v_fma_f32 v141, v141, v21, v37
    v_fma_f32 v142, v142, v22, v38
    v_fma_f32 v143, v143, v23, v39
    v_cvt_pk_bf16_f32 v58, v140, v141
    v_cvt_pk_bf16_f32 v59, v142, v143
    buffer_store_dwordx4 v[56:59], v10, s[36:39], s18 offen offset:2048 sc1
    v_fma_f32 v152, v152, v16, v32
    v_fma_f32 v153, v153, v17, v33
    v_fma_f32 v154, v154, v18, v34
    v_fma_f32 v155, v155, v19, v35
    v_cvt_pk_bf16_f32 v60, v152, v153
    v_cvt_pk_bf16_f32 v61, v154, v155
    v_fma_f32 v156, v156, v20, v36
    v_fma_f32 v157, v157, v21, v37
    v_fma_f32 v158, v158, v22, v38
    v_fma_f32 v159, v159, v23, v39
    v_cvt_pk_bf16_f32 v62, v156, v157
    v_cvt_pk_bf16_f32 v63, v158, v159
    buffer_store_dwordx4 v[60:63], v10, s[36:39], s18 offen offset:3072 sc1
    v_fma_f32 v168, v168, v16, v32
    v_fma_f32 v169, v169, v17, v33
    v_fma_f32 v170, v170, v18, v34
    v_fma_f32 v171, v171, v19, v35
    v_cvt_pk_bf16_f32 v64, v168, v169
    v_cvt_pk_bf16_f32 v65, v170, v171
    v_fma_f32 v172, v172, v20, v36
    v_fma_f32 v173, v173, v21, v37
    v_fma_f32 v174, v174, v22, v38
    v_fma_f32 v175, v175, v23, v39
    v_cvt_pk_bf16_f32 v66, v172, v173
    v_cvt_pk_bf16_f32 v67, v174, v175
    buffer_store_dwordx4 v[64:67], v10, s[36:39], s19 offen offset:0 sc1
    v_fma_f32 v184, v184, v16, v32
    v_fma_f32 v185, v185, v17, v33
    v_fma_f32 v186, v186, v18, v34
    v_fma_f32 v187, v187, v19, v35
    v_cvt_pk_bf16_f32 v68, v184, v185
    v_cvt_pk_bf16_f32 v69, v186, v187
    v_fma_f32 v188, v188, v20, v36
    v_fma_f32 v189, v189, v21, v37
    v_fma_f32 v190, v190, v22, v38
    v_fma_f32 v191, v191, v23, v39
    v_cvt_pk_bf16_f32 v70, v188, v189
    v_cvt_pk_bf16_f32 v71, v190, v191
    buffer_store_dwordx4 v[68:71], v10, s[36:39], s19 offen offset:1024 sc1
    v_fma_f32 v200, v200, v16, v32
    v_fma_f32 v201, v201, v17, v33
    v_fma_f32 v202, v202, v18, v34
    v_fma_f32 v203, v203, v19, v35
    v_cvt_pk_bf16_f32 v72, v200, v201
    v_cvt_pk_bf16_f32 v73, v202, v203
    v_fma_f32 v204, v204, v20, v36
    v_fma_f32 v205, v205, v21, v37
    v_fma_f32 v206, v206, v22, v38
    v_fma_f32 v207, v207, v23, v39
    v_cvt_pk_bf16_f32 v74, v204, v205
    v_cvt_pk_bf16_f32 v75, v206, v207
    buffer_store_dwordx4 v[72:75], v10, s[36:39], s19 offen offset:2048 sc1
    s_add_u32 s18, s18, 7168
    s_add_u32 s19, s19, 7168
    v_fma_f32 v112, v112, v24, v40
    v_fma_f32 v113, v113, v25, v41
    v_fma_f32 v114, v114, v26, v42
    v_fma_f32 v115, v115, v27, v43
    v_cvt_pk_bf16_f32 v76, v112, v113
    v_cvt_pk_bf16_f32 v77, v114, v115
    v_fma_f32 v116, v116, v28, v44
    v_fma_f32 v117, v117, v29, v45
    v_fma_f32 v118, v118, v30, v46
    v_fma_f32 v119, v119, v31, v47
    v_cvt_pk_bf16_f32 v78, v116, v117
    v_cvt_pk_bf16_f32 v79, v118, v119
    buffer_store_dwordx4 v[76:79], v10, s[36:39], s18 offen offset:0 sc1
    v_fma_f32 v128, v128, v24, v40
    v_fma_f32 v129, v129, v25, v41
    v_fma_f32 v130, v130, v26, v42
    v_fma_f32 v131, v131, v27, v43
    v_cvt_pk_bf16_f32 v80, v128, v129
    v_cvt_pk_bf16_f32 v81, v130, v131
    v_fma_f32 v132, v132, v28, v44
    v_fma_f32 v133, v133, v29, v45
    v_fma_f32 v134, v134, v30, v46
    v_fma_f32 v135, v135, v31, v47
    v_cvt_pk_bf16_f32 v82, v132, v133
    v_cvt_pk_bf16_f32 v83, v134, v135
    buffer_store_dwordx4 v[80:83], v10, s[36:39], s18 offen offset:1024 sc1
    v_fma_f32 v144, v144, v24, v40
    v_fma_f32 v145, v145, v25, v41
    v_fma_f32 v146, v146, v26, v42
    v_fma_f32 v147, v147, v27, v43
    v_cvt_pk_bf16_f32 v84, v144, v145
    v_cvt_pk_bf16_f32 v85, v146, v147
    v_fma_f32 v148, v148, v28, v44
    v_fma_f32 v149, v149, v29, v45
    v_fma_f32 v150, v150, v30, v46
    v_fma_f32 v151, v151, v31, v47
    v_cvt_pk_bf16_f32 v86, v148, v149
    v_cvt_pk_bf16_f32 v87, v150, v151
    buffer_store_dwordx4 v[84:87], v10, s[36:39], s18 offen offset:2048 sc1
    v_fma_f32 v160, v160, v24, v40
    v_fma_f32 v161, v161, v25, v41
    v_fma_f32 v162, v162, v26, v42
    v_fma_f32 v163, v163, v27, v43
    v_cvt_pk_bf16_f32 v88, v160, v161
    v_cvt_pk_bf16_f32 v89, v162, v163
    v_fma_f32 v164, v164, v28, v44
    v_fma_f32 v165, v165, v29, v45
    v_fma_f32 v166, v166, v30, v46
    v_fma_f32 v167, v167, v31, v47
    v_cvt_pk_bf16_f32 v90, v164, v165
    v_cvt_pk_bf16_f32 v91, v166, v167
    buffer_store_dwordx4 v[88:91], v10, s[36:39], s18 offen offset:3072 sc1
    v_fma_f32 v176, v176, v24, v40
    v_fma_f32 v177, v177, v25, v41
    v_fma_f32 v178, v178, v26, v42
    v_fma_f32 v179, v179, v27, v43
    v_cvt_pk_bf16_f32 v92, v176, v177
    v_cvt_pk_bf16_f32 v93, v178, v179
    v_fma_f32 v180, v180, v28, v44
    v_fma_f32 v181, v181, v29, v45
    v_fma_f32 v182, v182, v30, v46
    v_fma_f32 v183, v183, v31, v47
    v_cvt_pk_bf16_f32 v94, v180, v181
    v_cvt_pk_bf16_f32 v95, v182, v183
    buffer_store_dwordx4 v[92:95], v10, s[36:39], s19 offen offset:0 sc1
    v_fma_f32 v192, v192, v24, v40
    v_fma_f32 v193, v193, v25, v41
    v_fma_f32 v194, v194, v26, v42
    v_fma_f32 v195, v195, v27, v43
    v_cvt_pk_bf16_f32 v96, v192, v193
    v_cvt_pk_bf16_f32 v97, v194, v195
    v_fma_f32 v196, v196, v28, v44
    v_fma_f32 v197, v197, v29, v45
    v_fma_f32 v198, v198, v30, v46
    v_fma_f32 v199, v199, v31, v47
    v_cvt_pk_bf16_f32 v98, v196, v197
    v_cvt_pk_bf16_f32 v99, v198, v199
    buffer_store_dwordx4 v[96:99], v10, s[36:39], s19 offen offset:1024 sc1
    v_fma_f32 v208, v208, v24, v40
    v_fma_f32 v209, v209, v25, v41
    v_fma_f32 v210, v210, v26, v42
    v_fma_f32 v211, v211, v27, v43
    v_cvt_pk_bf16_f32 v100, v208, v209
    v_cvt_pk_bf16_f32 v101, v210, v211
    v_fma_f32 v212, v212, v28, v44
    v_fma_f32 v213, v213, v29, v45
    v_fma_f32 v214, v214, v30, v46
    v_fma_f32 v215, v215, v31, v47
    v_cvt_pk_bf16_f32 v102, v212, v213
    v_cvt_pk_bf16_f32 v103, v214, v215
    buffer_store_dwordx4 v[100:103], v10, s[36:39], s19 offen offset:2048 sc1
m_zjoin:
    s_and_b32 s12, s5, 3
    s_lshl_b32 s12, s12, 2
    s_lshr_b32 s13, s6, 3
    s_add_u32 s31, s12, s13
    s_lshr_b32 s12, s5, 2
    s_lshl_b32 s12, s12, 3
    s_and_b32 s13, s6, 7
    s_add_u32 s32, s12, s13
    v_lshlrev_b32 v5, 4, v9
    v_add_u32 v2, 49152, v5
    s_mul_i32 s12, s7, 3584
    v_add_u32 v4, s12, v5
    s_add_u32 s20, s12, 49152
    s_add_u32 s21, s12, 64000
    s_add_u32 s22, s12, 78848
    s_add_u32 s23, s12, 93696
    s_mul_i32 s26, s32, 458752
    s_add_u32 s26, s26, 0x1800000
    s_lshl_b32 s12, s31, 2
    s_add_u32 s12, s12, s7
    s_mov_b32 s27, 0
    s_mov_b32 s24, 0
    s_lshl_b32 s13, s7, 12
    s_add_u32 s25, s13, 108544
    s_add_u32 s30, s25, 49152
    v_bfe_u32 v160, v9, 1, 3
    v_lshrrev_b32 v161, 4, v9
    v_xor_b32 v160, v160, v161
    v_and_b32 v161, 15, v9
    v_lshlrev_b32 v161, 7, v161
    v_lshl_add_u32 v160, v160, 4, v161
    v_add_u32 v60, s25, v160
    v_xor_b32 v61, 64, v60
    v_mov_b32 v62, v60
    v_mov_b32 v63, v61
    s_lshl_b32 s13, s12, 5
    v_lshrrev_b32 v160, 5, v9
    v_lshlrev_b32 v160, 3, v160
    v_bfe_u32 v161, v9, 3, 2
    v_add3_u32 v160, v160, v161, s13
    v_lshlrev_b32 v160, 12, v160
    v_lshrrev_b32 v161, 4, v9
    v_and_b32 v162, 7, v9
    v_xor_b32 v161, v161, v162
    v_lshl_add_u32 v56, v161, 4, v160
    v_xor_b32 v57, 64, v56
    v_add_u32 v57, 64512, v57
    v_add_u32 v58, 14336, v56
    v_add_u32 v59, 14336, v57
    v_bfe_u32 v160, v9, 2, 2
    v_lshlrev_b32 v160, 3, v160
    v_and_b32 v161, 3, v9
    v_add3_u32 v160, v160, v161, s13
    v_lshlrev_b32 v7, 1, v160
    v_lshlrev_b32 v8, 3, v9
    s_add_u32 s34, s13, s32
    s_mul_i32 s34, s34, 3584
    s_add_u32 s34, s34, 0x1000000
    s_add_u32 s35, s34, 57344
    s_mov_b32 s33, 0
    v_lshlrev_b32 v1, 2, v9
    v_add_u32 v1, 157952, v1
    v_mov_b32 v3, 1
    s_lshl_b32 s13, s32, 3
    s_lshr_b32 s14, s31, 1
    s_add_u32 s14, s13, s14
    s_lshl_b32 s14, s14, 7
    v_mov_b32 v11, s14
    s_mov_b32 s29, 0x2f28000
    s_lshl_b32 s13, s13, 7
    s_add_u32 s19, s13, 81920
    v_mov_b32 v165, 158216
    v_mov_b32 v166, 1
    s_waitcnt vmcnt(0)
    s_mov_b64 exec, 1
    ds_add_rtn_u32 v166, v165, v166
    v_mov_b32 v165, s4
    s_waitcnt lgkmcnt(0)
    v_readfirstlane_b32 s12, v166
    v_mov_b32 v166, 0
    s_cmp_lg_u32 s12, 3
    s_cbranch_scc1 f1z_nf
    buffer_store_dword v165, v166, s[36:39], s15 offen sc1
f1z_nf:
    s_mov_b64 exec, -1
    buffer_load_ushort v182, v7, s[96:99], 0 offen offset:0
    buffer_load_ushort v198, v7, s[96:99], 0 offen offset:8
    s_waitcnt vmcnt(0)
    v_lshlrev_b32 v182, 16, v182
    v_lshlrev_b32 v198, 16, v198
    v_mov_b32 v104, v182
    v_mov_b32 v105, v182
    v_mov_b32 v106, v182
    v_mov_b32 v107, v182
    v_mov_b32 v108, v198
    v_mov_b32 v109, v198
    v_mov_b32 v110, v198
    v_mov_b32 v111, v198
    v_mov_b32 v112, v182
    v_mov_b32 v113, v182
    v_mov_b32 v114, v182
    v_mov_b32 v115, v182
    v_mov_b32 v116, v198
    v_mov_b32 v117, v198
    v_mov_b32 v118, v198
    v_mov_b32 v119, v198
    v_mov_b32 v120, v182
    v_mov_b32 v121, v182
    v_mov_b32 v122, v182
    v_mov_b32 v123, v182
    v_mov_b32 v124, v198
    v_mov_b32 v125, v198
    v_mov_b32 v126, v198
    v_mov_b32 v127, v198
    v_mov_b32 v128, v182
    v_mov_b32 v129, v182
    v_mov_b32 v130, v182
    v_mov_b32 v131, v182
    v_mov_b32 v132, v198
    v_mov_b32 v133, v198
    v_mov_b32 v134, v198
    v_mov_b32 v135, v198
    v_mov_b32 v136, v182
    v_mov_b32 v137, v182
    v_mov_b32 v138, v182
    v_mov_b32 v139, v182
    v_mov_b32 v140, v198
    v_mov_b32 v141, v198
    v_mov_b32 v142, v198
    v_mov_b32 v143, v198
    v_mov_b32 v144, v182
    v_mov_b32 v145, v182
    v_mov_b32 v146, v182
    v_mov_b32 v147, v182
    v_mov_b32 v148, v198
    v_mov_b32 v149, v198
    v_mov_b32 v150, v198
    v_mov_b32 v151, v198
    v_mov_b32 v152, v182
    v_mov_b32 v153, v182
    v_mov_b32 v154, v182
    v_mov_b32 v155, v182
    v_mov_b32 v156, v198
    v_mov_b32 v157, v198
    v_mov_b32 v158, v198
    v_mov_b32 v159, v198
    s_cmp_lg_u32 s3, 4
    s_cbranch_scc1 g_np
    s_mov_b32 s13, 0x80000
g_pl0_l:
    s_load_dword s15, s[100:101], s19 glc
    s_add_u32 s16, s19, 128
    s_load_dword s16, s[100:101], s16 glc
    s_add_u32 s17, s19, 256
    s_load_dword s17, s[100:101], s17 glc
    s_add_u32 s18, s19, 384
    s_load_dword s18, s[100:101], s18 glc
    s_sub_u32 s13, s13, 1
    s_cbranch_scc1 g_pl0_d
    s_waitcnt lgkmcnt(0)
    s_cmp_eq_u32 s15, s4
    s_cbranch_scc0 g_pl0_w
    s_cmp_eq_u32 s16, s4
    s_cbranch_scc0 g_pl0_w
    s_cmp_eq_u32 s17, s4
    s_cbranch_scc0 g_pl0_w
    s_cmp_eq_u32 s18, s4
    s_cbranch_scc0 g_pl0_w
    s_branch g_pl0_d
g_pl0_w:
    s_sleep 2
    s_branch g_pl0_l
g_pl0_d:
    s_waitcnt lgkmcnt(0)
    s_mov_b32 s13, 0x80000
g_pl1_l:
    s_add_u32 s15, s19, 512
    s_load_dword s15, s[100:101], s15 glc
    s_add_u32 s16, s19, 640
    s_load_dword s16, s[100:101], s16 glc
    s_add_u32 s17, s19, 768
    s_load_dword s17, s[100:101], s17 glc
    s_add_u32 s18, s19, 896
    s_load_dword s18, s[100:101], s18 glc
    s_sub_u32 s13, s13, 1
    s_cbranch_scc1 g_pl1_d
    s_waitcnt lgkmcnt(0)
    s_cmp_eq_u32 s15, s4
    s_cbranch_scc0 g_pl1_w
    s_cmp_eq_u32 s16, s4
    s_cbranch_scc0 g_pl1_w
    s_cmp_eq_u32 s17, s4
    s_cbranch_scc0 g_pl1_w
    s_cmp_eq_u32 s18, s4
    s_cbranch_scc0 g_pl1_w
    s_branch g_pl1_d
g_pl1_w:
    s_sleep 2
    s_branch g_pl1_l
g_pl1_d:
    s_waitcnt lgkmcnt(0)
g_np:
    s_add_u32 s33, s33, 4
    ds_add_u32 v1, v3
g_sp_s:
    ds_read_b32 v10, v1
    s_waitcnt lgkmcnt(0)
    v_readfirstlane_b32 s12, v10
    s_cmp_ge_u32 s12, s33
    s_cbranch_scc1 g_sp_x
    s_sleep 2
    s_branch g_sp_s
g_sp_x:
    s_mov_b32 m0, s20
    s_nop 0
    buffer_load_dwordx4 v4, s[36:39], s26 offen offset:0 sc1 lds
    buffer_load_dwordx4 v4, s[36:39], s26 offen offset:1024 sc1 lds
    buffer_load_dwordx4 v4, s[36:39], s26 offen offset:2048 sc1 lds
    buffer_load_dwordx4 v4, s[36:39], s26 offen offset:3072 sc1 lds
    s_add_u32 s26, s26, 14336
    s_add_u32 m0, s25, 0
    s_nop 0
    buffer_load_dwordx4 v56, s[44:47], s27 offen offset:0 lds
    buffer_load_dwordx4 v57, s[44:47], s27 offen offset:1024 lds
    buffer_load_dwordx4 v58, s[44:47], s27 offen offset:2048 lds
    buffer_load_dwordx4 v59, s[44:47], s27 offen offset:3072 lds
    s_add_u32 s27, s27, 128
    s_mov_b32 m0, s21
    s_nop 0
    buffer_load_dwordx4 v4, s[36:39], s26 offen offset:0 sc1 lds
    buffer_load_dwordx4 v4, s[36:39], s26 offen offset:1024 sc1 lds
    buffer_load_dwordx4 v4, s[36:39], s26 offen offset:2048 sc1 lds
    buffer_load_dwordx4 v4, s[36:39], s26 offen offset:3072 sc1 lds
    s_add_u32 s26, s26, 14336
    s_add_u32 m0, s25, 16384
    s_nop 0
    buffer_load_dwordx4 v56, s[44:47], s27 offen offset:0 lds
    buffer_load_dwordx4 v57, s[44:47], s27 offen offset:1024 lds
    buffer_load_dwordx4 v58, s[44:47], s27 offen offset:2048 lds
    buffer_load_dwordx4 v59, s[44:47], s27 offen offset:3072 lds
    s_add_u32 s27, s27, 128
    s_mov_b32 m0, s22
    s_nop 0
    buffer_load_dwordx4 v4, s[36:39], s26 offen offset:0 sc1 lds
    buffer_load_dwordx4 v4, s[36:39], s26 offen offset:1024 sc1 lds
    buffer_load_dwordx4 v4, s[36:39], s26 offen offset:2048 sc1 lds
    buffer_load_dwordx4 v4, s[36:39], s26 offen offset:3072 sc1 lds
    s_add_u32 s26, s26, 14336
    s_waitcnt vmcnt(12)
    s_add_u32 s33, s33, 4
    ds_add_u32 v1, v3
g_s0_s:
    ds_read_b32 v10, v1
    s_waitcnt lgkmcnt(0)
    v_readfirstlane_b32 s12, v10
    s_cmp_ge_u32 s12, s33
    s_cbranch_scc0 g_s0_s
    s_setprio 0
    ds_read_b128 v[40:43], v62 offset:0
    ds_read_b128 v[44:47], v62 offset:2048
    ds_read_b128 v[12:15], v2 offset:0
    ds_read_b128 v[16:19], v2 offset:1024
    ds_read_b128 v[20:23], v2 offset:2048
    ds_read_b128 v[24:27], v2 offset:3072
    ds_read_b128 v[28:31], v2 offset:4096
    ds_read_b128 v[32:35], v2 offset:5120
    ds_read_b128 v[36:39], v2 offset:6144
    s_mov_b32 s28, 2
.p2align 3
p2_gloop:
    s_waitcnt lgkmcnt(3)
    v_mfma_f32_16x16x32_bf16 v[104:107], v[12:15], v[40:43], v[104:107]
    s_waitcnt vmcnt(8)
    ds_add_u32 v1, v3
    ds_read_b128 v[48:51], v63 offset:0
    ds_read_b128 v[52:55], v63 offset:2048
    v_mfma_f32_16x16x32_bf16 v[108:111], v[12:15], v[44:47], v[108:111]
    ds_read_b128 v[12:15], v2 offset:7168
    s_add_u32 s33, s33, 4
    s_add_u32 s10, s28, s11
    s_bitcmp1_b32 0x4, s10
    s_cbranch_scc1 g_z10_r
g_z10_b:
    s_add_u32 m0, s25, 32768
    v_mfma_f32_16x16x32_bf16 v[112:115], v[16:19], v[40:43], v[112:115]
    buffer_load_dwordx4 v56, s[44:47], s27 offen offset:0 lds
    v_mfma_f32_16x16x32_bf16 v[116:119], v[16:19], v[44:47], v[116:119]
    ds_read_b128 v[16:19], v2 offset:8192
    v_mfma_f32_16x16x32_bf16 v[120:123], v[20:23], v[40:43], v[120:123]
    v_mfma_f32_16x16x32_bf16 v[124:127], v[20:23], v[44:47], v[124:127]
    ds_read_b128 v[20:23], v2 offset:9216
    buffer_load_dwordx4 v57, s[44:47], s27 offen offset:1024 lds
    v_mfma_f32_16x16x32_bf16 v[128:131], v[24:27], v[40:43], v[128:131]
    v_mfma_f32_16x16x32_bf16 v[132:135], v[24:27], v[44:47], v[132:135]
    ds_read_b128 v[24:27], v2 offset:10240
    s_waitcnt lgkmcnt(7)
    v_mfma_f32_16x16x32_bf16 v[136:139], v[28:31], v[40:43], v[136:139]
    v_mfma_f32_16x16x32_bf16 v[140:143], v[28:31], v[44:47], v[140:143]
    ds_read_b128 v[28:31], v2 offset:11264
    ds_read_b32 v10, v1
    buffer_load_dwordx4 v58, s[44:47], s27 offen offset:2048 lds
    v_mfma_f32_16x16x32_bf16 v[144:147], v[32:35], v[40:43], v[144:147]
    v_mfma_f32_16x16x32_bf16 v[148:151], v[32:35], v[44:47], v[148:151]
    ds_read_b128 v[32:35], v2 offset:12288
    v_mfma_f32_16x16x32_bf16 v[152:155], v[36:39], v[40:43], v[152:155]
    buffer_load_dwordx4 v59, s[44:47], s27 offen offset:3072 lds
    s_add_u32 s27, s27, 128
    v_mfma_f32_16x16x32_bf16 v[156:159], v[36:39], v[44:47], v[156:159]
    ds_read_b128 v[36:39], v2 offset:13312
    s_setprio 2
    s_waitcnt vmcnt(8) lgkmcnt(2)
    v_readfirstlane_b32 s12, v10
    s_setprio 0
    s_cmp_ge_u32 s12, s33
    s_cbranch_scc0 g_ck25_s
g_ck25_b:
    v_mfma_f32_16x16x32_bf16 v[104:107], v[12:15], v[48:51], v[104:107]
    ds_read_b128 v[40:43], v62 offset:16384
    ds_read_b128 v[44:47], v62 offset:18432
    v_mfma_f32_16x16x32_bf16 v[108:111], v[12:15], v[52:55], v[108:111]
    ds_read_b128 v[12:15], v2 offset:14848
    s_mov_b32 m0, s23
    v_mfma_f32_16x16x32_bf16 v[112:115], v[16:19], v[48:51], v[112:115]
    buffer_load_dwordx4 v4, s[36:39], s26 offen offset:0 sc1 lds
    v_mfma_f32_16x16x32_bf16 v[116:119], v[16:19], v[52:55], v[116:119]
    ds_read_b128 v[16:19], v2 offset:15872
    v_mfma_f32_16x16x32_bf16 v[120:123], v[20:23], v[48:51], v[120:123]
    v_mfma_f32_16x16x32_bf16 v[124:127], v[20:23], v[52:55], v[124:127]
    ds_read_b128 v[20:23], v2 offset:16896
    buffer_load_dwordx4 v4, s[36:39], s26 offen offset:1024 sc1 lds
    v_mfma_f32_16x16x32_bf16 v[128:131], v[24:27], v[48:51], v[128:131]
    v_mfma_f32_16x16x32_bf16 v[132:135], v[24:27], v[52:55], v[132:135]
    ds_read_b128 v[24:27], v2 offset:17920
    s_waitcnt lgkmcnt(6)
    v_mfma_f32_16x16x32_bf16 v[136:139], v[28:31], v[48:51], v[136:139]
    v_mfma_f32_16x16x32_bf16 v[140:143], v[28:31], v[52:55], v[140:143]
    ds_read_b128 v[28:31], v2 offset:18944
    buffer_load_dwordx4 v4, s[36:39], s26 offen offset:2048 sc1 lds
    v_mfma_f32_16x16x32_bf16 v[144:147], v[32:35], v[48:51], v[144:147]
    v_mfma_f32_16x16x32_bf16 v[148:151], v[32:35], v[52:55], v[148:151]
    ds_read_b128 v[32:35], v2 offset:19968
    v_mfma_f32_16x16x32_bf16 v[152:155], v[36:39], v[48:51], v[152:155]
    buffer_load_dwordx4 v4, s[36:39], s26 offen offset:3072 sc1 lds
    s_add_u32 s26, s26, 14336
    v_mfma_f32_16x16x32_bf16 v[156:159], v[36:39], v[52:55], v[156:159]
    ds_read_b128 v[36:39], v2 offset:20992
    s_waitcnt lgkmcnt(3)
    v_mfma_f32_16x16x32_bf16 v[104:107], v[12:15], v[40:43], v[104:107]
    s_waitcnt vmcnt(8)
    ds_add_u32 v1, v3
    ds_read_b128 v[48:51], v63 offset:16384
    ds_read_b128 v[52:55], v63 offset:18432
    v_mfma_f32_16x16x32_bf16 v[108:111], v[12:15], v[44:47], v[108:111]
    ds_read_b128 v[12:15], v2 offset:22016
    s_add_u32 s33, s33, 4
    s_add_u32 m0, s25, 0
    v_mfma_f32_16x16x32_bf16 v[112:115], v[16:19], v[40:43], v[112:115]
    buffer_load_dwordx4 v56, s[44:47], s27 offen offset:0 lds
    v_mfma_f32_16x16x32_bf16 v[116:119], v[16:19], v[44:47], v[116:119]
    ds_read_b128 v[16:19], v2 offset:23040
    v_mfma_f32_16x16x32_bf16 v[120:123], v[20:23], v[40:43], v[120:123]
    v_mfma_f32_16x16x32_bf16 v[124:127], v[20:23], v[44:47], v[124:127]
    ds_read_b128 v[20:23], v2 offset:24064
    buffer_load_dwordx4 v57, s[44:47], s27 offen offset:1024 lds
    v_mfma_f32_16x16x32_bf16 v[128:131], v[24:27], v[40:43], v[128:131]
    v_mfma_f32_16x16x32_bf16 v[132:135], v[24:27], v[44:47], v[132:135]
    ds_read_b128 v[24:27], v2 offset:25088
    s_waitcnt lgkmcnt(7)
    v_mfma_f32_16x16x32_bf16 v[136:139], v[28:31], v[40:43], v[136:139]
    v_mfma_f32_16x16x32_bf16 v[140:143], v[28:31], v[44:47], v[140:143]
    ds_read_b128 v[28:31], v2 offset:26112
    ds_read_b32 v10, v1
    buffer_load_dwordx4 v58, s[44:47], s27 offen offset:2048 lds
    v_mfma_f32_16x16x32_bf16 v[144:147], v[32:35], v[40:43], v[144:147]
    v_mfma_f32_16x16x32_bf16 v[148:151], v[32:35], v[44:47], v[148:151]
    ds_read_b128 v[32:35], v2 offset:27136
    v_mfma_f32_16x16x32_bf16 v[152:155], v[36:39], v[40:43], v[152:155]
    buffer_load_dwordx4 v59, s[44:47], s27 offen offset:3072 lds
    s_add_u32 s27, s27, 128
    v_mfma_f32_16x16x32_bf16 v[156:159], v[36:39], v[44:47], v[156:159]
    ds_read_b128 v[36:39], v2 offset:28160
    s_setprio 2
    s_waitcnt vmcnt(8) lgkmcnt(2)
    v_readfirstlane_b32 s12, v10
    s_setprio 0
    s_cmp_ge_u32 s12, s33
    s_cbranch_scc0 g_ck27_s
g_ck27_b:
    v_mfma_f32_16x16x32_bf16 v[104:107], v[12:15], v[48:51], v[104:107]
    ds_read_b128 v[40:43], v62 offset:32768
    ds_read_b128 v[44:47], v62 offset:34816
    v_mfma_f32_16x16x32_bf16 v[108:111], v[12:15], v[52:55], v[108:111]
    ds_read_b128 v[12:15], v2 offset:29696
    s_mov_b32 m0, s20
    v_mfma_f32_16x16x32_bf16 v[112:115], v[16:19], v[48:51], v[112:115]
    buffer_load_dwordx4 v4, s[36:39], s26 offen offset:0 sc1 lds
    v_mfma_f32_16x16x32_bf16 v[116:119], v[16:19], v[52:55], v[116:119]
    ds_read_b128 v[16:19], v2 offset:30720
    v_mfma_f32_16x16x32_bf16 v[120:123], v[20:23], v[48:51], v[120:123]
    v_mfma_f32_16x16x32_bf16 v[124:127], v[20:23], v[52:55], v[124:127]
    ds_read_b128 v[20:23], v2 offset:31744
    buffer_load_dwordx4 v4, s[36:39], s26 offen offset:1024 sc1 lds
    v_mfma_f32_16x16x32_bf16 v[128:131], v[24:27], v[48:51], v[128:131]
    v_mfma_f32_16x16x32_bf16 v[132:135], v[24:27], v[52:55], v[132:135]
    ds_read_b128 v[24:27], v2 offset:32768
    s_waitcnt lgkmcnt(6)
    v_mfma_f32_16x16x32_bf16 v[136:139], v[28:31], v[48:51], v[136:139]
    v_mfma_f32_16x16x32_bf16 v[140:143], v[28:31], v[52:55], v[140:143]
    ds_read_b128 v[28:31], v2 offset:33792
    buffer_load_dwordx4 v4, s[36:39], s26 offen offset:2048 sc1 lds
    v_mfma_f32_16x16x32_bf16 v[144:147], v[32:35], v[48:51], v[144:147]
    v_mfma_f32_16x16x32_bf16 v[148:151], v[32:35], v[52:55], v[148:151]
    ds_read_b128 v[32:35], v2 offset:34816
    v_mfma_f32_16x16x32_bf16 v[152:155], v[36:39], v[48:51], v[152:155]
    buffer_load_dwordx4 v4, s[36:39], s26 offen offset:3072 sc1 lds
    s_add_u32 s26, s26, 14336
    v_mfma_f32_16x16x32_bf16 v[156:159], v[36:39], v[52:55], v[156:159]
    ds_read_b128 v[36:39], v2 offset:35840
    s_waitcnt lgkmcnt(3)
    v_mfma_f32_16x16x32_bf16 v[104:107], v[12:15], v[40:43], v[104:107]
    s_waitcnt vmcnt(8)
    ds_add_u32 v1, v3
    ds_read_b128 v[48:51], v63 offset:32768
    ds_read_b128 v[52:55], v63 offset:34816
    v_mfma_f32_16x16x32_bf16 v[108:111], v[12:15], v[44:47], v[108:111]
    ds_read_b128 v[12:15], v2 offset:36864
    s_add_u32 s33, s33, 4
    s_add_u32 m0, s25, 16384
    v_mfma_f32_16x16x32_bf16 v[112:115], v[16:19], v[40:43], v[112:115]
    buffer_load_dwordx4 v56, s[44:47], s27 offen offset:0 lds
    v_mfma_f32_16x16x32_bf16 v[116:119], v[16:19], v[44:47], v[116:119]
    ds_read_b128 v[16:19], v2 offset:37888
    v_mfma_f32_16x16x32_bf16 v[120:123], v[20:23], v[40:43], v[120:123]
    v_mfma_f32_16x16x32_bf16 v[124:127], v[20:23], v[44:47], v[124:127]
    ds_read_b128 v[20:23], v2 offset:38912
    buffer_load_dwordx4 v57, s[44:47], s27 offen offset:1024 lds
    v_mfma_f32_16x16x32_bf16 v[128:131], v[24:27], v[40:43], v[128:131]
    v_mfma_f32_16x16x32_bf16 v[132:135], v[24:27], v[44:47], v[132:135]
    ds_read_b128 v[24:27], v2 offset:39936
    s_waitcnt lgkmcnt(7)
    v_mfma_f32_16x16x32_bf16 v[136:139], v[28:31], v[40:43], v[136:139]
    v_mfma_f32_16x16x32_bf16 v[140:143], v[28:31], v[44:47], v[140:143]
    ds_read_b128 v[28:31], v2 offset:40960
    ds_read_b32 v10, v1
    buffer_load_dwordx4 v58, s[44:47], s27 offen offset:2048 lds
    v_mfma_f32_16x16x32_bf16 v[144:147], v[32:35], v[40:43], v[144:147]
    v_mfma_f32_16x16x32_bf16 v[148:151], v[32:35], v[44:47], v[148:151]
    ds_read_b128 v[32:35], v2 offset:41984
    v_mfma_f32_16x16x32_bf16 v[152:155], v[36:39], v[40:43], v[152:155]
    buffer_load_dwordx4 v59, s[44:47], s27 offen offset:3072 lds
    s_add_u32 s27, s27, 128
    v_mfma_f32_16x16x32_bf16 v[156:159], v[36:39], v[44:47], v[156:159]
    ds_read_b128 v[36:39], v2 offset:43008
    s_setprio 2
    s_waitcnt vmcnt(8) lgkmcnt(2)
    v_readfirstlane_b32 s12, v10
    s_setprio 0
    s_cmp_ge_u32 s12, s33
    s_cbranch_scc0 g_ck29_s
g_ck29_b:
    v_mfma_f32_16x16x32_bf16 v[104:107], v[12:15], v[48:51], v[104:107]
    ds_read_b128 v[40:43], v62 offset:0
    ds_read_b128 v[44:47], v62 offset:2048
    v_mfma_f32_16x16x32_bf16 v[108:111], v[12:15], v[52:55], v[108:111]
    ds_read_b128 v[12:15], v2 offset:44544
    s_mov_b32 m0, s21
    v_mfma_f32_16x16x32_bf16 v[112:115], v[16:19], v[48:51], v[112:115]
    buffer_load_dwordx4 v4, s[36:39], s26 offen offset:0 sc1 lds
    v_mfma_f32_16x16x32_bf16 v[116:119], v[16:19], v[52:55], v[116:119]
    ds_read_b128 v[16:19], v2 offset:45568
    v_mfma_f32_16x16x32_bf16 v[120:123], v[20:23], v[48:51], v[120:123]
    v_mfma_f32_16x16x32_bf16 v[124:127], v[20:23], v[52:55], v[124:127]
    ds_read_b128 v[20:23], v2 offset:46592
    buffer_load_dwordx4 v4, s[36:39], s26 offen offset:1024 sc1 lds
    v_mfma_f32_16x16x32_bf16 v[128:131], v[24:27], v[48:51], v[128:131]
    v_mfma_f32_16x16x32_bf16 v[132:135], v[24:27], v[52:55], v[132:135]
    ds_read_b128 v[24:27], v2 offset:47616
    s_waitcnt lgkmcnt(6)
    v_mfma_f32_16x16x32_bf16 v[136:139], v[28:31], v[48:51], v[136:139]
    v_mfma_f32_16x16x32_bf16 v[140:143], v[28:31], v[52:55], v[140:143]
    ds_read_b128 v[28:31], v2 offset:48640
    buffer_load_dwordx4 v4, s[36:39], s26 offen offset:2048 sc1 lds
    v_mfma_f32_16x16x32_bf16 v[144:147], v[32:35], v[48:51], v[144:147]
    v_mfma_f32_16x16x32_bf16 v[148:151], v[32:35], v[52:55], v[148:151]
    ds_read_b128 v[32:35], v2 offset:49664
    v_mfma_f32_16x16x32_bf16 v[152:155], v[36:39], v[48:51], v[152:155]
    buffer_load_dwordx4 v4, s[36:39], s26 offen offset:3072 sc1 lds
    s_add_u32 s26, s26, 14336
    v_mfma_f32_16x16x32_bf16 v[156:159], v[36:39], v[52:55], v[156:159]
    ds_read_b128 v[36:39], v2 offset:50688
    s_waitcnt lgkmcnt(3)
    v_mfma_f32_16x16x32_bf16 v[104:107], v[12:15], v[40:43], v[104:107]
    s_waitcnt vmcnt(8)
    ds_add_u32 v1, v3
    ds_read_b128 v[48:51], v63 offset:0
    ds_read_b128 v[52:55], v63 offset:2048
    v_mfma_f32_16x16x32_bf16 v[108:111], v[12:15], v[44:47], v[108:111]
    ds_read_b128 v[12:15], v2 offset:51712
    s_add_u32 s33, s33, 4
    s_bitcmp1_b32 0x4, s10
    s_cbranch_scc1 g_z16_r
g_z16_b:
    s_add_u32 m0, s25, 32768
    v_mfma_f32_16x16x32_bf16 v[112:115], v[16:19], v[40:43], v[112:115]
    buffer_load_dwordx4 v56, s[44:47], s27 offen offset:0 lds
    v_mfma_f32_16x16x32_bf16 v[116:119], v[16:19], v[44:47], v[116:119]
    ds_read_b128 v[16:19], v2 offset:52736
    v_mfma_f32_16x16x32_bf16 v[120:123], v[20:23], v[40:43], v[120:123]
    v_mfma_f32_16x16x32_bf16 v[124:127], v[20:23], v[44:47], v[124:127]
    ds_read_b128 v[20:23], v2 offset:53760
    buffer_load_dwordx4 v57, s[44:47], s27 offen offset:1024 lds
    v_mfma_f32_16x16x32_bf16 v[128:131], v[24:27], v[40:43], v[128:131]
    v_mfma_f32_16x16x32_bf16 v[132:135], v[24:27], v[44:47], v[132:135]
    ds_read_b128 v[24:27], v2 offset:54784
    s_waitcnt lgkmcnt(7)
    v_mfma_f32_16x16x32_bf16 v[136:139], v[28:31], v[40:43], v[136:139]
    v_mfma_f32_16x16x32_bf16 v[140:143], v[28:31], v[44:47], v[140:143]
    ds_read_b128 v[28:31], v2 offset:55808
    ds_read_b32 v10, v1
    buffer_load_dwordx4 v58, s[44:47], s27 offen offset:2048 lds
    v_mfma_f32_16x16x32_bf16 v[144:147], v[32:35], v[40:43], v[144:147]
    v_mfma_f32_16x16x32_bf16 v[148:151], v[32:35], v[44:47], v[148:151]
    ds_read_b128 v[32:35], v2 offset:56832
    v_mfma_f32_16x16x32_bf16 v[152:155], v[36:39], v[40:43], v[152:155]
    buffer_load_dwordx4 v59, s[44:47], s27 offen offset:3072 lds
    s_add_u32 s27, s27, 128
    v_mfma_f32_16x16x32_bf16 v[156:159], v[36:39], v[44:47], v[156:159]
    ds_read_b128 v[36:39], v2 offset:57856
    s_setprio 2
    s_waitcnt vmcnt(8) lgkmcnt(2)
    v_readfirstlane_b32 s12, v10
    s_setprio 0
    s_cmp_ge_u32 s12, s33
    s_cbranch_scc0 g_ck31_s
g_ck31_b:
    v_mfma_f32_16x16x32_bf16 v[104:107], v[12:15], v[48:51], v[104:107]
    ds_read_b128 v[40:43], v62 offset:16384
    ds_read_b128 v[44:47], v62 offset:18432
    v_mfma_f32_16x16x32_bf16 v[108:111], v[12:15], v[52:55], v[108:111]
    ds_read_b128 v[12:15], v2 offset:0
    s_mov_b32 m0, s22
    v_mfma_f32_16x16x32_bf16 v[112:115], v[16:19], v[48:51], v[112:115]
    buffer_load_dwordx4 v4, s[36:39], s26 offen offset:0 sc1 lds
    v_mfma_f32_16x16x32_bf16 v[116:119], v[16:19], v[52:55], v[116:119]
    ds_read_b128 v[16:19], v2 offset:1024
    v_mfma_f32_16x16x32_bf16 v[120:123], v[20:23], v[48:51], v[120:123]
    v_mfma_f32_16x16x32_bf16 v[124:127], v[20:23], v[52:55], v[124:127]
    ds_read_b128 v[20:23], v2 offset:2048
    buffer_load_dwordx4 v4, s[36:39], s26 offen offset:1024 sc1 lds
    v_mfma_f32_16x16x32_bf16 v[128:131], v[24:27], v[48:51], v[128:131]
    v_mfma_f32_16x16x32_bf16 v[132:135], v[24:27], v[52:55], v[132:135]
    ds_read_b128 v[24:27], v2 offset:3072
    s_waitcnt lgkmcnt(6)
    v_mfma_f32_16x16x32_bf16 v[136:139], v[28:31], v[48:51], v[136:139]
    v_mfma_f32_16x16x32_bf16 v[140:143], v[28:31], v[52:55], v[140:143]
    ds_read_b128 v[28:31], v2 offset:4096
    buffer_load_dwordx4 v4, s[36:39], s26 offen offset:2048 sc1 lds
    v_mfma_f32_16x16x32_bf16 v[144:147], v[32:35], v[48:51], v[144:147]
    v_mfma_f32_16x16x32_bf16 v[148:151], v[32:35], v[52:55], v[148:151]
    ds_read_b128 v[32:35], v2 offset:5120
    v_mfma_f32_16x16x32_bf16 v[152:155], v[36:39], v[48:51], v[152:155]
    buffer_load_dwordx4 v4, s[36:39], s26 offen offset:3072 sc1 lds
    s_add_u32 s26, s26, 14336
    v_mfma_f32_16x16x32_bf16 v[156:159], v[36:39], v[52:55], v[156:159]
    ds_read_b128 v[36:39], v2 offset:6144
    s_waitcnt lgkmcnt(3)
    v_mfma_f32_16x16x32_bf16 v[104:107], v[12:15], v[40:43], v[104:107]
    s_waitcnt vmcnt(8)
    ds_add_u32 v1, v3
    ds_read_b128 v[48:51], v63 offset:16384
    ds_read_b128 v[52:55], v63 offset:18432
    v_mfma_f32_16x16x32_bf16 v[108:111], v[12:15], v[44:47], v[108:111]
    ds_read_b128 v[12:15], v2 offset:7168
    s_add_u32 s33, s33, 4
    s_add_u32 m0, s25, 0
    v_mfma_f32_16x16x32_bf16 v[112:115], v[16:19], v[40:43], v[112:115]
    buffer_load_dwordx4 v56, s[44:47], s27 offen offset:0 lds
    v_mfma_f32_16x16x32_bf16 v[116:119], v[16:19], v[44:47], v[116:119]
    ds_read_b128 v[16:19], v2 offset:8192
    v_mfma_f32_16x16x32_bf16 v[120:123], v[20:23], v[40:43], v[120:123]
    v_mfma_f32_16x16x32_bf16 v[124:127], v[20:23], v[44:47], v[124:127]
    ds_read_b128 v[20:23], v2 offset:9216
    buffer_load_dwordx4 v57, s[44:47], s27 offen offset:1024 lds
    v_mfma_f32_16x16x32_bf16 v[128:131], v[24:27], v[40:43], v[128:131]
    v_mfma_f32_16x16x32_bf16 v[132:135], v[24:27], v[44:47], v[132:135]
    ds_read_b128 v[24:27], v2 offset:10240
    s_waitcnt lgkmcnt(7)
    v_mfma_f32_16x16x32_bf16 v[136:139], v[28:31], v[40:43], v[136:139]
    v_mfma_f32_16x16x32_bf16 v[140:143], v[28:31], v[44:47], v[140:143]
    ds_read_b128 v[28:31], v2 offset:11264
    ds_read_b32 v10, v1
    buffer_load_dwordx4 v58, s[44:47], s27 offen offset:2048 lds
    v_mfma_f32_16x16x32_bf16 v[144:147], v[32:35], v[40:43], v[144:147]
    v_mfma_f32_16x16x32_bf16 v[148:151], v[32:35], v[44:47], v[148:151]
    ds_read_b128 v[32:35], v2 offset:12288
    v_mfma_f32_16x16x32_bf16 v[152:155], v[36:39], v[40:43], v[152:155]
    buffer_load_dwordx4 v59, s[44:47], s27 offen offset:3072 lds
    s_add_u32 s27, s27, 128
    v_mfma_f32_16x16x32_bf16 v[156:159], v[36:39], v[44:47], v[156:159]
    ds_read_b128 v[36:39], v2 offset:13312
    s_setprio 2
    s_waitcnt vmcnt(8) lgkmcnt(2)
    v_readfirstlane_b32 s12, v10
    s_setprio 0
    s_cmp_ge_u32 s12, s33
    s_cbranch_scc0 g_ck33_s
g_ck33_b:
    v_mfma_f32_16x16x32_bf16 v[104:107], v[12:15], v[48:51], v[104:107]
    ds_read_b128 v[40:43], v62 offset:32768
    ds_read_b128 v[44:47], v62 offset:34816
    v_mfma_f32_16x16x32_bf16 v[108:111], v[12:15], v[52:55], v[108:111]
    ds_read_b128 v[12:15], v2 offset:14848
    s_mov_b32 m0, s23
    v_mfma_f32_16x16x32_bf16 v[112:115], v[16:19], v[48:51], v[112:115]
    buffer_load_dwordx4 v4, s[36:39], s26 offen offset:0 sc1 lds
    v_mfma_f32_16x16x32_bf16 v[116:119], v[16:19], v[52:55], v[116:119]
    ds_read_b128 v[16:19], v2 offset:15872
    v_mfma_f32_16x16x32_bf16 v[120:123], v[20:23], v[48:51], v[120:123]
    v_mfma_f32_16x16x32_bf16 v[124:127], v[20:23], v[52:55], v[124:127]
    ds_read_b128 v[20:23], v2 offset:16896
    buffer_load_dwordx4 v4, s[36:39], s26 offen offset:1024 sc1 lds
    v_mfma_f32_16x16x32_bf16 v[128:131], v[24:27], v[48:51], v[128:131]
    v_mfma_f32_16x16x32_bf16 v[132:135], v[24:27], v[52:55], v[132:135]
    ds_read_b128 v[24:27], v2 offset:17920
    s_waitcnt lgkmcnt(6)
    v_mfma_f32_16x16x32_bf16 v[136:139], v[28:31], v[48:51], v[136:139]
    v_mfma_f32_16x16x32_bf16 v[140:143], v[28:31], v[52:55], v[140:143]
    ds_read_b128 v[28:31], v2 offset:18944
    buffer_load_dwordx4 v4, s[36:39], s26 offen offset:2048 sc1 lds
    v_mfma_f32_16x16x32_bf16 v[144:147], v[32:35], v[48:51], v[144:147]
    v_mfma_f32_16x16x32_bf16 v[148:151], v[32:35], v[52:55], v[148:151]
    ds_read_b128 v[32:35], v2 offset:19968
    v_mfma_f32_16x16x32_bf16 v[152:155], v[36:39], v[48:51], v[152:155]
    buffer_load_dwordx4 v4, s[36:39], s26 offen offset:3072 sc1 lds
    s_add_u32 s26, s26, 14336
    v_mfma_f32_16x16x32_bf16 v[156:159], v[36:39], v[52:55], v[156:159]
    ds_read_b128 v[36:39], v2 offset:20992
    s_waitcnt lgkmcnt(3)
    v_mfma_f32_16x16x32_bf16 v[104:107], v[12:15], v[40:43], v[104:107]
    s_waitcnt vmcnt(8)
    ds_add_u32 v1, v3
    ds_read_b128 v[48:51], v63 offset:32768
    ds_read_b128 v[52:55], v63 offset:34816
    v_mfma_f32_16x16x32_bf16 v[108:111], v[12:15], v[44:47], v[108:111]
    ds_read_b128 v[12:15], v2 offset:22016
    s_add_u32 s33, s33, 4
    s_add_u32 m0, s25, 16384
    v_mfma_f32_16x16x32_bf16 v[112:115], v[16:19], v[40:43], v[112:115]
    buffer_load_dwordx4 v56, s[44:47], s27 offen offset:0 lds
    v_mfma_f32_16x16x32_bf16 v[116:119], v[16:19], v[44:47], v[116:119]
    ds_read_b128 v[16:19], v2 offset:23040
    v_mfma_f32_16x16x32_bf16 v[120:123], v[20:23], v[40:43], v[120:123]
    v_mfma_f32_16x16x32_bf16 v[124:127], v[20:23], v[44:47], v[124:127]
    ds_read_b128 v[20:23], v2 offset:24064
    buffer_load_dwordx4 v57, s[44:47], s27 offen offset:1024 lds
    v_mfma_f32_16x16x32_bf16 v[128:131], v[24:27], v[40:43], v[128:131]
    v_mfma_f32_16x16x32_bf16 v[132:135], v[24:27], v[44:47], v[132:135]
    ds_read_b128 v[24:27], v2 offset:25088
    s_waitcnt lgkmcnt(7)
    v_mfma_f32_16x16x32_bf16 v[136:139], v[28:31], v[40:43], v[136:139]
    v_mfma_f32_16x16x32_bf16 v[140:143], v[28:31], v[44:47], v[140:143]
    ds_read_b128 v[28:31], v2 offset:26112
    ds_read_b32 v10, v1
    buffer_load_dwordx4 v58, s[44:47], s27 offen offset:2048 lds
    v_mfma_f32_16x16x32_bf16 v[144:147], v[32:35], v[40:43], v[144:147]
    v_mfma_f32_16x16x32_bf16 v[148:151], v[32:35], v[44:47], v[148:151]
    ds_read_b128 v[32:35], v2 offset:27136
    v_mfma_f32_16x16x32_bf16 v[152:155], v[36:39], v[40:43], v[152:155]
    buffer_load_dwordx4 v59, s[44:47], s27 offen offset:3072 lds
    s_add_u32 s27, s27, 128
    v_mfma_f32_16x16x32_bf16 v[156:159], v[36:39], v[44:47], v[156:159]
    ds_read_b128 v[36:39], v2 offset:28160
    s_setprio 2
    s_waitcnt vmcnt(8) lgkmcnt(2)
    v_readfirstlane_b32 s12, v10
    s_setprio 0
    s_cmp_ge_u32 s12, s33
    s_cbranch_scc0 g_ck35_s
g_ck35_b:
    v_mfma_f32_16x16x32_bf16 v[104:107], v[12:15], v[48:51], v[104:107]
    ds_read_b128 v[40:43], v62 offset:0
    ds_read_b128 v[44:47], v62 offset:2048
    v_mfma_f32_16x16x32_bf16 v[108:111], v[12:15], v[52:55], v[108:111]
    ds_read_b128 v[12:15], v2 offset:29696
    s_mov_b32 m0, s20
    v_mfma_f32_16x16x32_bf16 v[112:115], v[16:19], v[48:51], v[112:115]
    buffer_load_dwordx4 v4, s[36:39], s26 offen offset:0 sc1 lds
    v_mfma_f32_16x16x32_bf16 v[116:119], v[16:19], v[52:55], v[116:119]
    ds_read_b128 v[16:19], v2 offset:30720
    v_mfma_f32_16x16x32_bf16 v[120:123], v[20:23], v[48:51], v[120:123]
    v_mfma_f32_16x16x32_bf16 v[124:127], v[20:23], v[52:55], v[124:127]
    ds_read_b128 v[20:23], v2 offset:31744
    buffer_load_dwordx4 v4, s[36:39], s26 offen offset:1024 sc1 lds
    v_mfma_f32_16x16x32_bf16 v[128:131], v[24:27], v[48:51], v[128:131]
    v_mfma_f32_16x16x32_bf16 v[132:135], v[24:27], v[52:55], v[132:135]
    ds_read_b128 v[24:27], v2 offset:32768
    s_waitcnt lgkmcnt(6)
    v_mfma_f32_16x16x32_bf16 v[136:139], v[28:31], v[48:51], v[136:139]
    v_mfma_f32_16x16x32_bf16 v[140:143], v[28:31], v[52:55], v[140:143]
    ds_read_b128 v[28:31], v2 offset:33792
    buffer_load_dwordx4 v4, s[36:39], s26 offen offset:2048 sc1 lds
    v_mfma_f32_16x16x32_bf16 v[144:147], v[32:35], v[48:51], v[144:147]
    v_mfma_f32_16x16x32_bf16 v[148:151], v[32:35], v[52:55], v[148:151]
    ds_read_b128 v[32:35], v2 offset:34816
    v_mfma_f32_16x16x32_bf16 v[152:155], v[36:39], v[48:51], v[152:155]
    buffer_load_dwordx4 v4, s[36:39], s26 offen offset:3072 sc1 lds
    s_add_u32 s26, s26, 14336
    v_mfma_f32_16x16x32_bf16 v[156:159], v[36:39], v[52:55], v[156:159]
    ds_read_b128 v[36:39], v2 offset:35840
    s_waitcnt lgkmcnt(3)
    v_mfma_f32_16x16x32_bf16 v[104:107], v[12:15], v[40:43], v[104:107]
    s_waitcnt vmcnt(8)
    ds_add_u32 v1, v3
    ds_read_b128 v[48:51], v63 offset:0
    ds_read_b128 v[52:55], v63 offset:2048
    v_mfma_f32_16x16x32_bf16 v[108:111], v[12:15], v[44:47], v[108:111]
    ds_read_b128 v[12:15], v2 offset:36864
    s_add_u32 s33, s33, 4
    s_bitcmp1_b32 0x6, s10
    s_cbranch_scc1 g_z112_r
g_z112_b:
    s_add_u32 m0, s25, 32768
    v_mfma_f32_16x16x32_bf16 v[112:115], v[16:19], v[40:43], v[112:115]
    buffer_load_dwordx4 v56, s[44:47], s27 offen offset:0 lds
    v_mfma_f32_16x16x32_bf16 v[116:119], v[16:19], v[44:47], v[116:119]
    ds_read_b128 v[16:19], v2 offset:37888
    v_mfma_f32_16x16x32_bf16 v[120:123], v[20:23], v[40:43], v[120:123]
    v_mfma_f32_16x16x32_bf16 v[124:127], v[20:23], v[44:47], v[124:127]
    ds_read_b128 v[20:23], v2 offset:38912
    buffer_load_dwordx4 v57, s[44:47], s27 offen offset:1024 lds
    v_mfma_f32_16x16x32_bf16 v[128:131], v[24:27], v[40:43], v[128:131]
    v_mfma_f32_16x16x32_bf16 v[132:135], v[24:27], v[44:47], v[132:135]
    ds_read_b128 v[24:27], v2 offset:39936
    s_waitcnt lgkmcnt(7)
    v_mfma_f32_16x16x32_bf16 v[136:139], v[28:31], v[40:43], v[136:139]
    v_mfma_f32_16x16x32_bf16 v[140:143], v[28:31], v[44:47], v[140:143]
    ds_read_b128 v[28:31], v2 offset:40960
    ds_read_b32 v10, v1
    buffer_load_dwordx4 v58, s[44:47], s27 offen offset:2048 lds
    v_mfma_f32_16x16x32_bf16 v[144:147], v[32:35], v[40:43], v[144:147]
    v_mfma_f32_16x16x32_bf16 v[148:151], v[32:35], v[44:47], v[148:151]
    ds_read_b128 v[32:35], v2 offset:41984
    v_mfma_f32_16x16x32_bf16 v[152:155], v[36:39], v[40:43], v[152:155]
    buffer_load_dwordx4 v59, s[44:47], s27 offen offset:3072 lds
    s_add_u32 s27, s27, 128
    v_mfma_f32_16x16x32_bf16 v[156:159], v[36:39], v[44:47], v[156:159]
    ds_read_b128 v[36:39], v2 offset:43008
    s_setprio 2
    s_waitcnt vmcnt(8) lgkmcnt(2)
    v_readfirstlane_b32 s12, v10
    s_setprio 0
    s_cmp_ge_u32 s12, s33
    s_cbranch_scc0 g_ck37_s
g_ck37_b:
    v_mfma_f32_16x16x32_bf16 v[104:107], v[12:15], v[48:51], v[104:107]
    ds_read_b128 v[40:43], v62 offset:16384
    ds_read_b128 v[44:47], v62 offset:18432
    v_mfma_f32_16x16x32_bf16 v[108:111], v[12:15], v[52:55], v[108:111]
    ds_read_b128 v[12:15], v2 offset:44544
    s_mov_b32 m0, s21
    v_mfma_f32_16x16x32_bf16 v[112:115], v[16:19], v[48:51], v[112:115]
    buffer_load_dwordx4 v4, s[36:39], s26 offen offset:0 sc1 lds
    v_mfma_f32_16x16x32_bf16 v[116:119], v[16:19], v[52:55], v[116:119]
    ds_read_b128 v[16:19], v2 offset:45568
    v_mfma_f32_16x16x32_bf16 v[120:123], v[20:23], v[48:51], v[120:123]
    v_mfma_f32_16x16x32_bf16 v[124:127], v[20:23], v[52:55], v[124:127]
    ds_read_b128 v[20:23], v2 offset:46592
    buffer_load_dwordx4 v4, s[36:39], s26 offen offset:1024 sc1 lds
    v_mfma_f32_16x16x32_bf16 v[128:131], v[24:27], v[48:51], v[128:131]
    v_mfma_f32_16x16x32_bf16 v[132:135], v[24:27], v[52:55], v[132:135]
    ds_read_b128 v[24:27], v2 offset:47616
    s_waitcnt lgkmcnt(6)
    v_mfma_f32_16x16x32_bf16 v[136:139], v[28:31], v[48:51], v[136:139]
    v_mfma_f32_16x16x32_bf16 v[140:143], v[28:31], v[52:55], v[140:143]
    ds_read_b128 v[28:31], v2 offset:48640
    buffer_load_dwordx4 v4, s[36:39], s26 offen offset:2048 sc1 lds
    v_mfma_f32_16x16x32_bf16 v[144:147], v[32:35], v[48:51], v[144:147]
    v_mfma_f32_16x16x32_bf16 v[148:151], v[32:35], v[52:55], v[148:151]
    ds_read_b128 v[32:35], v2 offset:49664
    v_mfma_f32_16x16x32_bf16 v[152:155], v[36:39], v[48:51], v[152:155]
    buffer_load_dwordx4 v4, s[36:39], s26 offen offset:3072 sc1 lds
    s_add_u32 s26, s26, 14336
    v_mfma_f32_16x16x32_bf16 v[156:159], v[36:39], v[52:55], v[156:159]
    ds_read_b128 v[36:39], v2 offset:50688
    s_waitcnt lgkmcnt(3)
    v_mfma_f32_16x16x32_bf16 v[104:107], v[12:15], v[40:43], v[104:107]
    s_waitcnt vmcnt(8)
    ds_add_u32 v1, v3
    ds_read_b128 v[48:51], v63 offset:16384
    ds_read_b128 v[52:55], v63 offset:18432
    v_mfma_f32_16x16x32_bf16 v[108:111], v[12:15], v[44:47], v[108:111]
    ds_read_b128 v[12:15], v2 offset:51712
    s_add_u32 s33, s33, 4
    s_add_u32 m0, s25, 0
    v_mfma_f32_16x16x32_bf16 v[112:115], v[16:19], v[40:43], v[112:115]
    buffer_load_dwordx4 v56, s[44:47], s27 offen offset:0 lds
    v_mfma_f32_16x16x32_bf16 v[116:119], v[16:19], v[44:47], v[116:119]
    ds_read_b128 v[16:19], v2 offset:52736
    v_mfma_f32_16x16x32_bf16 v[120:123], v[20:23], v[40:43], v[120:123]
    v_mfma_f32_16x16x32_bf16 v[124:127], v[20:23], v[44:47], v[124:127]
    ds_read_b128 v[20:23], v2 offset:53760
    buffer_load_dwordx4 v57, s[44:47], s27 offen offset:1024 lds
    v_mfma_f32_16x16x32_bf16 v[128:131], v[24:27], v[40:43], v[128:131]
    v_mfma_f32_16x16x32_bf16 v[132:135], v[24:27], v[44:47], v[132:135]
    ds_read_b128 v[24:27], v2 offset:54784
    s_waitcnt lgkmcnt(7)
    v_mfma_f32_16x16x32_bf16 v[136:139], v[28:31], v[40:43], v[136:139]
    v_mfma_f32_16x16x32_bf16 v[140:143], v[28:31], v[44:47], v[140:143]
    ds_read_b128 v[28:31], v2 offset:55808
    ds_read_b32 v10, v1
    buffer_load_dwordx4 v58, s[44:47], s27 offen offset:2048 lds
    v_mfma_f32_16x16x32_bf16 v[144:147], v[32:35], v[40:43], v[144:147]
    v_mfma_f32_16x16x32_bf16 v[148:151], v[32:35], v[44:47], v[148:151]
    ds_read_b128 v[32:35], v2 offset:56832
    v_mfma_f32_16x16x32_bf16 v[152:155], v[36:39], v[40:43], v[152:155]
    buffer_load_dwordx4 v59, s[44:47], s27 offen offset:3072 lds
    s_add_u32 s27, s27, 128
    v_mfma_f32_16x16x32_bf16 v[156:159], v[36:39], v[44:47], v[156:159]
    ds_read_b128 v[36:39], v2 offset:57856
    s_setprio 2
    s_waitcnt vmcnt(8) lgkmcnt(2)
    v_readfirstlane_b32 s12, v10
    s_setprio 0
    s_cmp_ge_u32 s12, s33
    s_cbranch_scc0 g_ck39_s
g_ck39_b:
    v_mfma_f32_16x16x32_bf16 v[104:107], v[12:15], v[48:51], v[104:107]
    ds_read_b128 v[40:43], v62 offset:32768
    ds_read_b128 v[44:47], v62 offset:34816
    v_mfma_f32_16x16x32_bf16 v[108:111], v[12:15], v[52:55], v[108:111]
    ds_read_b128 v[12:15], v2 offset:0
    s_mov_b32 m0, s22
    v_mfma_f32_16x16x32_bf16 v[112:115], v[16:19], v[48:51], v[112:115]
    buffer_load_dwordx4 v4, s[36:39], s26 offen offset:0 sc1 lds
    v_mfma_f32_16x16x32_bf16 v[116:119], v[16:19], v[52:55], v[116:119]
    ds_read_b128 v[16:19], v2 offset:1024
    v_mfma_f32_16x16x32_bf16 v[120:123], v[20:23], v[48:51], v[120:123]
    v_mfma_f32_16x16x32_bf16 v[124:127], v[20:23], v[52:55], v[124:127]
    ds_read_b128 v[20:23], v2 offset:2048
    buffer_load_dwordx4 v4, s[36:39], s26 offen offset:1024 sc1 lds
    v_mfma_f32_16x16x32_bf16 v[128:131], v[24:27], v[48:51], v[128:131]
    v_mfma_f32_16x16x32_bf16 v[132:135], v[24:27], v[52:55], v[132:135]
    ds_read_b128 v[24:27], v2 offset:3072
    s_waitcnt lgkmcnt(6)
    v_mfma_f32_16x16x32_bf16 v[136:139], v[28:31], v[48:51], v[136:139]
    v_mfma_f32_16x16x32_bf16 v[140:143], v[28:31], v[52:55], v[140:143]
    ds_read_b128 v[28:31], v2 offset:4096
    buffer_load_dwordx4 v4, s[36:39], s26 offen offset:2048 sc1 lds
    v_mfma_f32_16x16x32_bf16 v[144:147], v[32:35], v[48:51], v[144:147]
    v_mfma_f32_16x16x32_bf16 v[148:151], v[32:35], v[52:55], v[148:151]
    ds_read_b128 v[32:35], v2 offset:5120
    v_mfma_f32_16x16x32_bf16 v[152:155], v[36:39], v[48:51], v[152:155]
    buffer_load_dwordx4 v4, s[36:39], s26 offen offset:3072 sc1 lds
    s_add_u32 s26, s26, 14336
    v_mfma_f32_16x16x32_bf16 v[156:159], v[36:39], v[52:55], v[156:159]
    ds_read_b128 v[36:39], v2 offset:6144
    s_waitcnt lgkmcnt(3)
    v_mfma_f32_16x16x32_bf16 v[104:107], v[12:15], v[40:43], v[104:107]
    s_waitcnt vmcnt(8)
    ds_add_u32 v1, v3
    ds_read_b128 v[48:51], v63 offset:32768
    ds_read_b128 v[52:55], v63 offset:34816
    v_mfma_f32_16x16x32_bf16 v[108:111], v[12:15], v[44:47], v[108:111]
    ds_read_b128 v[12:15], v2 offset:7168
    s_add_u32 s33, s33, 4
    s_add_u32 m0, s25, 16384
    v_mfma_f32_16x16x32_bf16 v[112:115], v[16:19], v[40:43], v[112:115]
    buffer_load_dwordx4 v56, s[44:47], s27 offen offset:0 lds
    v_mfma_f32_16x16x32_bf16 v[116:119], v[16:19], v[44:47], v[116:119]
    ds_read_b128 v[16:19], v2 offset:8192
    v_mfma_f32_16x16x32_bf16 v[120:123], v[20:23], v[40:43], v[120:123]
    v_mfma_f32_16x16x32_bf16 v[124:127], v[20:23], v[44:47], v[124:127]
    ds_read_b128 v[20:23], v2 offset:9216
    buffer_load_dwordx4 v57, s[44:47], s27 offen offset:1024 lds
    v_mfma_f32_16x16x32_bf16 v[128:131], v[24:27], v[40:43], v[128:131]
    v_mfma_f32_16x16x32_bf16 v[132:135], v[24:27], v[44:47], v[132:135]
    ds_read_b128 v[24:27], v2 offset:10240
    s_waitcnt lgkmcnt(7)
    v_mfma_f32_16x16x32_bf16 v[136:139], v[28:31], v[40:43], v[136:139]
    v_mfma_f32_16x16x32_bf16 v[140:143], v[28:31], v[44:47], v[140:143]
    ds_read_b128 v[28:31], v2 offset:11264
    ds_read_b32 v10, v1
    buffer_load_dwordx4 v58, s[44:47], s27 offen offset:2048 lds
    v_mfma_f32_16x16x32_bf16 v[144:147], v[32:35], v[40:43], v[144:147]
    v_mfma_f32_16x16x32_bf16 v[148:151], v[32:35], v[44:47], v[148:151]
    ds_read_b128 v[32:35], v2 offset:12288
    v_mfma_f32_16x16x32_bf16 v[152:155], v[36:39], v[40:43], v[152:155]
    buffer_load_dwordx4 v59, s[44:47], s27 offen offset:3072 lds
    s_add_u32 s27, s27, 128
    v_mfma_f32_16x16x32_bf16 v[156:159], v[36:39], v[44:47], v[156:159]
    ds_read_b128 v[36:39], v2 offset:13312
    s_setprio 2
    s_waitcnt vmcnt(8) lgkmcnt(2)
    v_readfirstlane_b32 s12, v10
    s_setprio 0
    s_cmp_ge_u32 s12, s33
    s_cbranch_scc0 g_ck41_s
g_ck41_b:
    v_mfma_f32_16x16x32_bf16 v[104:107], v[12:15], v[48:51], v[104:107]
    ds_read_b128 v[40:43], v62 offset:0
    ds_read_b128 v[44:47], v62 offset:2048
    v_mfma_f32_16x16x32_bf16 v[108:111], v[12:15], v[52:55], v[108:111]
    ds_read_b128 v[12:15], v2 offset:14848
    s_mov_b32 m0, s23
    v_mfma_f32_16x16x32_bf16 v[112:115], v[16:19], v[48:51], v[112:115]
    buffer_load_dwordx4 v4, s[36:39], s26 offen offset:0 sc1 lds
    v_mfma_f32_16x16x32_bf16 v[116:119], v[16:19], v[52:55], v[116:119]
    ds_read_b128 v[16:19], v2 offset:15872
    v_mfma_f32_16x16x32_bf16 v[120:123], v[20:23], v[48:51], v[120:123]
    v_mfma_f32_16x16x32_bf16 v[124:127], v[20:23], v[52:55], v[124:127]
    ds_read_b128 v[20:23], v2 offset:16896
    buffer_load_dwordx4 v4, s[36:39], s26 offen offset:1024 sc1 lds
    v_mfma_f32_16x16x32_bf16 v[128:131], v[24:27], v[48:51], v[128:131]
    v_mfma_f32_16x16x32_bf16 v[132:135], v[24:27], v[52:55], v[132:135]
    ds_read_b128 v[24:27], v2 offset:17920
    s_waitcnt lgkmcnt(6)
    v_mfma_f32_16x16x32_bf16 v[136:139], v[28:31], v[48:51], v[136:139]
    v_mfma_f32_16x16x32_bf16 v[140:143], v[28:31], v[52:55], v[140:143]
    ds_read_b128 v[28:31], v2 offset:18944
    buffer_load_dwordx4 v4, s[36:39], s26 offen offset:2048 sc1 lds
    v_mfma_f32_16x16x32_bf16 v[144:147], v[32:35], v[48:51], v[144:147]
    v_mfma_f32_16x16x32_bf16 v[148:151], v[32:35], v[52:55], v[148:151]
    ds_read_b128 v[32:35], v2 offset:19968
    v_mfma_f32_16x16x32_bf16 v[152:155], v[36:39], v[48:51], v[152:155]
    buffer_load_dwordx4 v4, s[36:39], s26 offen offset:3072 sc1 lds
    s_add_u32 s26, s26, 14336
    v_mfma_f32_16x16x32_bf16 v[156:159], v[36:39], v[52:55], v[156:159]
    ds_read_b128 v[36:39], v2 offset:20992
    s_waitcnt lgkmcnt(3)
    v_mfma_f32_16x16x32_bf16 v[104:107], v[12:15], v[40:43], v[104:107]
    s_waitcnt vmcnt(8)
    ds_add_u32 v1, v3
    ds_read_b128 v[48:51], v63 offset:0
    ds_read_b128 v[52:55], v63 offset:2048
    v_mfma_f32_16x16x32_bf16 v[108:111], v[12:15], v[44:47], v[108:111]
    ds_read_b128 v[12:15], v2 offset:22016
    s_add_u32 s33, s33, 4
    s_bitcmp1_b32 0x4, s10
    s_cbranch_scc1 g_z118_r
g_z118_b:
    s_add_u32 m0, s25, 32768
    v_mfma_f32_16x16x32_bf16 v[112:115], v[16:19], v[40:43], v[112:115]
    buffer_load_dwordx4 v56, s[44:47], s27 offen offset:0 lds
    v_mfma_f32_16x16x32_bf16 v[116:119], v[16:19], v[44:47], v[116:119]
    ds_read_b128 v[16:19], v2 offset:23040
    v_mfma_f32_16x16x32_bf16 v[120:123], v[20:23], v[40:43], v[120:123]
    v_mfma_f32_16x16x32_bf16 v[124:127], v[20:23], v[44:47], v[124:127]
    ds_read_b128 v[20:23], v2 offset:24064
    buffer_load_dwordx4 v57, s[44:47], s27 offen offset:1024 lds
    v_mfma_f32_16x16x32_bf16 v[128:131], v[24:27], v[40:43], v[128:131]
    v_mfma_f32_16x16x32_bf16 v[132:135], v[24:27], v[44:47], v[132:135]
    ds_read_b128 v[24:27], v2 offset:25088
    s_waitcnt lgkmcnt(7)
    v_mfma_f32_16x16x32_bf16 v[136:139], v[28:31], v[40:43], v[136:139]
    v_mfma_f32_16x16x32_bf16 v[140:143], v[28:31], v[44:47], v[140:143]
    ds_read_b128 v[28:31], v2 offset:26112
    ds_read_b32 v10, v1
    buffer_load_dwordx4 v58, s[44:47], s27 offen offset:2048 lds
    v_mfma_f32_16x16x32_bf16 v[144:147], v[32:35], v[40:43], v[144:147]
    v_mfma_f32_16x16x32_bf16 v[148:151], v[32:35], v[44:47], v[148:151]
    ds_read_b128 v[32:35], v2 offset:27136
    v_mfma_f32_16x16x32_bf16 v[152:155], v[36:39], v[40:43], v[152:155]
    buffer_load_dwordx4 v59, s[44:47], s27 offen offset:3072 lds
    s_add_u32 s27, s27, 128
    v_mfma_f32_16x16x32_bf16 v[156:159], v[36:39], v[44:47], v[156:159]
    ds_read_b128 v[36:39], v2 offset:28160
    s_setprio 2
    s_waitcnt vmcnt(8) lgkmcnt(2)
    v_readfirstlane_b32 s12, v10
    s_setprio 0
    s_cmp_ge_u32 s12, s33
    s_cbranch_scc0 g_ck43_s
g_ck43_b:
    v_mfma_f32_16x16x32_bf16 v[104:107], v[12:15], v[48:51], v[104:107]
    ds_read_b128 v[40:43], v62 offset:16384
    ds_read_b128 v[44:47], v62 offset:18432
    v_mfma_f32_16x16x32_bf16 v[108:111], v[12:15], v[52:55], v[108:111]
    ds_read_b128 v[12:15], v2 offset:29696
    s_mov_b32 m0, s20
    v_mfma_f32_16x16x32_bf16 v[112:115], v[16:19], v[48:51], v[112:115]
    buffer_load_dwordx4 v4, s[36:39], s26 offen offset:0 sc1 lds
    v_mfma_f32_16x16x32_bf16 v[116:119], v[16:19], v[52:55], v[116:119]
    ds_read_b128 v[16:19], v2 offset:30720
    v_mfma_f32_16x16x32_bf16 v[120:123], v[20:23], v[48:51], v[120:123]
    v_mfma_f32_16x16x32_bf16 v[124:127], v[20:23], v[52:55], v[124:127]
    ds_read_b128 v[20:23], v2 offset:31744
    buffer_load_dwordx4 v4, s[36:39], s26 offen offset:1024 sc1 lds
    v_mfma_f32_16x16x32_bf16 v[128:131], v[24:27], v[48:51], v[128:131]
    v_mfma_f32_16x16x32_bf16 v[132:135], v[24:27], v[52:55], v[132:135]
    ds_read_b128 v[24:27], v2 offset:32768
    s_waitcnt lgkmcnt(6)
    v_mfma_f32_16x16x32_bf16 v[136:139], v[28:31], v[48:51], v[136:139]
    v_mfma_f32_16x16x32_bf16 v[140:143], v[28:31], v[52:55], v[140:143]
    ds_read_b128 v[28:31], v2 offset:33792
    buffer_load_dwordx4 v4, s[36:39], s26 offen offset:2048 sc1 lds
    v_mfma_f32_16x16x32_bf16 v[144:147], v[32:35], v[48:51], v[144:147]
    v_mfma_f32_16x16x32_bf16 v[148:151], v[32:35], v[52:55], v[148:151]
    ds_read_b128 v[32:35], v2 offset:34816
    v_mfma_f32_16x16x32_bf16 v[152:155], v[36:39], v[48:51], v[152:155]
    buffer_load_dwordx4 v4, s[36:39], s26 offen offset:3072 sc1 lds
    s_add_u32 s26, s26, 14336
    v_mfma_f32_16x16x32_bf16 v[156:159], v[36:39], v[52:55], v[156:159]
    ds_read_b128 v[36:39], v2 offset:35840
    s_waitcnt lgkmcnt(3)
    v_mfma_f32_16x16x32_bf16 v[104:107], v[12:15], v[40:43], v[104:107]
    s_waitcnt vmcnt(8)
    ds_add_u32 v1, v3
    ds_read_b128 v[48:51], v63 offset:16384
    ds_read_b128 v[52:55], v63 offset:18432
    v_mfma_f32_16x16x32_bf16 v[108:111], v[12:15], v[44:47], v[108:111]
    ds_read_b128 v[12:15], v2 offset:36864
    s_add_u32 s33, s33, 4
    s_add_u32 m0, s25, 0
    v_mfma_f32_16x16x32_bf16 v[112:115], v[16:19], v[40:43], v[112:115]
    buffer_load_dwordx4 v56, s[44:47], s27 offen offset:0 lds
    v_mfma_f32_16x16x32_bf16 v[116:119], v[16:19], v[44:47], v[116:119]
    ds_read_b128 v[16:19], v2 offset:37888
    v_mfma_f32_16x16x32_bf16 v[120:123], v[20:23], v[40:43], v[120:123]
    v_mfma_f32_16x16x32_bf16 v[124:127], v[20:23], v[44:47], v[124:127]
    ds_read_b128 v[20:23], v2 offset:38912
    buffer_load_dwordx4 v57, s[44:47], s27 offen offset:1024 lds
    v_mfma_f32_16x16x32_bf16 v[128:131], v[24:27], v[40:43], v[128:131]
    v_mfma_f32_16x16x32_bf16 v[132:135], v[24:27], v[44:47], v[132:135]
    ds_read_b128 v[24:27], v2 offset:39936
    s_waitcnt lgkmcnt(7)
    v_mfma_f32_16x16x32_bf16 v[136:139], v[28:31], v[40:43], v[136:139]
    v_mfma_f32_16x16x32_bf16 v[140:143], v[28:31], v[44:47], v[140:143]
    ds_read_b128 v[28:31], v2 offset:40960
    ds_read_b32 v10, v1
    buffer_load_dwordx4 v58, s[44:47], s27 offen offset:2048 lds
    v_mfma_f32_16x16x32_bf16 v[144:147], v[32:35], v[40:43], v[144:147]
    v_mfma_f32_16x16x32_bf16 v[148:151], v[32:35], v[44:47], v[148:151]
    ds_read_b128 v[32:35], v2 offset:41984
    v_mfma_f32_16x16x32_bf16 v[152:155], v[36:39], v[40:43], v[152:155]
    buffer_load_dwordx4 v59, s[44:47], s27 offen offset:3072 lds
    s_add_u32 s27, s27, 128
    v_mfma_f32_16x16x32_bf16 v[156:159], v[36:39], v[44:47], v[156:159]
    ds_read_b128 v[36:39], v2 offset:43008
    s_setprio 2
    s_waitcnt vmcnt(8) lgkmcnt(2)
    v_readfirstlane_b32 s12, v10
    s_setprio 0
    s_cmp_ge_u32 s12, s33
    s_cbranch_scc0 g_ck45_s
g_ck45_b:
    v_mfma_f32_16x16x32_bf16 v[104:107], v[12:15], v[48:51], v[104:107]
    ds_read_b128 v[40:43], v62 offset:32768
    ds_read_b128 v[44:47], v62 offset:34816
    v_mfma_f32_16x16x32_bf16 v[108:111], v[12:15], v[52:55], v[108:111]
    ds_read_b128 v[12:15], v2 offset:44544
    s_mov_b32 m0, s21
    v_mfma_f32_16x16x32_bf16 v[112:115], v[16:19], v[48:51], v[112:115]
    buffer_load_dwordx4 v4, s[36:39], s26 offen offset:0 sc1 lds
    v_mfma_f32_16x16x32_bf16 v[116:119], v[16:19], v[52:55], v[116:119]
    ds_read_b128 v[16:19], v2 offset:45568
    v_mfma_f32_16x16x32_bf16 v[120:123], v[20:23], v[48:51], v[120:123]
    v_mfma_f32_16x16x32_bf16 v[124:127], v[20:23], v[52:55], v[124:127]
    ds_read_b128 v[20:23], v2 offset:46592
    buffer_load_dwordx4 v4, s[36:39], s26 offen offset:1024 sc1 lds
    v_mfma_f32_16x16x32_bf16 v[128:131], v[24:27], v[48:51], v[128:131]
    v_mfma_f32_16x16x32_bf16 v[132:135], v[24:27], v[52:55], v[132:135]
    ds_read_b128 v[24:27], v2 offset:47616
    s_waitcnt lgkmcnt(6)
    v_mfma_f32_16x16x32_bf16 v[136:139], v[28:31], v[48:51], v[136:139]
    v_mfma_f32_16x16x32_bf16 v[140:143], v[28:31], v[52:55], v[140:143]
    ds_read_b128 v[28:31], v2 offset:48640
    buffer_load_dwordx4 v4, s[36:39], s26 offen offset:2048 sc1 lds
    v_mfma_f32_16x16x32_bf16 v[144:147], v[32:35], v[48:51], v[144:147]
    v_mfma_f32_16x16x32_bf16 v[148:151], v[32:35], v[52:55], v[148:151]
    ds_read_b128 v[32:35], v2 offset:49664
    v_mfma_f32_16x16x32_bf16 v[152:155], v[36:39], v[48:51], v[152:155]
    buffer_load_dwordx4 v4, s[36:39], s26 offen offset:3072 sc1 lds
    s_add_u32 s26, s26, 14336
    v_mfma_f32_16x16x32_bf16 v[156:159], v[36:39], v[52:55], v[156:159]
    ds_read_b128 v[36:39], v2 offset:50688
    s_waitcnt lgkmcnt(3)
    v_mfma_f32_16x16x32_bf16 v[104:107], v[12:15], v[40:43], v[104:107]
    s_waitcnt vmcnt(8)
    ds_add_u32 v1, v3
    ds_read_b128 v[48:51], v63 offset:32768
    ds_read_b128 v[52:55], v63 offset:34816
    v_mfma_f32_16x16x32_bf16 v[108:111], v[12:15], v[44:47], v[108:111]
    ds_read_b128 v[12:15], v2 offset:51712
    s_add_u32 s33, s33, 4
    s_add_u32 m0, s25, 16384
    v_mfma_f32_16x16x32_bf16 v[112:115], v[16:19], v[40:43], v[112:115]
    buffer_load_dwordx4 v56, s[44:47], s27 offen offset:0 lds
    v_mfma_f32_16x16x32_bf16 v[116:119], v[16:19], v[44:47], v[116:119]
    ds_read_b128 v[16:19], v2 offset:52736
    v_mfma_f32_16x16x32_bf16 v[120:123], v[20:23], v[40:43], v[120:123]
    v_mfma_f32_16x16x32_bf16 v[124:127], v[20:23], v[44:47], v[124:127]
    ds_read_b128 v[20:23], v2 offset:53760
    buffer_load_dwordx4 v57, s[44:47], s27 offen offset:1024 lds
    v_mfma_f32_16x16x32_bf16 v[128:131], v[24:27], v[40:43], v[128:131]
    v_mfma_f32_16x16x32_bf16 v[132:135], v[24:27], v[44:47], v[132:135]
    ds_read_b128 v[24:27], v2 offset:54784
    s_waitcnt lgkmcnt(7)
    v_mfma_f32_16x16x32_bf16 v[136:139], v[28:31], v[40:43], v[136:139]
    v_mfma_f32_16x16x32_bf16 v[140:143], v[28:31], v[44:47], v[140:143]
    ds_read_b128 v[28:31], v2 offset:55808
    ds_read_b32 v10, v1
    buffer_load_dwordx4 v58, s[44:47], s27 offen offset:2048 lds
    v_mfma_f32_16x16x32_bf16 v[144:147], v[32:35], v[40:43], v[144:147]
    v_mfma_f32_16x16x32_bf16 v[148:151], v[32:35], v[44:47], v[148:151]
    ds_read_b128 v[32:35], v2 offset:56832
    v_mfma_f32_16x16x32_bf16 v[152:155], v[36:39], v[40:43], v[152:155]
    buffer_load_dwordx4 v59, s[44:47], s27 offen offset:3072 lds
    s_add_u32 s27, s27, 128
    v_mfma_f32_16x16x32_bf16 v[156:159], v[36:39], v[44:47], v[156:159]
    ds_read_b128 v[36:39], v2 offset:57856
    s_setprio 2
    s_waitcnt vmcnt(8) lgkmcnt(2)
    v_readfirstlane_b32 s12, v10
    s_setprio 0
    s_cmp_ge_u32 s12, s33
    s_cbranch_scc0 g_ck47_s
g_ck47_b:
    v_mfma_f32_16x16x32_bf16 v[104:107], v[12:15], v[48:51], v[104:107]
    ds_read_b128 v[40:43], v62 offset:0
    ds_read_b128 v[44:47], v62 offset:2048
    v_mfma_f32_16x16x32_bf16 v[108:111], v[12:15], v[52:55], v[108:111]
    ds_read_b128 v[12:15], v2 offset:0
    s_mov_b32 m0, s22
    v_mfma_f32_16x16x32_bf16 v[112:115], v[16:19], v[48:51], v[112:115]
    buffer_load_dwordx4 v4, s[36:39], s26 offen offset:0 sc1 lds
    v_mfma_f32_16x16x32_bf16 v[116:119], v[16:19], v[52:55], v[116:119]
    ds_read_b128 v[16:19], v2 offset:1024
    v_mfma_f32_16x16x32_bf16 v[120:123], v[20:23], v[48:51], v[120:123]
    v_mfma_f32_16x16x32_bf16 v[124:127], v[20:23], v[52:55], v[124:127]
    ds_read_b128 v[20:23], v2 offset:2048
    buffer_load_dwordx4 v4, s[36:39], s26 offen offset:1024 sc1 lds
    v_mfma_f32_16x16x32_bf16 v[128:131], v[24:27], v[48:51], v[128:131]
    v_mfma_f32_16x16x32_bf16 v[132:135], v[24:27], v[52:55], v[132:135]
    ds_read_b128 v[24:27], v2 offset:3072
    s_waitcnt lgkmcnt(6)
    v_mfma_f32_16x16x32_bf16 v[136:139], v[28:31], v[48:51], v[136:139]
    v_mfma_f32_16x16x32_bf16 v[140:143], v[28:31], v[52:55], v[140:143]
    ds_read_b128 v[28:31], v2 offset:4096
    buffer_load_dwordx4 v4, s[36:39], s26 offen offset:2048 sc1 lds
    v_mfma_f32_16x16x32_bf16 v[144:147], v[32:35], v[48:51], v[144:147]
    v_mfma_f32_16x16x32_bf16 v[148:151], v[32:35], v[52:55], v[148:151]
    ds_read_b128 v[32:35], v2 offset:5120
    v_mfma_f32_16x16x32_bf16 v[152:155], v[36:39], v[48:51], v[152:155]
    buffer_load_dwordx4 v4, s[36:39], s26 offen offset:3072 sc1 lds
    s_add_u32 s26, s26, 14336
    v_mfma_f32_16x16x32_bf16 v[156:159], v[36:39], v[52:55], v[156:159]
    ds_read_b128 v[36:39], v2 offset:6144
    s_sub_u32 s28, s28, 1
    s_cmp_lg_u32 s28, 0
    s_cbranch_scc1 p2_gloop
    s_waitcnt lgkmcnt(3)
    v_mfma_f32_16x16x32_bf16 v[104:107], v[12:15], v[40:43], v[104:107]
    s_waitcnt vmcnt(8)
    ds_add_u32 v1, v3
    ds_read_b128 v[48:51], v63 offset:0
    ds_read_b128 v[52:55], v63 offset:2048
    v_mfma_f32_16x16x32_bf16 v[108:111], v[12:15], v[44:47], v[108:111]
    ds_read_b128 v[12:15], v2 offset:7168
    s_add_u32 s33, s33, 4
    s_add_u32 m0, s25, 32768
    v_mfma_f32_16x16x32_bf16 v[112:115], v[16:19], v[40:43], v[112:115]
    buffer_load_dwordx4 v56, s[44:47], s27 offen offset:0 lds
    v_mfma_f32_16x16x32_bf16 v[116:119], v[16:19], v[44:47], v[116:119]
    ds_read_b128 v[16:19], v2 offset:8192
    v_mfma_f32_16x16x32_bf16 v[120:123], v[20:23], v[40:43], v[120:123]
    v_mfma_f32_16x16x32_bf16 v[124:127], v[20:23], v[44:47], v[124:127]
    ds_read_b128 v[20:23], v2 offset:9216
    buffer_load_dwordx4 v57, s[44:47], s27 offen offset:1024 lds
    v_mfma_f32_16x16x32_bf16 v[128:131], v[24:27], v[40:43], v[128:131]
    v_mfma_f32_16x16x32_bf16 v[132:135], v[24:27], v[44:47], v[132:135]
    ds_read_b128 v[24:27], v2 offset:10240
    s_waitcnt lgkmcnt(7)
    v_mfma_f32_16x16x32_bf16 v[136:139], v[28:31], v[40:43], v[136:139]
    v_mfma_f32_16x16x32_bf16 v[140:143], v[28:31], v[44:47], v[140:143]
    ds_read_b128 v[28:31], v2 offset:11264
    ds_read_b32 v10, v1
    buffer_load_dwordx4 v58, s[44:47], s27 offen offset:2048 lds
    v_mfma_f32_16x16x32_bf16 v[144:147], v[32:35], v[40:43], v[144:147]
    v_mfma_f32_16x16x32_bf16 v[148:151], v[32:35], v[44:47], v[148:151]
    ds_read_b128 v[32:35], v2 offset:12288
    v_mfma_f32_16x16x32_bf16 v[152:155], v[36:39], v[40:43], v[152:155]
    buffer_load_dwordx4 v59, s[44:47], s27 offen offset:3072 lds
    s_add_u32 s27, s27, 128
    v_mfma_f32_16x16x32_bf16 v[156:159], v[36:39], v[44:47], v[156:159]
    ds_read_b128 v[36:39], v2 offset:13312
    s_setprio 2
    s_waitcnt vmcnt(8) lgkmcnt(2)
    v_readfirstlane_b32 s12, v10
    s_setprio 0
    s_cmp_ge_u32 s12, s33
    s_cbranch_scc0 g_ck49_s
g_ck49_b:
    v_mfma_f32_16x16x32_bf16 v[104:107], v[12:15], v[48:51], v[104:107]
    ds_read_b128 v[40:43], v62 offset:16384
    ds_read_b128 v[44:47], v62 offset:18432
    v_mfma_f32_16x16x32_bf16 v[108:111], v[12:15], v[52:55], v[108:111]
    ds_read_b128 v[12:15], v2 offset:14848
    s_mov_b32 m0, s23
    v_mfma_f32_16x16x32_bf16 v[112:115], v[16:19], v[48:51], v[112:115]
    buffer_load_dwordx4 v4, s[36:39], s26 offen offset:0 sc1 lds
    v_mfma_f32_16x16x32_bf16 v[116:119], v[16:19], v[52:55], v[116:119]
    ds_read_b128 v[16:19], v2 offset:15872
    v_mfma_f32_16x16x32_bf16 v[120:123], v[20:23], v[48:51], v[120:123]
    v_mfma_f32_16x16x32_bf16 v[124:127], v[20:23], v[52:55], v[124:127]
    ds_read_b128 v[20:23], v2 offset:16896
    buffer_load_dwordx4 v4, s[36:39], s26 offen offset:1024 sc1 lds
    v_mfma_f32_16x16x32_bf16 v[128:131], v[24:27], v[48:51], v[128:131]
    v_mfma_f32_16x16x32_bf16 v[132:135], v[24:27], v[52:55], v[132:135]
    ds_read_b128 v[24:27], v2 offset:17920
    s_waitcnt lgkmcnt(6)
    v_mfma_f32_16x16x32_bf16 v[136:139], v[28:31], v[48:51], v[136:139]
    v_mfma_f32_16x16x32_bf16 v[140:143], v[28:31], v[52:55], v[140:143]
    ds_read_b128 v[28:31], v2 offset:18944
    buffer_load_dwordx4 v4, s[36:39], s26 offen offset:2048 sc1 lds
    v_mfma_f32_16x16x32_bf16 v[144:147], v[32:35], v[48:51], v[144:147]
    v_mfma_f32_16x16x32_bf16 v[148:151], v[32:35], v[52:55], v[148:151]
    ds_read_b128 v[32:35], v2 offset:19968
    v_mfma_f32_16x16x32_bf16 v[152:155], v[36:39], v[48:51], v[152:155]
    buffer_load_dwordx4 v4, s[36:39], s26 offen offset:3072 sc1 lds
    s_add_u32 s26, s26, 14336
    v_mfma_f32_16x16x32_bf16 v[156:159], v[36:39], v[52:55], v[156:159]
    ds_read_b128 v[36:39], v2 offset:20992
    s_waitcnt lgkmcnt(3)
    v_mfma_f32_16x16x32_bf16 v[104:107], v[12:15], v[40:43], v[104:107]
    s_waitcnt vmcnt(8)
    ds_add_u32 v1, v3
    ds_read_b128 v[48:51], v63 offset:16384
    ds_read_b128 v[52:55], v63 offset:18432
    v_mfma_f32_16x16x32_bf16 v[108:111], v[12:15], v[44:47], v[108:111]
    ds_read_b128 v[12:15], v2 offset:22016
    s_add_u32 s33, s33, 4
    s_add_u32 m0, s25, 0
    v_mfma_f32_16x16x32_bf16 v[112:115], v[16:19], v[40:43], v[112:115]
    buffer_load_dwordx4 v56, s[44:47], s27 offen offset:0 lds
    v_mfma_f32_16x16x32_bf16 v[116:119], v[16:19], v[44:47], v[116:119]
    ds_read_b128 v[16:19], v2 offset:23040
    v_mfma_f32_16x16x32_bf16 v[120:123], v[20:23], v[40:43], v[120:123]
    v_mfma_f32_16x16x32_bf16 v[124:127], v[20:23], v[44:47], v[124:127]
    ds_read_b128 v[20:23], v2 offset:24064
    buffer_load_dwordx4 v57, s[44:47], s27 offen offset:1024 lds
    v_mfma_f32_16x16x32_bf16 v[128:131], v[24:27], v[40:43], v[128:131]
    v_mfma_f32_16x16x32_bf16 v[132:135], v[24:27], v[44:47], v[132:135]
    ds_read_b128 v[24:27], v2 offset:25088
    s_waitcnt lgkmcnt(7)
    v_mfma_f32_16x16x32_bf16 v[136:139], v[28:31], v[40:43], v[136:139]
    v_mfma_f32_16x16x32_bf16 v[140:143], v[28:31], v[44:47], v[140:143]
    ds_read_b128 v[28:31], v2 offset:26112
    ds_read_b32 v10, v1
    buffer_load_dwordx4 v58, s[44:47], s27 offen offset:2048 lds
    v_mfma_f32_16x16x32_bf16 v[144:147], v[32:35], v[40:43], v[144:147]
    v_mfma_f32_16x16x32_bf16 v[148:151], v[32:35], v[44:47], v[148:151]
    ds_read_b128 v[32:35], v2 offset:27136
    v_mfma_f32_16x16x32_bf16 v[152:155], v[36:39], v[40:43], v[152:155]
    buffer_load_dwordx4 v59, s[44:47], s27 offen offset:3072 lds
    s_add_u32 s27, s27, 128
    v_mfma_f32_16x16x32_bf16 v[156:159], v[36:39], v[44:47], v[156:159]
    ds_read_b128 v[36:39], v2 offset:28160
    s_setprio 2
    s_waitcnt vmcnt(8) lgkmcnt(2)
    v_readfirstlane_b32 s12, v10
    s_setprio 0
    s_cmp_ge_u32 s12, s33
    s_cbranch_scc0 g_ck51_s
g_ck51_b:
    v_mfma_f32_16x16x32_bf16 v[104:107], v[12:15], v[48:51], v[104:107]
    ds_read_b128 v[40:43], v62 offset:32768
    ds_read_b128 v[44:47], v62 offset:34816
    v_mfma_f32_16x16x32_bf16 v[108:111], v[12:15], v[52:55], v[108:111]
    ds_read_b128 v[12:15], v2 offset:29696
    s_mov_b32 m0, s20
    v_mfma_f32_16x16x32_bf16 v[112:115], v[16:19], v[48:51], v[112:115]
    buffer_load_dwordx4 v4, s[36:39], s26 offen offset:0 sc1 lds
    v_mfma_f32_16x16x32_bf16 v[116:119], v[16:19], v[52:55], v[116:119]
    ds_read_b128 v[16:19], v2 offset:30720
    v_mfma_f32_16x16x32_bf16 v[120:123], v[20:23], v[48:51], v[120:123]
    v_mfma_f32_16x16x32_bf16 v[124:127], v[20:23], v[52:55], v[124:127]
    ds_read_b128 v[20:23], v2 offset:31744
    buffer_load_dwordx4 v4, s[36:39], s26 offen offset:1024 sc1 lds
    v_mfma_f32_16x16x32_bf16 v[128:131], v[24:27], v[48:51], v[128:131]
    v_mfma_f32_16x16x32_bf16 v[132:135], v[24:27], v[52:55], v[132:135]
    ds_read_b128 v[24:27], v2 offset:32768
    s_waitcnt lgkmcnt(6)
    v_mfma_f32_16x16x32_bf16 v[136:139], v[28:31], v[48:51], v[136:139]
    v_mfma_f32_16x16x32_bf16 v[140:143], v[28:31], v[52:55], v[140:143]
    ds_read_b128 v[28:31], v2 offset:33792
    buffer_load_dwordx4 v4, s[36:39], s26 offen offset:2048 sc1 lds
    v_mfma_f32_16x16x32_bf16 v[144:147], v[32:35], v[48:51], v[144:147]
    v_mfma_f32_16x16x32_bf16 v[148:151], v[32:35], v[52:55], v[148:151]
    ds_read_b128 v[32:35], v2 offset:34816
    v_mfma_f32_16x16x32_bf16 v[152:155], v[36:39], v[48:51], v[152:155]
    buffer_load_dwordx4 v4, s[36:39], s26 offen offset:3072 sc1 lds
    s_add_u32 s26, s26, 14336
    v_mfma_f32_16x16x32_bf16 v[156:159], v[36:39], v[52:55], v[156:159]
    ds_read_b128 v[36:39], v2 offset:35840
    s_waitcnt lgkmcnt(3)
    v_mfma_f32_16x16x32_bf16 v[104:107], v[12:15], v[40:43], v[104:107]
    s_waitcnt vmcnt(8)
    ds_add_u32 v1, v3
    ds_read_b128 v[48:51], v63 offset:32768
    ds_read_b128 v[52:55], v63 offset:34816
    v_mfma_f32_16x16x32_bf16 v[108:111], v[12:15], v[44:47], v[108:111]
    ds_read_b128 v[12:15], v2 offset:36864
    s_add_u32 s33, s33, 4
    s_add_u32 m0, s25, 16384
    v_mfma_f32_16x16x32_bf16 v[112:115], v[16:19], v[40:43], v[112:115]
    buffer_load_dwordx4 v56, s[44:47], s27 offen offset:0 lds
    v_mfma_f32_16x16x32_bf16 v[116:119], v[16:19], v[44:47], v[116:119]
    ds_read_b128 v[16:19], v2 offset:37888
    v_mfma_f32_16x16x32_bf16 v[120:123], v[20:23], v[40:43], v[120:123]
    v_mfma_f32_16x16x32_bf16 v[124:127], v[20:23], v[44:47], v[124:127]
    ds_read_b128 v[20:23], v2 offset:38912
    buffer_load_dwordx4 v57, s[44:47], s27 offen offset:1024 lds
    v_mfma_f32_16x16x32_bf16 v[128:131], v[24:27], v[40:43], v[128:131]
    v_mfma_f32_16x16x32_bf16 v[132:135], v[24:27], v[44:47], v[132:135]
    ds_read_b128 v[24:27], v2 offset:39936
    s_waitcnt lgkmcnt(7)
    v_mfma_f32_16x16x32_bf16 v[136:139], v[28:31], v[40:43], v[136:139]
    v_mfma_f32_16x16x32_bf16 v[140:143], v[28:31], v[44:47], v[140:143]
    ds_read_b128 v[28:31], v2 offset:40960
    ds_read_b32 v10, v1
    buffer_load_dwordx4 v58, s[44:47], s27 offen offset:2048 lds
    v_mfma_f32_16x16x32_bf16 v[144:147], v[32:35], v[40:43], v[144:147]
    v_mfma_f32_16x16x32_bf16 v[148:151], v[32:35], v[44:47], v[148:151]
    ds_read_b128 v[32:35], v2 offset:41984
    v_mfma_f32_16x16x32_bf16 v[152:155], v[36:39], v[40:43], v[152:155]
    buffer_load_dwordx4 v59, s[44:47], s27 offen offset:3072 lds
    s_add_u32 s27, s27, 128
    v_mfma_f32_16x16x32_bf16 v[156:159], v[36:39], v[44:47], v[156:159]
    ds_read_b128 v[36:39], v2 offset:43008
    s_setprio 2
    s_waitcnt vmcnt(8) lgkmcnt(2)
    v_readfirstlane_b32 s12, v10
    s_setprio 0
    s_cmp_ge_u32 s12, s33
    s_cbranch_scc0 g_ck53_s
g_ck53_b:
    v_mfma_f32_16x16x32_bf16 v[104:107], v[12:15], v[48:51], v[104:107]
    ds_read_b128 v[40:43], v62 offset:0
    ds_read_b128 v[44:47], v62 offset:2048
    v_mfma_f32_16x16x32_bf16 v[108:111], v[12:15], v[52:55], v[108:111]
    ds_read_b128 v[12:15], v2 offset:44544
    s_mov_b32 m0, s21
    v_mfma_f32_16x16x32_bf16 v[112:115], v[16:19], v[48:51], v[112:115]
    buffer_load_dwordx4 v4, s[36:39], s26 offen offset:0 sc1 lds
    v_mfma_f32_16x16x32_bf16 v[116:119], v[16:19], v[52:55], v[116:119]
    ds_read_b128 v[16:19], v2 offset:45568
    v_mfma_f32_16x16x32_bf16 v[120:123], v[20:23], v[48:51], v[120:123]
    v_mfma_f32_16x16x32_bf16 v[124:127], v[20:23], v[52:55], v[124:127]
    ds_read_b128 v[20:23], v2 offset:46592
    buffer_load_dwordx4 v4, s[36:39], s26 offen offset:1024 sc1 lds
    v_mfma_f32_16x16x32_bf16 v[128:131], v[24:27], v[48:51], v[128:131]
    v_mfma_f32_16x16x32_bf16 v[132:135], v[24:27], v[52:55], v[132:135]
    ds_read_b128 v[24:27], v2 offset:47616
    s_waitcnt lgkmcnt(6)
    v_mfma_f32_16x16x32_bf16 v[136:139], v[28:31], v[48:51], v[136:139]
    v_mfma_f32_16x16x32_bf16 v[140:143], v[28:31], v[52:55], v[140:143]
    ds_read_b128 v[28:31], v2 offset:48640
    buffer_load_dwordx4 v4, s[36:39], s26 offen offset:2048 sc1 lds
    v_mfma_f32_16x16x32_bf16 v[144:147], v[32:35], v[48:51], v[144:147]
    v_mfma_f32_16x16x32_bf16 v[148:151], v[32:35], v[52:55], v[148:151]
    ds_read_b128 v[32:35], v2 offset:49664
    v_mfma_f32_16x16x32_bf16 v[152:155], v[36:39], v[48:51], v[152:155]
    buffer_load_dwordx4 v4, s[36:39], s26 offen offset:3072 sc1 lds
    s_add_u32 s26, s26, 14336
    v_mfma_f32_16x16x32_bf16 v[156:159], v[36:39], v[52:55], v[156:159]
    ds_read_b128 v[36:39], v2 offset:50688
    s_waitcnt lgkmcnt(3)
    v_mfma_f32_16x16x32_bf16 v[104:107], v[12:15], v[40:43], v[104:107]
    s_waitcnt vmcnt(8)
    ds_add_u32 v1, v3
    ds_read_b128 v[48:51], v63 offset:0
    ds_read_b128 v[52:55], v63 offset:2048
    v_mfma_f32_16x16x32_bf16 v[108:111], v[12:15], v[44:47], v[108:111]
    ds_read_b128 v[12:15], v2 offset:51712
    s_add_u32 s33, s33, 4
    s_add_u32 m0, s25, 32768
    v_mfma_f32_16x16x32_bf16 v[112:115], v[16:19], v[40:43], v[112:115]
    buffer_load_dwordx4 v56, s[44:47], s27 offen offset:0 lds
    v_mfma_f32_16x16x32_bf16 v[116:119], v[16:19], v[44:47], v[116:119]
    ds_read_b128 v[16:19], v2 offset:52736
    v_mfma_f32_16x16x32_bf16 v[120:123], v[20:23], v[40:43], v[120:123]
    v_mfma_f32_16x16x32_bf16 v[124:127], v[20:23], v[44:47], v[124:127]
    ds_read_b128 v[20:23], v2 offset:53760
    buffer_load_dwordx4 v57, s[44:47], s27 offen offset:1024 lds
    v_mfma_f32_16x16x32_bf16 v[128:131], v[24:27], v[40:43], v[128:131]
    v_mfma_f32_16x16x32_bf16 v[132:135], v[24:27], v[44:47], v[132:135]
    ds_read_b128 v[24:27], v2 offset:54784
    s_waitcnt lgkmcnt(7)
    v_mfma_f32_16x16x32_bf16 v[136:139], v[28:31], v[40:43], v[136:139]
    v_mfma_f32_16x16x32_bf16 v[140:143], v[28:31], v[44:47], v[140:143]
    ds_read_b128 v[28:31], v2 offset:55808
    ds_read_b32 v10, v1
    buffer_load_dwordx4 v58, s[44:47], s27 offen offset:2048 lds
    v_mfma_f32_16x16x32_bf16 v[144:147], v[32:35], v[40:43], v[144:147]
    v_mfma_f32_16x16x32_bf16 v[148:151], v[32:35], v[44:47], v[148:151]
    ds_read_b128 v[32:35], v2 offset:56832
    v_mfma_f32_16x16x32_bf16 v[152:155], v[36:39], v[40:43], v[152:155]
    buffer_load_dwordx4 v59, s[44:47], s27 offen offset:3072 lds
    s_add_u32 s27, s27, 128
    v_mfma_f32_16x16x32_bf16 v[156:159], v[36:39], v[44:47], v[156:159]
    ds_read_b128 v[36:39], v2 offset:57856
    s_setprio 2
    s_waitcnt vmcnt(8) lgkmcnt(2)
    v_readfirstlane_b32 s12, v10
    s_setprio 0
    s_cmp_ge_u32 s12, s33
    s_cbranch_scc0 g_ck55_s
g_ck55_b:
    v_mfma_f32_16x16x32_bf16 v[104:107], v[12:15], v[48:51], v[104:107]
    ds_read_b128 v[40:43], v62 offset:16384
    ds_read_b128 v[44:47], v62 offset:18432
    v_mfma_f32_16x16x32_bf16 v[108:111], v[12:15], v[52:55], v[108:111]
    ds_read_b128 v[12:15], v2 offset:0
    s_mov_b32 m0, s22
    v_mfma_f32_16x16x32_bf16 v[112:115], v[16:19], v[48:51], v[112:115]
    buffer_load_dwordx4 v4, s[36:39], s26 offen offset:0 sc1 lds
    v_mfma_f32_16x16x32_bf16 v[116:119], v[16:19], v[52:55], v[116:119]
    ds_read_b128 v[16:19], v2 offset:1024
    v_mfma_f32_16x16x32_bf16 v[120:123], v[20:23], v[48:51], v[120:123]
    v_mfma_f32_16x16x32_bf16 v[124:127], v[20:23], v[52:55], v[124:127]
    ds_read_b128 v[20:23], v2 offset:2048
    buffer_load_dwordx4 v4, s[36:39], s26 offen offset:1024 sc1 lds
    v_mfma_f32_16x16x32_bf16 v[128:131], v[24:27], v[48:51], v[128:131]
    v_mfma_f32_16x16x32_bf16 v[132:135], v[24:27], v[52:55], v[132:135]
    ds_read_b128 v[24:27], v2 offset:3072
    s_waitcnt lgkmcnt(6)
    v_mfma_f32_16x16x32_bf16 v[136:139], v[28:31], v[48:51], v[136:139]
    v_mfma_f32_16x16x32_bf16 v[140:143], v[28:31], v[52:55], v[140:143]
    ds_read_b128 v[28:31], v2 offset:4096
    buffer_load_dwordx4 v4, s[36:39], s26 offen offset:2048 sc1 lds
    v_mfma_f32_16x16x32_bf16 v[144:147], v[32:35], v[48:51], v[144:147]
    v_mfma_f32_16x16x32_bf16 v[148:151], v[32:35], v[52:55], v[148:151]
    ds_read_b128 v[32:35], v2 offset:5120
    v_mfma_f32_16x16x32_bf16 v[152:155], v[36:39], v[48:51], v[152:155]
    buffer_load_dwordx4 v4, s[36:39], s26 offen offset:3072 sc1 lds
    s_add_u32 s26, s26, 14336
    v_mfma_f32_16x16x32_bf16 v[156:159], v[36:39], v[52:55], v[156:159]
    ds_read_b128 v[36:39], v2 offset:6144
    s_waitcnt lgkmcnt(3)
    v_mfma_f32_16x16x32_bf16 v[104:107], v[12:15], v[40:43], v[104:107]
    s_waitcnt vmcnt(8)
    ds_add_u32 v1, v3
    ds_read_b128 v[48:51], v63 offset:16384
    ds_read_b128 v[52:55], v63 offset:18432
    v_mfma_f32_16x16x32_bf16 v[108:111], v[12:15], v[44:47], v[108:111]
    ds_read_b128 v[12:15], v2 offset:7168
    s_add_u32 s33, s33, 4
    s_add_u32 m0, s25, 0
    v_mfma_f32_16x16x32_bf16 v[112:115], v[16:19], v[40:43], v[112:115]
    buffer_load_dwordx4 v56, s[44:47], s27 offen offset:0 lds
    v_mfma_f32_16x16x32_bf16 v[116:119], v[16:19], v[44:47], v[116:119]
    ds_read_b128 v[16:19], v2 offset:8192
    v_mfma_f32_16x16x32_bf16 v[120:123], v[20:23], v[40:43], v[120:123]
    v_mfma_f32_16x16x32_bf16 v[124:127], v[20:23], v[44:47], v[124:127]
    ds_read_b128 v[20:23], v2 offset:9216
    buffer_load_dwordx4 v57, s[44:47], s27 offen offset:1024 lds
    v_mfma_f32_16x16x32_bf16 v[128:131], v[24:27], v[40:43], v[128:131]
    v_mfma_f32_16x16x32_bf16 v[132:135], v[24:27], v[44:47], v[132:135]
    ds_read_b128 v[24:27], v2 offset:10240
    s_waitcnt lgkmcnt(7)
    v_mfma_f32_16x16x32_bf16 v[136:139], v[28:31], v[40:43], v[136:139]
    v_mfma_f32_16x16x32_bf16 v[140:143], v[28:31], v[44:47], v[140:143]
    ds_read_b128 v[28:31], v2 offset:11264
    ds_read_b32 v10, v1
    buffer_load_dwordx4 v58, s[44:47], s27 offen offset:2048 lds
    v_mfma_f32_16x16x32_bf16 v[144:147], v[32:35], v[40:43], v[144:147]
    v_mfma_f32_16x16x32_bf16 v[148:151], v[32:35], v[44:47], v[148:151]
    ds_read_b128 v[32:35], v2 offset:12288
    v_mfma_f32_16x16x32_bf16 v[152:155], v[36:39], v[40:43], v[152:155]
    buffer_load_dwordx4 v59, s[44:47], s27 offen offset:3072 lds
    s_add_u32 s27, s27, 128
    v_mfma_f32_16x16x32_bf16 v[156:159], v[36:39], v[44:47], v[156:159]
    ds_read_b128 v[36:39], v2 offset:13312
    s_setprio 2
    s_waitcnt vmcnt(8) lgkmcnt(2)
    v_readfirstlane_b32 s12, v10
    s_setprio 0
    s_cmp_ge_u32 s12, s33
    s_cbranch_scc0 g_ck57_s
g_ck57_b:
    v_mfma_f32_16x16x32_bf16 v[104:107], v[12:15], v[48:51], v[104:107]
    ds_read_b128 v[40:43], v62 offset:32768
    ds_read_b128 v[44:47], v62 offset:34816
    v_mfma_f32_16x16x32_bf16 v[108:111], v[12:15], v[52:55], v[108:111]
    ds_read_b128 v[12:15], v2 offset:14848
    s_mov_b32 m0, s23
    v_mfma_f32_16x16x32_bf16 v[112:115], v[16:19], v[48:51], v[112:115]
    buffer_load_dwordx4 v4, s[36:39], s26 offen offset:0 sc1 lds
    v_mfma_f32_16x16x32_bf16 v[116:119], v[16:19], v[52:55], v[116:119]
    ds_read_b128 v[16:19], v2 offset:15872
    v_mfma_f32_16x16x32_bf16 v[120:123], v[20:23], v[48:51], v[120:123]
    v_mfma_f32_16x16x32_bf16 v[124:127], v[20:23], v[52:55], v[124:127]
    ds_read_b128 v[20:23], v2 offset:16896
    buffer_load_dwordx4 v4, s[36:39], s26 offen offset:1024 sc1 lds
    v_mfma_f32_16x16x32_bf16 v[128:131], v[24:27], v[48:51], v[128:131]
    v_mfma_f32_16x16x32_bf16 v[132:135], v[24:27], v[52:55], v[132:135]
    ds_read_b128 v[24:27], v2 offset:17920
    s_waitcnt lgkmcnt(6)
    v_mfma_f32_16x16x32_bf16 v[136:139], v[28:31], v[48:51], v[136:139]
    v_mfma_f32_16x16x32_bf16 v[140:143], v[28:31], v[52:55], v[140:143]
    ds_read_b128 v[28:31], v2 offset:18944
    buffer_load_dwordx4 v4, s[36:39], s26 offen offset:2048 sc1 lds
    v_mfma_f32_16x16x32_bf16 v[144:147], v[32:35], v[48:51], v[144:147]
    v_mfma_f32_16x16x32_bf16 v[148:151], v[32:35], v[52:55], v[148:151]
    ds_read_b128 v[32:35], v2 offset:19968
    v_mfma_f32_16x16x32_bf16 v[152:155], v[36:39], v[48:51], v[152:155]
    buffer_load_dwordx4 v4, s[36:39], s26 offen offset:3072 sc1 lds
    s_add_u32 s26, s26, 14336
    v_mfma_f32_16x16x32_bf16 v[156:159], v[36:39], v[52:55], v[156:159]
    ds_read_b128 v[36:39], v2 offset:20992
    s_waitcnt lgkmcnt(3)
    v_mfma_f32_16x16x32_bf16 v[104:107], v[12:15], v[40:43], v[104:107]
    s_waitcnt vmcnt(8)
    ds_add_u32 v1, v3
    ds_read_b128 v[48:51], v63 offset:32768
    ds_read_b128 v[52:55], v63 offset:34816
    v_mfma_f32_16x16x32_bf16 v[108:111], v[12:15], v[44:47], v[108:111]
    ds_read_b128 v[12:15], v2 offset:22016
    s_add_u32 s33, s33, 4
    s_add_u32 m0, s25, 16384
    v_mfma_f32_16x16x32_bf16 v[112:115], v[16:19], v[40:43], v[112:115]
    buffer_load_dwordx4 v56, s[44:47], s27 offen offset:0 lds
    v_mfma_f32_16x16x32_bf16 v[116:119], v[16:19], v[44:47], v[116:119]
    ds_read_b128 v[16:19], v2 offset:23040
    v_mfma_f32_16x16x32_bf16 v[120:123], v[20:23], v[40:43], v[120:123]
    buffer_load_dwordx4 v57, s[44:47], s27 offen offset:1024 lds
    v_mfma_f32_16x16x32_bf16 v[124:127], v[20:23], v[44:47], v[124:127]
    ds_read_b128 v[20:23], v2 offset:24064
    v_mfma_f32_16x16x32_bf16 v[128:131], v[24:27], v[40:43], v[128:131]
    v_mfma_f32_16x16x32_bf16 v[132:135], v[24:27], v[44:47], v[132:135]
    ds_read_b128 v[24:27], v2 offset:25088
    buffer_load_dwordx4 v58, s[44:47], s27 offen offset:2048 lds
    s_waitcnt lgkmcnt(7)
    v_mfma_f32_16x16x32_bf16 v[136:139], v[28:31], v[40:43], v[136:139]
    v_mfma_f32_16x16x32_bf16 v[140:143], v[28:31], v[44:47], v[140:143]
    ds_read_b128 v[28:31], v2 offset:26112
    ds_read_b32 v10, v1
    v_mfma_f32_16x16x32_bf16 v[144:147], v[32:35], v[40:43], v[144:147]
    buffer_load_dwordx4 v59, s[44:47], s27 offen offset:3072 lds
    s_add_u32 s27, s27, 128
    v_mfma_f32_16x16x32_bf16 v[148:151], v[32:35], v[44:47], v[148:151]
    ds_read_b128 v[32:35], v2 offset:27136
    v_mfma_f32_16x16x32_bf16 v[152:155], v[36:39], v[40:43], v[152:155]
    buffer_load_dword v167, v11, s[36:39], s29 offen sc0 sc1
    v_mfma_f32_16x16x32_bf16 v[156:159], v[36:39], v[44:47], v[156:159]
    ds_read_b128 v[36:39], v2 offset:28160
    s_setprio 2
    s_waitcnt vmcnt(9) lgkmcnt(2)
    v_readfirstlane_b32 s12, v10
    s_setprio 0
    s_cmp_ge_u32 s12, s33
    s_cbranch_scc0 g_ck59_s
g_ck59_b:
    v_mfma_f32_16x16x32_bf16 v[104:107], v[12:15], v[48:51], v[104:107]
    ds_read_b128 v[40:43], v62 offset:0
    ds_read_b128 v[44:47], v62 offset:2048
    v_mfma_f32_16x16x32_bf16 v[108:111], v[12:15], v[52:55], v[108:111]
    ds_read_b128 v[12:15], v2 offset:29696
    v_mfma_f32_16x16x32_bf16 v[112:115], v[16:19], v[48:51], v[112:115]
    v_mfma_f32_16x16x32_bf16 v[116:119], v[16:19], v[52:55], v[116:119]
    ds_read_b128 v[16:19], v2 offset:30720
    v_mfma_f32_16x16x32_bf16 v[120:123], v[20:23], v[48:51], v[120:123]
    v_mfma_f32_16x16x32_bf16 v[124:127], v[20:23], v[52:55], v[124:127]
    ds_read_b128 v[20:23], v2 offset:31744
    v_mfma_f32_16x16x32_bf16 v[128:131], v[24:27], v[48:51], v[128:131]
    v_mfma_f32_16x16x32_bf16 v[132:135], v[24:27], v[52:55], v[132:135]
    ds_read_b128 v[24:27], v2 offset:32768
    s_waitcnt lgkmcnt(6)
    v_mfma_f32_16x16x32_bf16 v[136:139], v[28:31], v[48:51], v[136:139]
    v_mfma_f32_16x16x32_bf16 v[140:143], v[28:31], v[52:55], v[140:143]
    ds_read_b128 v[28:31], v2 offset:33792
    v_mfma_f32_16x16x32_bf16 v[144:147], v[32:35], v[48:51], v[144:147]
    v_mfma_f32_16x16x32_bf16 v[148:151], v[32:35], v[52:55], v[148:151]
    ds_read_b128 v[32:35], v2 offset:34816
    v_mfma_f32_16x16x32_bf16 v[152:155], v[36:39], v[48:51], v[152:155]
    v_mfma_f32_16x16x32_bf16 v[156:159], v[36:39], v[52:55], v[156:159]
    ds_read_b128 v[36:39], v2 offset:35840
    s_waitcnt lgkmcnt(3)
    v_mfma_f32_16x16x32_bf16 v[104:107], v[12:15], v[40:43], v[104:107]
    s_waitcnt vmcnt(0)
    ds_add_u32 v1, v3
    ds_read_b128 v[48:51], v63 offset:0
    ds_read_b128 v[52:55], v63 offset:2048
    v_mfma_f32_16x16x32_bf16 v[108:111], v[12:15], v[44:47], v[108:111]
    ds_read_b128 v[12:15], v2 offset:36864
    s_add_u32 s33, s33, 4
    v_cmp_ne_u32 vcc, s4, v167
    s_nop 4
    s_cbranch_vccnz g_fy_s
g_fy_b:
    v_mfma_f32_16x16x32_bf16 v[112:115], v[16:19], v[40:43], v[112:115]
    buffer_load_dwordx4 v[168:171], v5, s[36:39], s34 offen offset:0 sc1
    v_mfma_f32_16x16x32_bf16 v[116:119], v[16:19], v[44:47], v[116:119]
    ds_read_b128 v[16:19], v2 offset:37888
    v_mfma_f32_16x16x32_bf16 v[120:123], v[20:23], v[40:43], v[120:123]
    v_mfma_f32_16x16x32_bf16 v[124:127], v[20:23], v[44:47], v[124:127]
    ds_read_b128 v[20:23], v2 offset:38912
    buffer_load_dwordx4 v[172:175], v5, s[36:39], s34 offen offset:1024 sc1
    v_mfma_f32_16x16x32_bf16 v[128:131], v[24:27], v[40:43], v[128:131]
    v_mfma_f32_16x16x32_bf16 v[132:135], v[24:27], v[44:47], v[132:135]
    ds_read_b128 v[24:27], v2 offset:39936
    s_waitcnt lgkmcnt(7)
    v_mfma_f32_16x16x32_bf16 v[136:139], v[28:31], v[40:43], v[136:139]
    v_mfma_f32_16x16x32_bf16 v[140:143], v[28:31], v[44:47], v[140:143]
    ds_read_b128 v[28:31], v2 offset:40960
    ds_read_b32 v10, v1
    buffer_load_dwordx4 v[176:179], v5, s[36:39], s34 offen offset:2048 sc1
    v_mfma_f32_16x16x32_bf16 v[144:147], v[32:35], v[40:43], v[144:147]
    v_mfma_f32_16x16x32_bf16 v[148:151], v[32:35], v[44:47], v[148:151]
    ds_read_b128 v[32:35], v2 offset:41984
    v_mfma_f32_16x16x32_bf16 v[152:155], v[36:39], v[40:43], v[152:155]
    buffer_load_dwordx2 v[180:181], v8, s[36:39], s34 offen offset:3072 sc1
    v_mfma_f32_16x16x32_bf16 v[156:159], v[36:39], v[44:47], v[156:159]
    ds_read_b128 v[36:39], v2 offset:43008
    s_setprio 2
    s_waitcnt vmcnt(5) lgkmcnt(2)
    v_readfirstlane_b32 s12, v10
    s_setprio 0
    s_cmp_ge_u32 s12, s33
    s_cbranch_scc0 g_ck61_s
g_ck61_b:
    v_mfma_f32_16x16x32_bf16 v[104:107], v[12:15], v[48:51], v[104:107]
    ds_read_b128 v[40:43], v62 offset:16384
    ds_read_b128 v[44:47], v62 offset:18432
    v_mfma_f32_16x16x32_bf16 v[108:111], v[12:15], v[52:55], v[108:111]
    ds_read_b128 v[12:15], v2 offset:44544
    v_mfma_f32_16x16x32_bf16 v[112:115], v[16:19], v[48:51], v[112:115]
    buffer_load_dwordx4 v[184:187], v5, s[36:39], s35 offen offset:0 sc1
    v_mfma_f32_16x16x32_bf16 v[116:119], v[16:19], v[52:55], v[116:119]
    ds_read_b128 v[16:19], v2 offset:45568
    v_mfma_f32_16x16x32_bf16 v[120:123], v[20:23], v[48:51], v[120:123]
    v_mfma_f32_16x16x32_bf16 v[124:127], v[20:23], v[52:55], v[124:127]
    ds_read_b128 v[20:23], v2 offset:46592
    buffer_load_dwordx4 v[188:191], v5, s[36:39], s35 offen offset:1024 sc1
    v_mfma_f32_16x16x32_bf16 v[128:131], v[24:27], v[48:51], v[128:131]
    v_mfma_f32_16x16x32_bf16 v[132:135], v[24:27], v[52:55], v[132:135]
    ds_read_b128 v[24:27], v2 offset:47616
    s_waitcnt lgkmcnt(6)
    v_mfma_f32_16x16x32_bf16 v[136:139], v[28:31], v[48:51], v[136:139]
    v_mfma_f32_16x16x32_bf16 v[140:143], v[28:31], v[52:55], v[140:143]
    ds_read_b128 v[28:31], v2 offset:48640
    buffer_load_dwordx4 v[192:195], v5, s[36:39], s35 offen offset:2048 sc1
    v_mfma_f32_16x16x32_bf16 v[144:147], v[32:35], v[48:51], v[144:147]
    v_mfma_f32_16x16x32_bf16 v[148:151], v[32:35], v[52:55], v[148:151]
    ds_read_b128 v[32:35], v2 offset:49664
    v_mfma_f32_16x16x32_bf16 v[152:155], v[36:39], v[48:51], v[152:155]
    buffer_load_dwordx2 v[196:197], v8, s[36:39], s35 offen offset:3072 sc1
    v_mfma_f32_16x16x32_bf16 v[156:159], v[36:39], v[52:55], v[156:159]
    ds_read_b128 v[36:39], v2 offset:50688
    s_waitcnt lgkmcnt(3)
    v_mfma_f32_16x16x32_bf16 v[104:107], v[12:15], v[40:43], v[104:107]
    ds_read_b128 v[48:51], v63 offset:16384
    ds_read_b128 v[52:55], v63 offset:18432
    v_mfma_f32_16x16x32_bf16 v[108:111], v[12:15], v[44:47], v[108:111]
    ds_read_b128 v[12:15], v2 offset:51712
    v_mfma_f32_16x16x32_bf16 v[112:115], v[16:19], v[40:43], v[112:115]
    v_mfma_f32_16x16x32_bf16 v[116:119], v[16:19], v[44:47], v[116:119]
    ds_read_b128 v[16:19], v2 offset:52736
    v_mfma_f32_16x16x32_bf16 v[120:123], v[20:23], v[40:43], v[120:123]
    v_mfma_f32_16x16x32_bf16 v[124:127], v[20:23], v[44:47], v[124:127]
    ds_read_b128 v[20:23], v2 offset:53760
    v_mfma_f32_16x16x32_bf16 v[128:131], v[24:27], v[40:43], v[128:131]
    v_mfma_f32_16x16x32_bf16 v[132:135], v[24:27], v[44:47], v[132:135]
    ds_read_b128 v[24:27], v2 offset:54784
    s_waitcnt lgkmcnt(6)
    v_mfma_f32_16x16x32_bf16 v[136:139], v[28:31], v[40:43], v[136:139]
    v_mfma_f32_16x16x32_bf16 v[140:143], v[28:31], v[44:47], v[140:143]
    ds_read_b128 v[28:31], v2 offset:55808
    v_mfma_f32_16x16x32_bf16 v[144:147], v[32:35], v[40:43], v[144:147]
    v_mfma_f32_16x16x32_bf16 v[148:151], v[32:35], v[44:47], v[148:151]
    ds_read_b128 v[32:35], v2 offset:56832
    v_mfma_f32_16x16x32_bf16 v[152:155], v[36:39], v[40:43], v[152:155]
    v_mfma_f32_16x16x32_bf16 v[156:159], v[36:39], v[44:47], v[156:159]
    ds_read_b128 v[36:39], v2 offset:57856
    s_waitcnt lgkmcnt(3)
    v_mfma_f32_16x16x32_bf16 v[104:107], v[12:15], v[48:51], v[104:107]
    v_mfma_f32_16x16x32_bf16 v[108:111], v[12:15], v[52:55], v[108:111]
    v_mfma_f32_16x16x32_bf16 v[112:115], v[16:19], v[48:51], v[112:115]
    v_mfma_f32_16x16x32_bf16 v[116:119], v[16:19], v[52:55], v[116:119]
    v_mfma_f32_16x16x32_bf16 v[120:123], v[20:23], v[48:51], v[120:123]
    v_mfma_f32_16x16x32_bf16 v[124:127], v[20:23], v[52:55], v[124:127]
    v_mfma_f32_16x16x32_bf16 v[128:131], v[24:27], v[48:51], v[128:131]
    v_mfma_f32_16x16x32_bf16 v[132:135], v[24:27], v[52:55], v[132:135]
    s_waitcnt lgkmcnt(0)
    v_mfma_f32_16x16x32_bf16 v[136:139], v[28:31], v[48:51], v[136:139]
    v_mfma_f32_16x16x32_bf16 v[140:143], v[28:31], v[52:55], v[140:143]
    v_mfma_f32_16x16x32_bf16 v[144:147], v[32:35], v[48:51], v[144:147]
    v_mfma_f32_16x16x32_bf16 v[148:151], v[32:35], v[52:55], v[148:151]
    v_mfma_f32_16x16x32_bf16 v[152:155], v[36:39], v[48:51], v[152:155]
    v_mfma_f32_16x16x32_bf16 v[156:159], v[36:39], v[52:55], v[156:159]
    s_and_b32 s16, s32, 1
    s_mul_i32 s17, s32, 7
    s_add_u32 s17, s17, s16
    s_lshr_b32 s17, s17, 1
    s_add_u32 s17, s17, 32
    s_lshl_b32 s17, s17, 13
    s_mul_i32 s18, s31, 720896
    s_add_u32 s17, s17, s18
    s_lshl_b32 s18, s7, 11
    s_add_u32 s17, s17, s18
    s_add_u32 s17, s17, 0x2000000
    s_add_u32 s18, s17, 8192
    s_add_u32 s19, s17, 16384
    s_mov_b32 s20, 24576
    s_cmp_eq_u32 s16, 0
    s_cselect_b32 s20, s20, 0xffffe008
    s_add_u32 s20, s20, s17
    s_waitcnt vmcnt(0)
    v_lshlrev_b32 v160, 16, v168
    v_and_b32 v161, 0xffff0000, v168
    v_lshlrev_b32 v162, 16, v169
    v_and_b32 v163, 0xffff0000, v169
    v_mul_f32 v104, v104, v160
    v_mul_f32 v105, v105, v161
    v_mul_f32 v106, v106, v162
    v_mul_f32 v107, v107, v163
    v_cvt_pk_bf16_f32 v64, v104, v105
    v_cvt_pk_bf16_f32 v65, v106, v107
    v_lshlrev_b32 v160, 16, v170
    v_and_b32 v161, 0xffff0000, v170
    v_lshlrev_b32 v162, 16, v171
    v_and_b32 v163, 0xffff0000, v171
    v_mul_f32 v112, v112, v160
    v_mul_f32 v113, v113, v161
    v_mul_f32 v114, v114, v162
    v_mul_f32 v115, v115, v163
    v_cvt_pk_bf16_f32 v66, v112, v113
    v_cvt_pk_bf16_f32 v67, v114, v115
    v_lshlrev_b32 v160, 16, v172
    v_and_b32 v161, 0xffff0000, v172
    v_lshlrev_b32 v162, 16, v173
    v_and_b32 v163, 0xffff0000, v173
    v_mul_f32 v120, v120, v160
    v_mul_f32 v121, v121, v161
    v_mul_f32 v122, v122, v162
    v_mul_f32 v123, v123, v163
    v_cvt_pk_bf16_f32 v68, v120, v121
    v_cvt_pk_bf16_f32 v69, v122, v123
    v_lshlrev_b32 v160, 16, v174
    v_and_b32 v161, 0xffff0000, v174
    v_lshlrev_b32 v162, 16, v175
    v_and_b32 v163, 0xffff0000, v175
    v_mul_f32 v128, v128, v160
    v_mul_f32 v129, v129, v161
    v_mul_f32 v130, v130, v162
    v_mul_f32 v131, v131, v163
    v_cvt_pk_bf16_f32 v70, v128, v129
    v_cvt_pk_bf16_f32 v71, v130, v131
    v_lshlrev_b32 v160, 16, v176
    v_and_b32 v161, 0xffff0000, v176
    v_lshlrev_b32 v162, 16, v177
    v_and_b32 v163, 0xffff0000, v177
    v_mul_f32 v136, v136, v160
    v_mul_f32 v137, v137, v161
    v_mul_f32 v138, v138, v162
    v_mul_f32 v139, v139, v163
    v_cvt_pk_bf16_f32 v72, v136, v137
    v_cvt_pk_bf16_f32 v73, v138, v139
    v_lshlrev_b32 v160, 16, v178
    v_and_b32 v161, 0xffff0000, v178
    v_lshlrev_b32 v162, 16, v179
    v_and_b32 v163, 0xffff0000, v179
    v_mul_f32 v144, v144, v160
    v_mul_f32 v145, v145, v161
    v_mul_f32 v146, v146, v162
    v_mul_f32 v147, v147, v163
    v_cvt_pk_bf16_f32 v74, v144, v145
    v_cvt_pk_bf16_f32 v75, v146, v147
    v_lshlrev_b32 v160, 16, v180
    v_and_b32 v161, 0xffff0000, v180
    v_lshlrev_b32 v162, 16, v181
    v_and_b32 v163, 0xffff0000, v181
    v_mul_f32 v152, v152, v160
    v_mul_f32 v153, v153, v161
    v_mul_f32 v154, v154, v162
    v_mul_f32 v155, v155, v163
    v_cvt_pk_bf16_f32 v76, v152, v153
    v_cvt_pk_bf16_f32 v77, v154, v155
    buffer_store_dwordx4 v[64:67], v5, s[36:39], s17 offen offset:0 sc1
    buffer_store_dwordx4 v[68:71], v5, s[36:39], s18 offen offset:0 sc1
    buffer_store_dwordx4 v[72:75], v5, s[36:39], s19 offen offset:0 sc1
    buffer_store_dwordx2 v[76:77], v5, s[36:39], s20 offen offset:0 sc1
    v_lshlrev_b32 v160, 16, v184
    v_and_b32 v161, 0xffff0000, v184
    v_lshlrev_b32 v162, 16, v185
    v_and_b32 v163, 0xffff0000, v185
    v_mul_f32 v108, v108, v160
    v_mul_f32 v109, v109, v161
    v_mul_f32 v110, v110, v162
    v_mul_f32 v111, v111, v163
    v_cvt_pk_bf16_f32 v80, v108, v109
    v_cvt_pk_bf16_f32 v81, v110, v111
    v_lshlrev_b32 v160, 16, v186
    v_and_b32 v161, 0xffff0000, v186
    v_lshlrev_b32 v162, 16, v187
    v_and_b32 v163, 0xffff0000, v187
    v_mul_f32 v116, v116, v160
    v_mul_f32 v117, v117, v161
    v_mul_f32 v118, v118, v162
    v_mul_f32 v119, v119, v163
    v_cvt_pk_bf16_f32 v82, v116, v117
    v_cvt_pk_bf16_f32 v83, v118, v119
    v_lshlrev_b32 v160, 16, v188
    v_and_b32 v161, 0xffff0000, v188
    v_lshlrev_b32 v162, 16, v189
    v_and_b32 v163, 0xffff0000, v189
    v_mul_f32 v124, v124, v160
    v_mul_f32 v125, v125, v161
    v_mul_f32 v126, v126, v162
    v_mul_f32 v127, v127, v163
    v_cvt_pk_bf16_f32 v84, v124, v125
    v_cvt_pk_bf16_f32 v85, v126, v127
    v_lshlrev_b32 v160, 16, v190
    v_and_b32 v161, 0xffff0000, v190
    v_lshlrev_b32 v162, 16, v191
    v_and_b32 v163, 0xffff0000, v191
    v_mul_f32 v132, v132, v160
    v_mul_f32 v133, v133, v161
    v_mul_f32 v134, v134, v162
    v_mul_f32 v135, v135, v163
    v_cvt_pk_bf16_f32 v86, v132, v133
    v_cvt_pk_bf16_f32 v87, v134, v135
    v_lshlrev_b32 v160, 16, v192
    v_and_b32 v161, 0xffff0000, v192
    v_lshlrev_b32 v162, 16, v193
    v_and_b32 v163, 0xffff0000, v193
    v_mul_f32 v140, v140, v160
    v_mul_f32 v141, v141, v161
    v_mul_f32 v142, v142, v162
    v_mul_f32 v143, v143, v163
    v_cvt_pk_bf16_f32 v88, v140, v141
    v_cvt_pk_bf16_f32 v89, v142, v143
    v_lshlrev_b32 v160, 16, v194
    v_and_b32 v161, 0xffff0000, v194
    v_lshlrev_b32 v162, 16, v195
    v_and_b32 v163, 0xffff0000, v195
    v_mul_f32 v148, v148, v160
    v_mul_f32 v149, v149, v161
    v_mul_f32 v150, v150, v162
    v_mul_f32 v151, v151, v163
    v_cvt_pk_bf16_f32 v90, v148, v149
    v_cvt_pk_bf16_f32 v91, v150, v151
    v_lshlrev_b32 v160, 16, v196
    v_and_b32 v161, 0xffff0000, v196
    v_lshlrev_b32 v162, 16, v197
    v_and_b32 v163, 0xffff0000, v197
    v_mul_f32 v156, v156, v160
    v_mul_f32 v157, v157, v161
    v_mul_f32 v158, v158, v162
    v_mul_f32 v159, v159, v163
    v_cvt_pk_bf16_f32 v92, v156, v157
    v_cvt_pk_bf16_f32 v93, v158, v159
    buffer_store_dwordx4 v[80:83], v5, s[36:39], s17 offen offset:1024 sc1
    buffer_store_dwordx4 v[84:87], v5, s[36:39], s18 offen offset:1024 sc1
    buffer_store_dwordx4 v[88:91], v5, s[36:39], s19 offen offset:1024 sc1
    buffer_store_dwordx2 v[92:93], v5, s[36:39], s20 offen offset:1024 sc1
    s_lshl_b32 s14, s31, 4
    s_add_u32 s14, s14, s32
    s_lshl_b32 s14, s14, 7
    s_add_u32 s14, s14, 0x2f20000
    s_mov_b32 s15, 158224
m_out:
    s_setprio 0
    s_and_b32 s16, s5, 3
    s_lshl_b32 s16, s16, 2
    s_lshr_b32 s17, s6, 3
    s_add_u32 s24, s16, s17
    s_lshr_b32 s16, s5, 2
    s_lshl_b32 s16, s16, 3
    s_and_b32 s17, s6, 7
    s_add_u32 s25, s16, s17
    s_lshr_b32 s19, s3, 2
    v_lshlrev_b32 v10, 4, v9
    s_lshl_b32 s30, s3, 11
    v_add_u32 v8, s30, v10
    s_mul_i32 s28, s24, 720896
    s_add_u32 s28, s28, 0x2000000
    s_lshl_b32 s20, s3, 10
    s_add_u32 s31, s20, 16384
    v_add_u32 v1, s20, v10
    s_mul_i32 s29, s25, 360448
    s_add_u32 s29, s29, 0x3800000
    s_lshl_b32 s20, s7, 11
    v_add_u32 v2, s20, v10
    v_bfe_u32 v11, v9, 2, 2
    v_lshrrev_b32 v12, 4, v9
    v_lshl_add_u32 v13, v12, 2, v11
    v_bfe_u32 v14, v13, 1, 2
    v_and_b32 v15, 3, v9
    v_lshlrev_b32 v15, 3, v15
    v_lshl_add_u32 v15, v13, 7, v15
    s_lshl_b32 s20, s19, 1
    v_xor_b32 v14, s20, v14
    v_lshl_add_u32 v4, v14, 5, v15
    v_xor_b32 v14, 1, v14
    v_lshl_add_u32 v5, v14, 5, v15
    s_lshl_b32 s20, s24, 2
    s_add_u32 s20, s20, s7
    s_lshl_b32 s20, s20, 5
    v_lshlrev_b32 v11, 3, v11
    v_and_b32 v13, 3, v9
    v_add3_u32 v11, v11, v13, s20
    v_lshlrev_b32 v11, 11, v11
    v_lshl_add_u32 v11, v12, 3, v11
    s_lshl_b32 s20, s25, 7
    s_lshl_b32 s21, s19, 6
    s_add_u32 s20, s20, s21
    v_add_u32 v11, s20, v11
    v_add_u32 v12, 0x2000, v11
    v_mov_b32 v200, 0
    v_mov_b32 v201, 0
    v_mov_b32 v202, 0
    v_mov_b32 v203, 0
    v_mov_b32 v204, 0
    v_mov_b32 v205, 0
    v_mov_b32 v206, 0
    v_mov_b32 v207, 0
    v_mov_b32 v208, 0
    v_mov_b32 v209, 0
    v_mov_b32 v210, 0
    v_mov_b32 v211, 0
    v_mov_b32 v212, 0
    v_mov_b32 v213, 0
    v_mov_b32 v214, 0
    v_mov_b32 v215, 0
    v_mov_b32 v216, 0
    v_mov_b32 v217, 0
    v_mov_b32 v218, 0
    v_mov_b32 v219, 0
    v_mov_b32 v220, 0
    v_mov_b32 v221, 0
    v_mov_b32 v222, 0
    v_mov_b32 v223, 0
    v_mov_b32 v224, 0
    v_mov_b32 v225, 0
    v_mov_b32 v226, 0
    v_mov_b32 v227, 0
    v_mov_b32 v228, 0
    v_mov_b32 v229, 0
    v_mov_b32 v230, 0
    v_mov_b32 v231, 0
    v_mov_b32 v3, v2
    v_mov_b32 v6, v4
    v_mov_b32 v7, v5
    s_mov_b32 s26, 0
    s_lshl_b32 s20, s25, 4
    s_sub_u32 s20, s20, 32
    v_add_u32 v240, s20, v9
    s_mul_i32 s20, s25, 14
    s_sub_u32 s20, s20, 48
    v_min_u32 v241, 61, v9
    v_add_u32 v241, s20, v241
    v_cmp_gt_u32 vcc, 48, v9
    s_lshr_b32 s20, s24, 1
    v_lshlrev_b32 v242, 3, v9
    v_cndmask_b32 v240, v241, v240, vcc
    v_add_u32 v240, 1024, v240
    v_add_u32 v242, s20, v242
    v_cmp_gt_u32 vcc, 32, v9
    s_lshl_b32 s20, s24, 4
    s_add_u32 s20, s20, 256
    v_cndmask_b32 v242, v240, v242, vcc
    v_and_b32 v243, 15, v9
    v_add_u32 v243, s20, v243
    v_lshlrev_b32 v242, 7, v242
    v_lshlrev_b32 v243, 7, v243
    s_mov_b32 s33, 0x2f18000
    v_mov_b32 v244, s15
    v_mov_b32 v245, 1
    s_waitcnt vmcnt(0)
    s_mov_b64 exec, 1
    ds_add_rtn_u32 v245, v244, v245
    v_mov_b32 v244, s4
    s_waitcnt lgkmcnt(0)
    v_readfirstlane_b32 s16, v245
    v_mov_b32 v245, 0
    s_cmp_lg_u32 s16, 3
    s_cbranch_scc1 f2_nf
    buffer_store_dword v244, v245, s[36:39], s14 offen sc1
f2_nf:
    s_mov_b64 exec, -1
    s_cmp_ge_u32 s3, 4
    s_cbranch_scc1 k_join
    s_cmp_lg_u32 s3, 0
    s_cbranch_scc1 k_np1
    v_mov_b32 v246, 157952
k_gw:
    ds_read_b32 v247, v246
    s_waitcnt lgkmcnt(0)
    v_readfirstlane_b32 s22, v247
    s_cmp_ge_u32 s22, 132
    s_cbranch_scc1 k_gd
    s_sleep 4
    s_branch k_gw
k_gd:
    s_mov_b32 s17, 0x40000
k_p1_l:
    buffer_load_dword v244, v242, s[36:39], s33 offen sc0 sc1
    s_waitcnt vmcnt(0)
    v_xor_b32 v244, s4, v244
    v_cmp_ne_u32 vcc, 0, v244
    s_sub_u32 s17, s17, 1
    s_cselect_b64 vcc, 0, vcc
    s_nop 3
    s_cbranch_vccz k_p1_d
    s_sleep 2
    s_branch k_p1_l
k_p1_d:
k_np1:
    v_lshlrev_b32 v246, 2, v9
    v_add_u32 v246, 157696, v246
    v_mov_b32 v247, 1
    s_add_u32 s34, s34, 4
    ds_add_u32 v246, v247
k_sa_s:
    ds_read_b32 v245, v246
    s_waitcnt lgkmcnt(0)
    v_readfirstlane_b32 s16, v245
    s_cmp_ge_u32 s16, s34
    s_cbranch_scc1 k_sa_x
    s_sleep 3
    s_branch k_sa_s
k_sa_x:
    s_add_u32 m0, s30, 0
    s_add_u32 s16, s28, 0
    buffer_load_dwordx4 v8, s[36:39], s16 offen sc1 lds
    buffer_load_dwordx4 v8, s[36:39], s16 offen offset:1024 sc1 lds
    s_add_u32 m0, s31, 0
    s_add_u32 s16, s29, 0
    buffer_load_dwordx4 v1, s[36:39], s16 offen sc1 lds
    s_add_u32 m0, s30, 8192
    s_add_u32 s16, s28, 8192
    buffer_load_dwordx4 v8, s[36:39], s16 offen sc1 lds
    buffer_load_dwordx4 v8, s[36:39], s16 offen offset:1024 sc1 lds
    s_add_u32 m0, s31, 4096
    s_add_u32 s16, s29, 4096
    buffer_load_dwordx4 v1, s[36:39], s16 offen sc1 lds
    s_add_u32 m0, s30, 24576
    s_add_u32 s16, s28, 16384
    buffer_load_dwordx4 v8, s[36:39], s16 offen sc1 lds
    buffer_load_dwordx4 v8, s[36:39], s16 offen offset:1024 sc1 lds
    s_add_u32 m0, s31, 24576
    s_add_u32 s16, s29, 8192
    buffer_load_dwordx4 v1, s[36:39], s16 offen sc1 lds
    s_add_u32 m0, s30, 32768
    s_add_u32 s16, s28, 24576
    buffer_load_dwordx4 v8, s[36:39], s16 offen sc1 lds
    buffer_load_dwordx4 v8, s[36:39], s16 offen offset:1024 sc1 lds
    s_add_u32 m0, s31, 28672
    s_add_u32 s16, s29, 12288
    buffer_load_dwordx4 v1, s[36:39], s16 offen sc1 lds
    s_waitcnt vmcnt(0)
k_join:
    s_add_u32 s28, s28, 32768
    s_add_u32 s29, s29, 16384
    s_barrier
    s_mov_b32 s27, 49152
    s_add_u32 m0, s27, s30
    s_nop 0
    buffer_load_dwordx4 v8, s[36:39], s28 offen sc1 lds
    buffer_load_dwordx4 v8, s[36:39], s28 offen offset:1024 sc1 lds
    s_add_u32 s28, s28, 16384
    s_add_u32 m0, s27, s31
    s_nop 0
    buffer_load_dwordx4 v1, s[36:39], s29 offen sc1 lds
    s_add_u32 s29, s29, 8192
    s_mov_b32 s27, 73728
    s_add_u32 m0, s27, s30
    s_nop 0
    buffer_load_dwordx4 v8, s[36:39], s28 offen sc1 lds
    buffer_load_dwordx4 v8, s[36:39], s28 offen offset:1024 sc1 lds
    s_add_u32 s28, s28, 16384
    s_add_u32 m0, s27, s31
    s_nop 0
    buffer_load_dwordx4 v1, s[36:39], s29 offen sc1 lds
    s_add_u32 s29, s29, 8192
    ds_read_b128 v[16:19], v3 offset:0
    ds_read_b128 v[20:23], v3 offset:1024
    ds_read_b64_tr_b16 v[32:33], v6 offset:16384
    ds_read_b64_tr_b16 v[34:35], v6 offset:18432
    ds_read_b64_tr_b16 v[36:37], v7 offset:16384
    ds_read_b64_tr_b16 v[38:39], v7 offset:18432
    ds_read_b128 v[24:27], v3 offset:8192
    ds_read_b128 v[28:31], v3 offset:9216
    ds_read_b64_tr_b16 v[40:41], v6 offset:20480
    ds_read_b64_tr_b16 v[42:43], v6 offset:22528
    ds_read_b64_tr_b16 v[44:45], v7 offset:20480
    ds_read_b64_tr_b16 v[46:47], v7 offset:22528
    s_mov_b32 s27, s26
    s_add_u32 s26, s26, 24576
    s_cmp_eq_u32 s26, 147456
    s_cselect_b32 s26, 0, s26
    v_add_u32 v3, s26, v2
    v_add_u32 v6, s26, v4
    v_add_u32 v7, s26, v5
    s_waitcnt vmcnt(6) lgkmcnt(0)
    s_barrier
    s_mov_b32 s27, 98304
    s_add_u32 m0, s27, s30
    s_nop 0
    buffer_load_dwordx4 v8, s[36:39], s28 offen sc1 lds
    v_mfma_f32_16x16x32_bf16 v[200:203], v[32:35], v[16:19], v[200:203]
    buffer_load_dwordx4 v8, s[36:39], s28 offen offset:1024 sc1 lds
    s_add_u32 s28, s28, 16384
    ds_read_b128 v[48:51], v3 offset:0
    ds_read_b128 v[52:55], v3 offset:1024
    v_mfma_f32_16x16x32_bf16 v[204:207], v[36:39], v[16:19], v[204:207]
    s_add_u32 m0, s27, s31
    s_nop 0
    buffer_load_dwordx4 v1, s[36:39], s29 offen sc1 lds
    s_add_u32 s29, s29, 8192
    ds_read_b64_tr_b16 v[64:65], v6 offset:16384
    ds_read_b64_tr_b16 v[66:67], v6 offset:18432
    v_mfma_f32_16x16x32_bf16 v[208:211], v[32:35], v[20:23], v[208:211]
    s_mov_b32 s27, 122880
    s_add_u32 m0, s27, s30
    s_nop 0
    buffer_load_dwordx4 v8, s[36:39], s28 offen sc1 lds
    ds_read_b64_tr_b16 v[68:69], v7 offset:16384
    ds_read_b64_tr_b16 v[70:71], v7 offset:18432
    v_mfma_f32_16x16x32_bf16 v[212:215], v[36:39], v[20:23], v[212:215]
    buffer_load_dwordx4 v8, s[36:39], s28 offen offset:1024 sc1 lds
    s_add_u32 s28, s28, 16384
    ds_read_b128 v[56:59], v3 offset:8192
    ds_read_b128 v[60:63], v3 offset:9216
    v_mfma_f32_16x16x32_bf16 v[200:203], v[40:43], v[24:27], v[200:203]
    s_add_u32 m0, s27, s31
    s_nop 0
    buffer_load_dwordx4 v1, s[36:39], s29 offen sc1 lds
    s_add_u32 s29, s29, 8192
    ds_read_b64_tr_b16 v[72:73], v6 offset:20480
    ds_read_b64_tr_b16 v[74:75], v6 offset:22528
    v_mfma_f32_16x16x32_bf16 v[204:207], v[44:47], v[24:27], v[204:207]
    ds_read_b64_tr_b16 v[76:77], v7 offset:20480
    ds_read_b64_tr_b16 v[78:79], v7 offset:22528
    v_mfma_f32_16x16x32_bf16 v[208:211], v[40:43], v[28:31], v[208:211]
    s_mov_b32 s27, s26
    s_add_u32 s26, s26, 24576
    s_cmp_eq_u32 s26, 147456
    s_cselect_b32 s26, 0, s26
    v_add_u32 v3, s26, v2
    v_add_u32 v6, s26, v4
    v_add_u32 v7, s26, v5
    v_mfma_f32_16x16x32_bf16 v[212:215], v[44:47], v[28:31], v[212:215]
    s_waitcnt vmcnt(9) lgkmcnt(0)
    s_barrier
    s_mov_b32 s27, 0
    s_add_u32 m0, s27, s30
    s_nop 0
    buffer_load_dwordx4 v8, s[36:39], s28 offen sc1 lds
    v_mfma_f32_16x16x32_bf16 v[200:203], v[64:67], v[48:51], v[200:203]
    buffer_load_dwordx4 v8, s[36:39], s28 offen offset:1024 sc1 lds
    s_add_u32 s28, s28, 16384
    ds_read_b128 v[16:19], v3 offset:0
    ds_read_b128 v[20:23], v3 offset:1024
    v_mfma_f32_16x16x32_bf16 v[204:207], v[68:71], v[48:51], v[204:207]
    s_add_u32 m0, s27, s31
    s_nop 0
    buffer_load_dwordx4 v1, s[36:39], s29 offen sc1 lds
    s_add_u32 s29, s29, 8192
    ds_read_b64_tr_b16 v[32:33], v6 offset:16384
    ds_read_b64_tr_b16 v[34:35], v6 offset:18432
    v_mfma_f32_16x16x32_bf16 v[208:211], v[64:67], v[52:55], v[208:211]
    s_mov_b32 s27, 24576
    s_add_u32 m0, s27, s30
    s_nop 0
    buffer_load_dwordx4 v8, s[36:39], s28 offen sc1 lds
    ds_read_b64_tr_b16 v[36:37], v7 offset:16384
    ds_read_b64_tr_b16 v[38:39], v7 offset:18432
    v_mfma_f32_16x16x32_bf16 v[212:215], v[68:71], v[52:55], v[212:215]
    buffer_load_dwordx4 v8, s[36:39], s28 offen offset:1024 sc1 lds
    s_add_u32 s28, s28, 16384
    ds_read_b128 v[24:27], v3 offset:8192
    ds_read_b128 v[28:31], v3 offset:9216
    v_mfma_f32_16x16x32_bf16 v[200:203], v[72:75], v[56:59], v[200:203]
    s_add_u32 m0, s27, s31
    s_nop 0
    buffer_load_dwordx4 v1, s[36:39], s29 offen sc1 lds
    s_add_u32 s29, s29, 8192
    ds_read_b64_tr_b16 v[40:41], v6 offset:20480
    ds_read_b64_tr_b16 v[42:43], v6 offset:22528
    v_mfma_f32_16x16x32_bf16 v[204:207], v[76:79], v[56:59], v[204:207]
    ds_read_b64_tr_b16 v[44:45], v7 offset:20480
    ds_read_b64_tr_b16 v[46:47], v7 offset:22528
    v_mfma_f32_16x16x32_bf16 v[208:211], v[72:75], v[60:63], v[208:211]
    s_mov_b32 s27, s26
    s_add_u32 s26, s26, 24576
    s_cmp_eq_u32 s26, 147456
    s_cselect_b32 s26, 0, s26
    v_add_u32 v3, s26, v2
    v_add_u32 v6, s26, v4
    v_add_u32 v7, s26, v5
    v_mfma_f32_16x16x32_bf16 v[212:215], v[76:79], v[60:63], v[212:215]
    s_waitcnt vmcnt(12) lgkmcnt(0)
    s_barrier
    v_mfma_f32_16x16x32_bf16 v[200:203], v[32:35], v[16:19], v[200:203]
    s_mov_b32 s27, 49152
    s_add_u32 m0, s27, s30
    s_nop 0
    buffer_load_dwordx4 v8, s[36:39], s28 offen sc1 lds
    ds_read_b128 v[48:51], v3 offset:0
    ds_read_b128 v[52:55], v3 offset:1024
    v_mfma_f32_16x16x32_bf16 v[204:207], v[36:39], v[16:19], v[204:207]
    ds_read_b64_tr_b16 v[64:65], v6 offset:16384
    ds_read_b64_tr_b16 v[66:67], v6 offset:18432
    v_mfma_f32_16x16x32_bf16 v[208:211], v[32:35], v[20:23], v[208:211]
    buffer_load_dwordx4 v8, s[36:39], s28 offen offset:1024 sc1 lds
    s_add_u32 s28, s28, 16384
    ds_read_b64_tr_b16 v[68:69], v7 offset:16384
    ds_read_b64_tr_b16 v[70:71], v7 offset:18432
    v_mfma_f32_16x16x32_bf16 v[212:215], v[36:39], v[20:23], v[212:215]
    ds_read_b128 v[56:59], v3 offset:8192
    ds_read_b128 v[60:63], v3 offset:9216
    v_mfma_f32_16x16x32_bf16 v[200:203], v[40:43], v[24:27], v[200:203]
    s_add_u32 m0, s27, s31
    s_nop 0
    buffer_load_dwordx4 v1, s[36:39], s29 offen sc1 lds
    s_add_u32 s29, s29, 8192
    ds_read_b64_tr_b16 v[72:73], v6 offset:20480
    ds_read_b64_tr_b16 v[74:75], v6 offset:22528
    v_mfma_f32_16x16x32_bf16 v[204:207], v[44:47], v[24:27], v[204:207]
    ds_read_b64_tr_b16 v[76:77], v7 offset:20480
    ds_read_b64_tr_b16 v[78:79], v7 offset:22528
    v_mfma_f32_16x16x32_bf16 v[208:211], v[40:43], v[28:31], v[208:211]
    s_mov_b32 s27, s26
    s_add_u32 s26, s26, 24576
    s_cmp_eq_u32 s26, 147456
    s_cselect_b32 s26, 0, s26
    v_add_u32 v3, s26, v2
    v_add_u32 v6, s26, v4
    v_add_u32 v7, s26, v5
    v_mfma_f32_16x16x32_bf16 v[212:215], v[44:47], v[28:31], v[212:215]
    s_waitcnt vmcnt(12) lgkmcnt(0)
    s_barrier
    v_mfma_f32_16x16x32_bf16 v[200:203], v[64:67], v[48:51], v[200:203]
    s_mov_b32 s27, 73728
    s_add_u32 m0, s27, s30
    s_nop 0
    buffer_load_dwordx4 v8, s[36:39], s28 offen sc1 lds
    ds_read_b128 v[16:19], v3 offset:0
    ds_read_b128 v[20:23], v3 offset:1024
    v_mfma_f32_16x16x32_bf16 v[204:207], v[68:71], v[48:51], v[204:207]
    ds_read_b64_tr_b16 v[32:33], v6 offset:16384
    ds_read_b64_tr_b16 v[34:35], v6 offset:18432
    v_mfma_f32_16x16x32_bf16 v[208:211], v[64:67], v[52:55], v[208:211]
    buffer_load_dwordx4 v8, s[36:39], s28 offen offset:1024 sc1 lds
    s_add_u32 s28, s28, 16384
    ds_read_b64_tr_b16 v[36:37], v7 offset:16384
    ds_read_b64_tr_b16 v[38:39], v7 offset:18432
    v_mfma_f32_16x16x32_bf16 v[212:215], v[68:71], v[52:55], v[212:215]
    ds_read_b128 v[24:27], v3 offset:8192
    ds_read_b128 v[28:31], v3 offset:9216
    v_mfma_f32_16x16x32_bf16 v[200:203], v[72:75], v[56:59], v[200:203]
    s_add_u32 m0, s27, s31
    s_nop 0
    buffer_load_dwordx4 v1, s[36:39], s29 offen sc1 lds
    s_add_u32 s29, s29, 8192
    ds_read_b64_tr_b16 v[40:41], v6 offset:20480
    ds_read_b64_tr_b16 v[42:43], v6 offset:22528
    v_mfma_f32_16x16x32_bf16 v[204:207], v[76:79], v[56:59], v[204:207]
    ds_read_b64_tr_b16 v[44:45], v7 offset:20480
    ds_read_b64_tr_b16 v[46:47], v7 offset:22528
    v_mfma_f32_16x16x32_bf16 v[208:211], v[72:75], v[60:63], v[208:211]
    s_mov_b32 s27, s26
    s_add_u32 s26, s26, 24576
    s_cmp_eq_u32 s26, 147456
    s_cselect_b32 s26, 0, s26
    v_add_u32 v3, s26, v2
    v_add_u32 v6, s26, v4
    v_add_u32 v7, s26, v5
    v_mfma_f32_16x16x32_bf16 v[212:215], v[76:79], v[60:63], v[212:215]
    s_waitcnt vmcnt(12) lgkmcnt(0)
    s_barrier
    s_mov_b32 s32, 6
.p2align 3
k3_l1:
    s_bitcmp1_b32 0x50, s32
    s_cbranch_scc1 k_u_r
k_u_b:
    v_mfma_f32_16x16x32_bf16 v[200:203], v[32:35], v[16:19], v[200:203]
    s_add_u32 m0, s27, s30
    s_nop 0
    buffer_load_dwordx4 v8, s[36:39], s28 offen sc1 lds
    ds_read_b128 v[48:51], v3 offset:0
    ds_read_b128 v[52:55], v3 offset:1024
    v_mfma_f32_16x16x32_bf16 v[204:207], v[36:39], v[16:19], v[204:207]
    ds_read_b64_tr_b16 v[64:65], v6 offset:16384
    ds_read_b64_tr_b16 v[66:67], v6 offset:18432
    v_mfma_f32_16x16x32_bf16 v[208:211], v[32:35], v[20:23], v[208:211]
    buffer_load_dwordx4 v8, s[36:39], s28 offen offset:1024 sc1 lds
    s_add_u32 s28, s28, 16384
    ds_read_b64_tr_b16 v[68:69], v7 offset:16384
    ds_read_b64_tr_b16 v[70:71], v7 offset:18432
    v_mfma_f32_16x16x32_bf16 v[212:215], v[36:39], v[20:23], v[212:215]
    ds_read_b128 v[56:59], v3 offset:8192
    ds_read_b128 v[60:63], v3 offset:9216
    v_mfma_f32_16x16x32_bf16 v[200:203], v[40:43], v[24:27], v[200:203]
    s_add_u32 m0, s27, s31
    s_nop 0
    buffer_load_dwordx4 v1, s[36:39], s29 offen sc1 lds
    s_add_u32 s29, s29, 8192
    ds_read_b64_tr_b16 v[72:73], v6 offset:20480
    ds_read_b64_tr_b16 v[74:75], v6 offset:22528
    v_mfma_f32_16x16x32_bf16 v[204:207], v[44:47], v[24:27], v[204:207]
    ds_read_b64_tr_b16 v[76:77], v7 offset:20480
    ds_read_b64_tr_b16 v[78:79], v7 offset:22528
    v_mfma_f32_16x16x32_bf16 v[208:211], v[40:43], v[28:31], v[208:211]
    s_mov_b32 s27, s26
    s_add_u32 s26, s26, 24576
    s_cmp_eq_u32 s26, 147456
    s_cselect_b32 s26, 0, s26
    v_add_u32 v3, s26, v2
    v_add_u32 v6, s26, v4
    v_add_u32 v7, s26, v5
    v_mfma_f32_16x16x32_bf16 v[212:215], v[44:47], v[28:31], v[212:215]
    s_waitcnt vmcnt(12) lgkmcnt(0)
    s_barrier
    v_mfma_f32_16x16x32_bf16 v[200:203], v[64:67], v[48:51], v[200:203]
    s_add_u32 m0, s27, s30
    s_nop 0
    buffer_load_dwordx4 v8, s[36:39], s28 offen sc1 lds
    ds_read_b128 v[16:19], v3 offset:0
    ds_read_b128 v[20:23], v3 offset:1024
    v_mfma_f32_16x16x32_bf16 v[204:207], v[68:71], v[48:51], v[204:207]
    ds_read_b64_tr_b16 v[32:33], v6 offset:16384
    ds_read_b64_tr_b16 v[34:35], v6 offset:18432
    v_mfma_f32_16x16x32_bf16 v[208:211], v[64:67], v[52:55], v[208:211]
    buffer_load_dwordx4 v8, s[36:39], s28 offen offset:1024 sc1 lds
    s_add_u32 s28, s28, 16384
    ds_read_b64_tr_b16 v[36:37], v7 offset:16384
    ds_read_b64_tr_b16 v[38:39], v7 offset:18432
    v_mfma_f32_16x16x32_bf16 v[212:215], v[68:71], v[52:55], v[212:215]
    ds_read_b128 v[24:27], v3 offset:8192
    ds_read_b128 v[28:31], v3 offset:9216
    v_mfma_f32_16x16x32_bf16 v[200:203], v[72:75], v[56:59], v[200:203]
    s_add_u32 m0, s27, s31
    s_nop 0
    buffer_load_dwordx4 v1, s[36:39], s29 offen sc1 lds
    s_add_u32 s29, s29, 8192
    ds_read_b64_tr_b16 v[40:41], v6 offset:20480
    ds_read_b64_tr_b16 v[42:43], v6 offset:22528
    v_mfma_f32_16x16x32_bf16 v[204:207], v[76:79], v[56:59], v[204:207]
    ds_read_b64_tr_b16 v[44:45], v7 offset:20480
    ds_read_b64_tr_b16 v[46:47], v7 offset:22528
    v_mfma_f32_16x16x32_bf16 v[208:211], v[72:75], v[60:63], v[208:211]
    s_mov_b32 s27, s26
    s_add_u32 s26, s26, 24576
    s_cmp_eq_u32 s26, 147456
    s_cselect_b32 s26, 0, s26
    v_add_u32 v3, s26, v2
    v_add_u32 v6, s26, v4
    v_add_u32 v7, s26, v5
    v_mfma_f32_16x16x32_bf16 v[212:215], v[76:79], v[60:63], v[212:215]
    s_waitcnt vmcnt(12) lgkmcnt(0)
    s_barrier
    s_sub_u32 s32, s32, 1
    s_cmp_lg_u32 s32, 0
    s_cbranch_scc1 k3_l1
    s_mov_b32 s32, 11
.p2align 3
k3_l3:
    v_mfma_f32_16x16x32_bf16 v[216:219], v[32:35], v[16:19], v[216:219]
    s_add_u32 m0, s27, s30
    s_nop 0
    buffer_load_dwordx4 v8, s[36:39], s28 offen sc1 lds
    ds_read_b128 v[48:51], v3 offset:0
    ds_read_b128 v[52:55], v3 offset:1024
    v_mfma_f32_16x16x32_bf16 v[220:223], v[36:39], v[16:19], v[220:223]
    ds_read_b64_tr_b16 v[64:65], v6 offset:16384
    ds_read_b64_tr_b16 v[66:67], v6 offset:18432
    v_mfma_f32_16x16x32_bf16 v[224:227], v[32:35], v[20:23], v[224:227]
    buffer_load_dwordx4 v8, s[36:39], s28 offen offset:1024 sc1 lds
    s_add_u32 s28, s28, 16384
    ds_read_b64_tr_b16 v[68:69], v7 offset:16384
    ds_read_b64_tr_b16 v[70:71], v7 offset:18432
    v_mfma_f32_16x16x32_bf16 v[228:231], v[36:39], v[20:23], v[228:231]
    ds_read_b128 v[56:59], v3 offset:8192
    ds_read_b128 v[60:63], v3 offset:9216
    v_mfma_f32_16x16x32_bf16 v[216:219], v[40:43], v[24:27], v[216:219]
    s_add_u32 m0, s27, s31
    s_nop 0
    buffer_load_dwordx4 v1, s[36:39], s29 offen sc1 lds
    s_add_u32 s29, s29, 8192
    ds_read_b64_tr_b16 v[72:73], v6 offset:20480
    ds_read_b64_tr_b16 v[74:75], v6 offset:22528
    v_mfma_f32_16x16x32_bf16 v[220:223], v[44:47], v[24:27], v[220:223]
    ds_read_b64_tr_b16 v[76:77], v7 offset:20480
    ds_read_b64_tr_b16 v[78:79], v7 offset:22528
    v_mfma_f32_16x16x32_bf16 v[224:227], v[40:43], v[28:31], v[224:227]
    s_mov_b32 s27, s26
    s_add_u32 s26, s26, 24576
    s_cmp_eq_u32 s26, 147456
    s_cselect_b32 s26, 0, s26
    v_add_u32 v3, s26, v2
    v_add_u32 v6, s26, v4
    v_add_u32 v7, s26, v5
    v_mfma_f32_16x16x32_bf16 v[228:231], v[44:47], v[28:31], v[228:231]
    s_waitcnt vmcnt(12) lgkmcnt(0)
    s_barrier
    v_mfma_f32_16x16x32_bf16 v[216:219], v[64:67], v[48:51], v[216:219]
    s_add_u32 m0, s27, s30
    s_nop 0
    buffer_load_dwordx4 v8, s[36:39], s28 offen sc1 lds
    ds_read_b128 v[16:19], v3 offset:0
    ds_read_b128 v[20:23], v3 offset:1024
    v_mfma_f32_16x16x32_bf16 v[220:223], v[68:71], v[48:51], v[220:223]
    ds_read_b64_tr_b16 v[32:33], v6 offset:16384
    ds_read_b64_tr_b16 v[34:35], v6 offset:18432
    v_mfma_f32_16x16x32_bf16 v[224:227], v[64:67], v[52:55], v[224:227]
    buffer_load_dwordx4 v8, s[36:39], s28 offen offset:1024 sc1 lds
    s_add_u32 s28, s28, 16384
    ds_read_b64_tr_b16 v[36:37], v7 offset:16384
    ds_read_b64_tr_b16 v[38:39], v7 offset:18432
    v_mfma_f32_16x16x32_bf16 v[228:231], v[68:71], v[52:55], v[228:231]
    ds_read_b128 v[24:27], v3 offset:8192
    ds_read_b128 v[28:31], v3 offset:9216
    v_mfma_f32_16x16x32_bf16 v[216:219], v[72:75], v[56:59], v[216:219]
    s_add_u32 m0, s27, s31
    s_nop 0
    buffer_load_dwordx4 v1, s[36:39], s29 offen sc1 lds
    s_add_u32 s29, s29, 8192
    ds_read_b64_tr_b16 v[40:41], v6 offset:20480
    ds_read_b64_tr_b16 v[42:43], v6 offset:22528
    v_mfma_f32_16x16x32_bf16 v[220:223], v[76:79], v[56:59], v[220:223]
    ds_read_b64_tr_b16 v[44:45], v7 offset:20480
    ds_read_b64_tr_b16 v[46:47], v7 offset:22528
    v_mfma_f32_16x16x32_bf16 v[224:227], v[72:75], v[60:63], v[224:227]
    s_mov_b32 s27, s26
    s_add_u32 s26, s26, 24576
    s_cmp_eq_u32 s26, 147456
    s_cselect_b32 s26, 0, s26
    v_add_u32 v3, s26, v2
    v_add_u32 v6, s26, v4
    v_add_u32 v7, s26, v5
    v_mfma_f32_16x16x32_bf16 v[228:231], v[76:79], v[60:63], v[228:231]
    s_waitcnt vmcnt(12) lgkmcnt(0)
    s_barrier
    s_sub_u32 s32, s32, 1
    s_cmp_lg_u32 s32, 0
    s_cbranch_scc1 k3_l3
    buffer_load_dwordx2 v[232:233], v11, s[56:59], 0 offen offset:0
    buffer_load_dwordx2 v[234:235], v11, s[56:59], 0 offen offset:32
    buffer_load_dwordx2 v[236:237], v12, s[56:59], 0 offen offset:0
    buffer_load_dwordx2 v[238:239], v12, s[56:59], 0 offen offset:32
    v_mfma_f32_16x16x32_bf16 v[216:219], v[32:35], v[16:19], v[216:219]
    ds_read_b128 v[48:51], v3 offset:0
    ds_read_b128 v[52:55], v3 offset:1024
    v_mfma_f32_16x16x32_bf16 v[220:223], v[36:39], v[16:19], v[220:223]
    ds_read_b64_tr_b16 v[64:65], v6 offset:16384
    ds_read_b64_tr_b16 v[66:67], v6 offset:18432
    v_mfma_f32_16x16x32_bf16 v[224:227], v[32:35], v[20:23], v[224:227]
    ds_read_b64_tr_b16 v[68:69], v7 offset:16384
    ds_read_b64_tr_b16 v[70:71], v7 offset:18432
    v_mfma_f32_16x16x32_bf16 v[228:231], v[36:39], v[20:23], v[228:231]
    ds_read_b128 v[56:59], v3 offset:8192
    ds_read_b128 v[60:63], v3 offset:9216
    v_mfma_f32_16x16x32_bf16 v[216:219], v[40:43], v[24:27], v[216:219]
    ds_read_b64_tr_b16 v[72:73], v6 offset:20480
    ds_read_b64_tr_b16 v[74:75], v6 offset:22528
    v_mfma_f32_16x16x32_bf16 v[220:223], v[44:47], v[24:27], v[220:223]
    ds_read_b64_tr_b16 v[76:77], v7 offset:20480
    ds_read_b64_tr_b16 v[78:79], v7 offset:22528
    v_mfma_f32_16x16x32_bf16 v[224:227], v[40:43], v[28:31], v[224:227]
    s_mov_b32 s27, s26
    s_add_u32 s26, s26, 24576
    s_cmp_eq_u32 s26, 147456
    s_cselect_b32 s26, 0, s26
    v_add_u32 v3, s26, v2
    v_add_u32 v6, s26, v4
    v_add_u32 v7, s26, v5
    v_mfma_f32_16x16x32_bf16 v[228:231], v[44:47], v[28:31], v[228:231]
    s_waitcnt vmcnt(13) lgkmcnt(0)
    s_barrier
    v_mfma_f32_16x16x32_bf16 v[216:219], v[64:67], v[48:51], v[216:219]
    ds_read_b128 v[16:19], v3 offset:0
    ds_read_b128 v[20:23], v3 offset:1024
    v_mfma_f32_16x16x32_bf16 v[220:223], v[68:71], v[48:51], v[220:223]
    ds_read_b64_tr_b16 v[32:33], v6 offset:16384
    ds_read_b64_tr_b16 v[34:35], v6 offset:18432
    v_mfma_f32_16x16x32_bf16 v[224:227], v[64:67], v[52:55], v[224:227]
    ds_read_b64_tr_b16 v[36:37], v7 offset:16384
    ds_read_b64_tr_b16 v[38:39], v7 offset:18432
    v_mfma_f32_16x16x32_bf16 v[228:231], v[68:71], v[52:55], v[228:231]
    ds_read_b128 v[24:27], v3 offset:8192
    ds_read_b128 v[28:31], v3 offset:9216
    v_mfma_f32_16x16x32_bf16 v[216:219], v[72:75], v[56:59], v[216:219]
    ds_read_b64_tr_b16 v[40:41], v6 offset:20480
    ds_read_b64_tr_b16 v[42:43], v6 offset:22528
    v_mfma_f32_16x16x32_bf16 v[220:223], v[76:79], v[56:59], v[220:223]
    ds_read_b64_tr_b16 v[44:45], v7 offset:20480
    ds_read_b64_tr_b16 v[46:47], v7 offset:22528
    v_mfma_f32_16x16x32_bf16 v[224:227], v[72:75], v[60:63], v[224:227]
    s_mov_b32 s27, s26
    s_add_u32 s26, s26, 24576
    s_cmp_eq_u32 s26, 147456
    s_cselect_b32 s26, 0, s26
    v_add_u32 v3, s26, v2
    v_add_u32 v6, s26, v4
    v_add_u32 v7, s26, v5
    v_mfma_f32_16x16x32_bf16 v[228:231], v[76:79], v[60:63], v[228:231]
    s_waitcnt vmcnt(10) lgkmcnt(0)
    s_barrier
    v_mfma_f32_16x16x32_bf16 v[216:219], v[32:35], v[16:19], v[216:219]
    ds_read_b128 v[48:51], v3 offset:0
    ds_read_b128 v[52:55], v3 offset:1024
    v_mfma_f32_16x16x32_bf16 v[220:223], v[36:39], v[16:19], v[220:223]
    ds_read_b64_tr_b16 v[64:65], v6 offset:16384
    ds_read_b64_tr_b16 v[66:67], v6 offset:18432
    v_mfma_f32_16x16x32_bf16 v[224:227], v[32:35], v[20:23], v[224:227]
    ds_read_b64_tr_b16 v[68:69], v7 offset:16384
    ds_read_b64_tr_b16 v[70:71], v7 offset:18432
    v_mfma_f32_16x16x32_bf16 v[228:231], v[36:39], v[20:23], v[228:231]
    ds_read_b128 v[56:59], v3 offset:8192
    ds_read_b128 v[60:63], v3 offset:9216
    v_mfma_f32_16x16x32_bf16 v[216:219], v[40:43], v[24:27], v[216:219]
    ds_read_b64_tr_b16 v[72:73], v6 offset:20480
    ds_read_b64_tr_b16 v[74:75], v6 offset:22528
    v_mfma_f32_16x16x32_bf16 v[220:223], v[44:47], v[24:27], v[220:223]
    ds_read_b64_tr_b16 v[76:77], v7 offset:20480
    ds_read_b64_tr_b16 v[78:79], v7 offset:22528
    v_mfma_f32_16x16x32_bf16 v[224:227], v[40:43], v[28:31], v[224:227]
    s_mov_b32 s27, s26
    s_add_u32 s26, s26, 24576
    s_cmp_eq_u32 s26, 147456
    s_cselect_b32 s26, 0, s26
    v_add_u32 v3, s26, v2
    v_add_u32 v6, s26, v4
    v_add_u32 v7, s26, v5
    v_mfma_f32_16x16x32_bf16 v[228:231], v[44:47], v[28:31], v[228:231]
    s_waitcnt vmcnt(7) lgkmcnt(0)
    s_barrier
    v_mfma_f32_16x16x32_bf16 v[216:219], v[64:67], v[48:51], v[216:219]
    ds_read_b128 v[16:19], v3 offset:0
    ds_read_b128 v[20:23], v3 offset:1024
    v_mfma_f32_16x16x32_bf16 v[220:223], v[68:71], v[48:51], v[220:223]
    ds_read_b64_tr_b16 v[32:33], v6 offset:16384
    ds_read_b64_tr_b16 v[34:35], v6 offset:18432
    v_mfma_f32_16x16x32_bf16 v[224:227], v[64:67], v[52:55], v[224:227]
    ds_read_b64_tr_b16 v[36:37], v7 offset:16384
    ds_read_b64_tr_b16 v[38:39], v7 offset:18432
    v_mfma_f32_16x16x32_bf16 v[228:231], v[68:71], v[52:55], v[228:231]
    ds_read_b128 v[24:27], v3 offset:8192
    ds_read_b128 v[28:31], v3 offset:9216
    v_mfma_f32_16x16x32_bf16 v[216:219], v[72:75], v[56:59], v[216:219]
    ds_read_b64_tr_b16 v[40:41], v6 offset:20480
    ds_read_b64_tr_b16 v[42:43], v6 offset:22528
    v_mfma_f32_16x16x32_bf16 v[220:223], v[76:79], v[56:59], v[220:223]
    ds_read_b64_tr_b16 v[44:45], v7 offset:20480
    ds_read_b64_tr_b16 v[46:47], v7 offset:22528
    v_mfma_f32_16x16x32_bf16 v[224:227], v[72:75], v[60:63], v[224:227]
    s_mov_b32 s27, s26
    s_add_u32 s26, s26, 24576
    s_cmp_eq_u32 s26, 147456
    s_cselect_b32 s26, 0, s26
    v_add_u32 v3, s26, v2
    v_add_u32 v6, s26, v4
    v_add_u32 v7, s26, v5
    v_mfma_f32_16x16x32_bf16 v[228:231], v[76:79], v[60:63], v[228:231]
    s_waitcnt vmcnt(4) lgkmcnt(0)
    s_barrier
    v_mfma_f32_16x16x32_bf16 v[216:219], v[32:35], v[16:19], v[216:219]
    ds_read_b128 v[48:51], v3 offset:0
    ds_read_b128 v[52:55], v3 offset:1024
    v_mfma_f32_16x16x32_bf16 v[220:223], v[36:39], v[16:19], v[220:223]
    ds_read_b64_tr_b16 v[64:65], v6 offset:16384
    ds_read_b64_tr_b16 v[66:67], v6 offset:18432
    v_mfma_f32_16x16x32_bf16 v[224:227], v[32:35], v[20:23], v[224:227]
    ds_read_b64_tr_b16 v[68:69], v7 offset:16384
    ds_read_b64_tr_b16 v[70:71], v7 offset:18432
    v_mfma_f32_16x16x32_bf16 v[228:231], v[36:39], v[20:23], v[228:231]
    ds_read_b128 v[56:59], v3 offset:8192
    ds_read_b128 v[60:63], v3 offset:9216
    v_mfma_f32_16x16x32_bf16 v[216:219], v[40:43], v[24:27], v[216:219]
    ds_read_b64_tr_b16 v[72:73], v6 offset:20480
    ds_read_b64_tr_b16 v[74:75], v6 offset:22528
    v_mfma_f32_16x16x32_bf16 v[220:223], v[44:47], v[24:27], v[220:223]
    ds_read_b64_tr_b16 v[76:77], v7 offset:20480
    ds_read_b64_tr_b16 v[78:79], v7 offset:22528
    v_mfma_f32_16x16x32_bf16 v[224:227], v[40:43], v[28:31], v[224:227]
    s_mov_b32 s27, s26
    s_add_u32 s26, s26, 24576
    s_cmp_eq_u32 s26, 147456
    s_cselect_b32 s26, 0, s26
    v_add_u32 v3, s26, v2
    v_add_u32 v6, s26, v4
    v_add_u32 v7, s26, v5
    v_mfma_f32_16x16x32_bf16 v[228:231], v[44:47], v[28:31], v[228:231]
    s_waitcnt lgkmcnt(0)
    v_mfma_f32_16x16x32_bf16 v[216:219], v[64:67], v[48:51], v[216:219]
    v_mfma_f32_16x16x32_bf16 v[220:223], v[68:71], v[48:51], v[220:223]
    v_mfma_f32_16x16x32_bf16 v[224:227], v[64:67], v[52:55], v[224:227]
    v_mfma_f32_16x16x32_bf16 v[228:231], v[68:71], v[52:55], v[228:231]
    v_mfma_f32_16x16x32_bf16 v[216:219], v[72:75], v[56:59], v[216:219]
    v_mfma_f32_16x16x32_bf16 v[220:223], v[76:79], v[56:59], v[220:223]
    v_mfma_f32_16x16x32_bf16 v[224:227], v[72:75], v[60:63], v[224:227]
    v_mfma_f32_16x16x32_bf16 v[228:231], v[76:79], v[60:63], v[228:231]
    s_waitcnt vmcnt(0)
    s_nop 7
    s_mov_b32 s20, 0xbfb8aa3b
    v_mul_f32 v16, s20, v216
    v_mul_f32 v17, s20, v217
    v_mul_f32 v18, s20, v218
    v_mul_f32 v19, s20, v219
    v_mul_f32 v20, s20, v220
    v_mul_f32 v21, s20, v221
    v_mul_f32 v22, s20, v222
    v_mul_f32 v23, s20, v223
    v_mul_f32 v24, s20, v224
    v_mul_f32 v25, s20, v225
    v_mul_f32 v26, s20, v226
    v_mul_f32 v27, s20, v227
    v_mul_f32 v28, s20, v228
    v_mul_f32 v29, s20, v229
    v_mul_f32 v30, s20, v230
    v_mul_f32 v31, s20, v231
    v_exp_f32 v16, v16
    v_exp_f32 v17, v17
    v_exp_f32 v18, v18
    v_exp_f32 v19, v19
    v_exp_f32 v20, v20
    v_exp_f32 v21, v21
    v_exp_f32 v22, v22
    v_exp_f32 v23, v23
    v_exp_f32 v24, v24
    v_exp_f32 v25, v25
    v_exp_f32 v26, v26
    v_exp_f32 v27, v27
    v_exp_f32 v28, v28
    v_exp_f32 v29, v29
    v_exp_f32 v30, v30
    v_exp_f32 v31, v31
    v_add_f32 v16, 1.0, v16
    v_add_f32 v17, 1.0, v17
    v_add_f32 v18, 1.0, v18
    v_add_f32 v19, 1.0, v19
    v_add_f32 v20, 1.0, v20
    v_add_f32 v21, 1.0, v21
    v_add_f32 v22, 1.0, v22
    v_add_f32 v23, 1.0, v23
    v_add_f32 v24, 1.0, v24
    v_add_f32 v25, 1.0, v25
    v_add_f32 v26, 1.0, v26
    v_add_f32 v27, 1.0, v27
    v_add_f32 v28, 1.0, v28
    v_add_f32 v29, 1.0, v29
    v_add_f32 v30, 1.0, v30
    v_add_f32 v31, 1.0, v31
    v_rcp_f32 v16, v16
    v_rcp_f32 v17, v17
    v_rcp_f32 v18, v18
    v_rcp_f32 v19, v19
    v_rcp_f32 v20, v20
    v_rcp_f32 v21, v21
    v_rcp_f32 v22, v22
    v_rcp_f32 v23, v23
    v_rcp_f32 v24, v24
    v_rcp_f32 v25, v25
    v_rcp_f32 v26, v26
    v_rcp_f32 v27, v27
    v_rcp_f32 v28, v28
    v_rcp_f32 v29, v29
    v_rcp_f32 v30, v30
    v_rcp_f32 v31, v31
    v_mul_f32 v16, v16, v216
    v_mul_f32 v17, v17, v217
    v_mul_f32 v18, v18, v218
    v_mul_f32 v19, v19, v219
    v_mul_f32 v20, v20, v220
    v_mul_f32 v21, v21, v221
    v_mul_f32 v22, v22, v222
    v_mul_f32 v23, v23, v223
    v_mul_f32 v24, v24, v224
    v_mul_f32 v25, v25, v225
    v_mul_f32 v26, v26, v226
    v_mul_f32 v27, v27, v227
    v_mul_f32 v28, v28, v228
    v_mul_f32 v29, v29, v229
    v_mul_f32 v30, v30, v230
    v_mul_f32 v31, v31, v231
    v_lshlrev_b32 v32, 16, v232
    v_and_b32 v33, 0xffff0000, v232
    v_lshlrev_b32 v34, 16, v233
    v_and_b32 v35, 0xffff0000, v233
    v_lshlrev_b32 v36, 16, v234
    v_and_b32 v37, 0xffff0000, v234
    v_lshlrev_b32 v38, 16, v235
    v_and_b32 v39, 0xffff0000, v235
    v_lshlrev_b32 v40, 16, v236
    v_and_b32 v41, 0xffff0000, v236
    v_lshlrev_b32 v42, 16, v237
    v_and_b32 v43, 0xffff0000, v237
    v_lshlrev_b32 v44, 16, v238
    v_and_b32 v45, 0xffff0000, v238
    v_lshlrev_b32 v46, 16, v239
    v_and_b32 v47, 0xffff0000, v239
    v_fmac_f32 v32, v16, v200
    v_fmac_f32 v33, v17, v201
    v_fmac_f32 v34, v18, v202
    v_fmac_f32 v35, v19, v203
    v_fmac_f32 v36, v20, v204
    v_fmac_f32 v37, v21, v205
    v_fmac_f32 v38, v22, v206
    v_fmac_f32 v39, v23, v207
    v_fmac_f32 v40, v24, v208
    v_fmac_f32 v41, v25, v209
    v_fmac_f32 v42, v26, v210
    v_fmac_f32 v43, v27, v211
    v_fmac_f32 v44, v28, v212
    v_fmac_f32 v45, v29, v213
    v_fmac_f32 v46, v30, v214
    v_fmac_f32 v47, v31, v215
    v_cvt_pk_bf16_f32 v48, v32, v33
    v_cvt_pk_bf16_f32 v49, v34, v35
    v_cvt_pk_bf16_f32 v50, v36, v37
    v_cvt_pk_bf16_f32 v51, v38, v39
    v_cvt_pk_bf16_f32 v52, v40, v41
    v_cvt_pk_bf16_f32 v53, v42, v43
    v_cvt_pk_bf16_f32 v54, v44, v45
    v_cvt_pk_bf16_f32 v55, v46, v47
    buffer_store_dwordx2 v[48:49], v11, s[60:63], 0 offen offset:0
    buffer_store_dwordx2 v[50:51], v11, s[60:63], 0 offen offset:32
    buffer_store_dwordx2 v[52:53], v12, s[60:63], 0 offen offset:0
    buffer_store_dwordx2 v[54:55], v12, s[60:63], 0 offen offset:32
    s_or_b32 s16, s2, s3
    s_cmp_lg_u32 s16, 0
    s_cbranch_scc1 k3_fin
    s_mov_b32 s16, 0x2f30000
    v_mov_b32 v60, s4
    v_mov_b32 v61, 0
    s_waitcnt vmcnt(0)
    s_mov_b64 exec, 1
    buffer_store_dword v60, v61, s[36:39], s16 offen sc1
    s_mov_b64 exec, -1
k3_fin:
    s_waitcnt vmcnt(0)
    s_endpgm
a_cp_r:
    s_cmp_eq_u32 s10, 11
    s_cbranch_scc1 a_cp_e0
    s_cmp_eq_u32 s10, 10
    s_cbranch_scc1 a_cp_e1
    s_cmp_eq_u32 s10, 9
    s_cbranch_scc1 a_cp_e2
    s_cmp_eq_u32 s10, 6
    s_cbranch_scc1 a_cp_e3
    s_cmp_eq_u32 s10, 5
    s_cbranch_scc1 a_cp_e4
    s_cmp_eq_u32 s10, 4
    s_cbranch_scc1 a_cp_e5
a_cp_e6:
    s_add_u32 s13, s15, 196608
    v_mov_b32 v184, 158232
    v_mov_b32 v185, 1
    s_waitcnt vmcnt(63)
    s_mov_b64 exec, 1
    ds_add_rtn_u32 v185, v184, v185
    v_mov_b32 v184, s4
    s_waitcnt lgkmcnt(0)
    v_readfirstlane_b32 s12, v185
    v_mov_b32 v185, 0
    s_cmp_lg_u32 s12, 3
    s_cbranch_scc1 f1i_nf
    buffer_store_dword v184, v185, s[36:39], s13 offen sc1
f1i_nf:
    s_mov_b64 exec, -1
    s_branch a_cp_b
a_cp_e5:
    buffer_store_dwordx4 v[232:235], v4, s[36:39], s14 offen offset:2048 sc1
    buffer_store_dwordx4 v[236:239], v4, s[36:39], s14 offen offset:3072 sc1
    s_branch a_cp_b
a_cp_e4:
    buffer_store_dwordx4 v[224:227], v4, s[36:39], s14 offen offset:0 sc1
    buffer_store_dwordx4 v[228:231], v4, s[36:39], s14 offen offset:1024 sc1
    s_branch a_cp_b
a_cp_e3:
    buffer_store_dwordx4 v[216:219], v4, s[36:39], s11 offen offset:0 sc1
    buffer_store_dwordx4 v[220:223], v4, s[36:39], s11 offen offset:1024 sc1
    s_branch a_cp_b
a_cp_e2:
    buffer_load_dwordx4 v[232:235], v1, s[52:55], s9 offen
    s_add_u32 s9, s9, 16384
    buffer_load_dwordx4 v[236:239], v1, s[52:55], s9 offen
    s_add_u32 s9, s9, 16384
    s_branch a_cp_b
a_cp_e1:
    buffer_load_dwordx4 v[224:227], v1, s[52:55], s9 offen
    s_add_u32 s9, s9, 16384
    buffer_load_dwordx4 v[228:231], v1, s[52:55], s9 offen
    s_add_u32 s9, s9, 16384
    s_branch a_cp_b
a_cp_e0:
    buffer_load_dwordx4 v[216:219], v1, s[48:51], s8 offen
    s_add_u32 s8, s8, 16384
    buffer_load_dwordx4 v[220:223], v1, s[48:51], s8 offen
    s_add_u32 s8, s8, 16384
    s_branch a_cp_b
a_ck_s:
    ds_read_b32 v5, v7
    s_waitcnt lgkmcnt(0)
    v_readfirstlane_b32 s12, v5
    s_cmp_ge_u32 s12, s34
    s_cbranch_scc0 a_ck_s
    s_branch a_ck_b
g1_z1_cp_r:
    s_cmp_eq_u32 s10, 10
    s_cbranch_scc1 g1_z1_cp_e0
    s_cmp_eq_u32 s10, 8
    s_cbranch_scc1 g1_z1_cp_e1
    s_cmp_eq_u32 s10, 6
    s_cbranch_scc1 g1_z1_cp_e2
g1_z1_cp_e3:
    buffer_load_dword v248, v229, s[44:47], s8 offen
    s_add_u32 s8, s8, 0x200000
    buffer_load_dword v249, v229, s[44:47], s8 offen
    s_add_u32 s8, s8, 0x200000
    s_branch g1_z1_cp_b
g1_z1_cp_e2:
    buffer_load_dword v248, v229, s[44:47], s8 offen
    s_add_u32 s8, s8, 0x200000
    buffer_load_dword v249, v229, s[44:47], s8 offen
    s_add_u32 s8, s8, 0x200000
    s_branch g1_z1_cp_b
g1_z1_cp_e1:
    buffer_load_dword v248, v229, s[40:43], s8 offen
    s_add_u32 s8, s8, 0x200000
    s_sub_u32 s8, s8, 0x800000
    s_branch g1_z1_cp_b
g1_z1_cp_e0:
    buffer_load_dword v248, v229, s[40:43], s8 offen
    buffer_load_dword v249, v229, s[20:23], s8 offen
    s_add_u32 s8, s8, 0x200000
    s_branch g1_z1_cp_b
g1_z2_cp_r:
    s_cmp_eq_u32 s10, 10
    s_cbranch_scc1 g1_z2_cp_e0
    s_cmp_eq_u32 s10, 8
    s_cbranch_scc1 g1_z2_cp_e1
    s_cmp_eq_u32 s10, 6
    s_cbranch_scc1 g1_z2_cp_e2
g1_z2_cp_e3:
    buffer_load_dword v248, v229, s[44:47], s8 offen
    s_add_u32 s8, s8, 0x200000
    buffer_load_dword v249, v229, s[44:47], s8 offen
    s_add_u32 s8, s8, 0x200000
    s_branch g1_z2_cp_b
g1_z2_cp_e2:
    buffer_load_dword v248, v229, s[44:47], s8 offen
    s_add_u32 s8, s8, 0x200000
    buffer_load_dword v249, v229, s[44:47], s8 offen
    s_add_u32 s8, s8, 0x200000
    s_branch g1_z2_cp_b
g1_z2_cp_e1:
    buffer_load_dword v248, v229, s[40:43], s8 offen
    s_add_u32 s8, s8, 0x200000
    s_sub_u32 s8, s8, 0x800000
    s_branch g1_z2_cp_b
g1_z2_cp_e0:
    buffer_load_dword v248, v229, s[40:43], s8 offen
    buffer_load_dword v249, v229, s[20:23], s8 offen
    s_add_u32 s8, s8, 0x200000
    s_branch g1_z2_cp_b
g_z10_r:
g_z10_e0:
    buffer_store_dwordx4 v[200:203], v5, s[36:39], s8 offen offset:0 sc1
    buffer_store_dwordx4 v[204:207], v5, s[36:39], s8 offen offset:1024 sc1
    buffer_store_dwordx4 v[208:211], v5, s[36:39], s8 offen offset:2048 sc1
    buffer_store_dwordx2 v[212:213], v8, s[36:39], s8 offen offset:3072 sc1
    s_add_u32 s8, s8, 57344
    s_branch g_z10_b
g_ck25_s:
    ds_read_b32 v10, v1
    s_waitcnt lgkmcnt(0)
    v_readfirstlane_b32 s12, v10
    s_cmp_ge_u32 s12, s33
    s_cbranch_scc0 g_ck25_s
    s_branch g_ck25_b
g_ck27_s:
    ds_read_b32 v10, v1
    s_waitcnt lgkmcnt(0)
    v_readfirstlane_b32 s12, v10
    s_cmp_ge_u32 s12, s33
    s_cbranch_scc0 g_ck27_s
    s_branch g_ck27_b
g_ck29_s:
    ds_read_b32 v10, v1
    s_waitcnt lgkmcnt(0)
    v_readfirstlane_b32 s12, v10
    s_cmp_ge_u32 s12, s33
    s_cbranch_scc0 g_ck29_s
    s_branch g_ck29_b
g_z16_r:
g_z16_e0:
    buffer_store_dwordx4 v[214:217], v5, s[36:39], s8 offen offset:0 sc1
    buffer_store_dwordx4 v[218:221], v5, s[36:39], s8 offen offset:1024 sc1
    buffer_store_dwordx4 v[222:225], v5, s[36:39], s8 offen offset:2048 sc1
    buffer_store_dwordx2 v[226:227], v8, s[36:39], s8 offen offset:3072 sc1
    s_add_u32 s8, s8, 57344
    s_branch g_z16_b
g_ck31_s:
    ds_read_b32 v10, v1
    s_waitcnt lgkmcnt(0)
    v_readfirstlane_b32 s12, v10
    s_cmp_ge_u32 s12, s33
    s_cbranch_scc0 g_ck31_s
    s_branch g_ck31_b
g_ck33_s:
    ds_read_b32 v10, v1
    s_waitcnt lgkmcnt(0)
    v_readfirstlane_b32 s12, v10
    s_cmp_ge_u32 s12, s33
    s_cbranch_scc0 g_ck33_s
    s_branch g_ck33_b
g_ck35_s:
    ds_read_b32 v10, v1
    s_waitcnt lgkmcnt(0)
    v_readfirstlane_b32 s12, v10
    s_cmp_ge_u32 s12, s33
    s_cbranch_scc0 g_ck35_s
    s_branch g_ck35_b
g_z112_r:
    s_cmp_eq_u32 s10, 2
    s_cbranch_scc1 g_z112_e0
g_z112_e1:
    v_mov_b32 v160, 158228
    v_mov_b32 v161, 1
    s_mov_b64 exec, 1
    ds_add_rtn_u32 v161, v160, v161
    v_mov_b32 v160, s4
    s_waitcnt lgkmcnt(0)
    v_readfirstlane_b32 s12, v161
    v_mov_b32 v161, 0
    s_cmp_lg_u32 s12, 3
    s_cbranch_scc1 f1y_nf
    buffer_store_dword v160, v161, s[36:39], s9 offen sc1
f1y_nf:
    s_mov_b64 exec, -1
    s_branch g_z112_b
g_z112_e0:
    buffer_store_dwordx4 v[228:231], v5, s[36:39], s8 offen offset:0 sc1
    buffer_store_dwordx4 v[232:235], v5, s[36:39], s8 offen offset:1024 sc1
    buffer_store_dwordx4 v[236:239], v5, s[36:39], s8 offen offset:2048 sc1
    buffer_store_dwordx2 v[240:241], v8, s[36:39], s8 offen offset:3072 sc1
    s_add_u32 s8, s8, 57344
    s_branch g_z112_b
g_ck37_s:
    ds_read_b32 v10, v1
    s_waitcnt lgkmcnt(0)
    v_readfirstlane_b32 s12, v10
    s_cmp_ge_u32 s12, s33
    s_cbranch_scc0 g_ck37_s
    s_branch g_ck37_b
g_ck39_s:
    ds_read_b32 v10, v1
    s_waitcnt lgkmcnt(0)
    v_readfirstlane_b32 s12, v10
    s_cmp_ge_u32 s12, s33
    s_cbranch_scc0 g_ck39_s
    s_branch g_ck39_b
g_ck41_s:
    ds_read_b32 v10, v1
    s_waitcnt lgkmcnt(0)
    v_readfirstlane_b32 s12, v10
    s_cmp_ge_u32 s12, s33
    s_cbranch_scc0 g_ck41_s
    s_branch g_ck41_b
g_z118_r:
g_z118_e0:
    buffer_store_dwordx4 v[242:245], v5, s[36:39], s8 offen offset:0 sc1
    buffer_store_dwordx4 v[246:249], v5, s[36:39], s8 offen offset:1024 sc1
    buffer_store_dwordx4 v[250:253], v5, s[36:39], s8 offen offset:2048 sc1
    buffer_store_dwordx2 v[254:255], v8, s[36:39], s8 offen offset:3072 sc1
    s_add_u32 s8, s8, 57344
    s_branch g_z118_b
g_ck43_s:
    ds_read_b32 v10, v1
    s_waitcnt lgkmcnt(0)
    v_readfirstlane_b32 s12, v10
    s_cmp_ge_u32 s12, s33
    s_cbranch_scc0 g_ck43_s
    s_branch g_ck43_b
g_ck45_s:
    ds_read_b32 v10, v1
    s_waitcnt lgkmcnt(0)
    v_readfirstlane_b32 s12, v10
    s_cmp_ge_u32 s12, s33
    s_cbranch_scc0 g_ck45_s
    s_branch g_ck45_b
g_ck47_s:
    ds_read_b32 v10, v1
    s_waitcnt lgkmcnt(0)
    v_readfirstlane_b32 s12, v10
    s_cmp_ge_u32 s12, s33
    s_cbranch_scc0 g_ck47_s
    s_branch g_ck47_b
g_ck49_s:
    ds_read_b32 v10, v1
    s_waitcnt lgkmcnt(0)
    v_readfirstlane_b32 s12, v10
    s_cmp_ge_u32 s12, s33
    s_cbranch_scc0 g_ck49_s
    s_branch g_ck49_b
g_ck51_s:
    ds_read_b32 v10, v1
    s_waitcnt lgkmcnt(0)
    v_readfirstlane_b32 s12, v10
    s_cmp_ge_u32 s12, s33
    s_cbranch_scc0 g_ck51_s
    s_branch g_ck51_b
g_ck53_s:
    ds_read_b32 v10, v1
    s_waitcnt lgkmcnt(0)
    v_readfirstlane_b32 s12, v10
    s_cmp_ge_u32 s12, s33
    s_cbranch_scc0 g_ck53_s
    s_branch g_ck53_b
g_ck55_s:
    ds_read_b32 v10, v1
    s_waitcnt lgkmcnt(0)
    v_readfirstlane_b32 s12, v10
    s_cmp_ge_u32 s12, s33
    s_cbranch_scc0 g_ck55_s
    s_branch g_ck55_b
g_ck57_s:
    ds_read_b32 v10, v1
    s_waitcnt lgkmcnt(0)
    v_readfirstlane_b32 s12, v10
    s_cmp_ge_u32 s12, s33
    s_cbranch_scc0 g_ck57_s
    s_branch g_ck57_b
g_ck59_s:
    ds_read_b32 v10, v1
    s_waitcnt lgkmcnt(0)
    v_readfirstlane_b32 s12, v10
    s_cmp_ge_u32 s12, s33
    s_cbranch_scc0 g_ck59_s
    s_branch g_ck59_b
g_fy_s:
    s_mov_b32 s13, 0x40000
g_fyp_l:
    buffer_load_dword v167, v11, s[36:39], s29 offen sc0 sc1
    s_waitcnt vmcnt(0)
    v_xor_b32 v167, s4, v167
    v_cmp_ne_u32 vcc, 0, v167
    s_sub_u32 s13, s13, 1
    s_cselect_b64 vcc, 0, vcc
    s_nop 3
    s_cbranch_vccz g_fyp_d
    s_sleep 2
    s_branch g_fyp_l
g_fyp_d:
    s_branch g_fy_b
g_ck61_s:
    ds_read_b32 v10, v1
    s_waitcnt lgkmcnt(0)
    v_readfirstlane_b32 s12, v10
    s_cmp_ge_u32 s12, s33
    s_cbranch_scc0 g_ck61_s
    s_branch g_ck61_b
k_fg_s:
    s_mov_b32 s17, 0x40000
k_fgp_l:
    buffer_load_dword v244, v243, s[36:39], s33 offen sc0 sc1
    s_waitcnt vmcnt(0)
    v_xor_b32 v244, s4, v244
    v_cmp_ne_u32 vcc, 0, v244
    s_sub_u32 s17, s17, 1
    s_cselect_b64 vcc, 0, vcc
    s_nop 3
    s_cbranch_vccz k_fgp_d
    s_sleep 2
    s_branch k_fgp_l
k_fgp_d:
    s_branch k_fg_b
k_u_r:
    s_cmp_eq_u32 s32, 6
    s_cbranch_scc1 k_u_e0
k_u_e1:
    v_cmp_ne_u32 vcc, s4, v244
    s_nop 4
    s_cbranch_vccnz k_fg_s
k_fg_b:
    s_branch k_u_b
k_u_e0:
    buffer_load_dword v244, v243, s[36:39], s33 offen sc0 sc1
    s_branch k_u_b
m_done:
    s_endpgm
code_end:
.section .rodata,"a"
.p2align 6
.amdhsa_kernel recurrent_scan__mha_block__mixer_gmlp__prompt_kernel
  .amdhsa_next_free_vgpr 256
  .amdhsa_next_free_sgpr 102
  .amdhsa_accum_offset 256
  .amdhsa_group_segment_fixed_size 0
  .amdhsa_kernarg_size 88
  .amdhsa_user_sgpr_count 2
  .amdhsa_user_sgpr_kernarg_segment_ptr 1
  .amdhsa_system_sgpr_workgroup_id_x 1
  .amdhsa_float_denorm_mode_32 3
  .amdhsa_float_denorm_mode_16_64 3
.end_amdhsa_kernel
```
